```python
import torch

def _softmax(x, axis=-1):
    return torch.softmax(x, dim=axis)
def _gelu(x):
    return torch.nn.functional.gelu(x, approximate="tanh")
def _silu(x):
    return torch.nn.functional.silu(x)
def _sigmoid(x):
    return torch.sigmoid(x)
def _layernorm(x, axis=-1, eps=1e-5):
    m = x.mean(dim=axis, keepdim=True)
    v = x.var(dim=axis, keepdim=True, unbiased=False)
    return (x - m) / torch.sqrt(v + eps)
def _scatter_add(tgt, idx, src, axis=0):
    return tgt.clone().index_add_(axis, idx, src)
def _segment_sum(src, seg, n):
    out = torch.zeros((n,) + src.shape[1:], dtype=src.dtype)
    return out.index_add_(0, seg, src)
def _pad(x, pw):
    flat = tuple(v for pair in reversed(pw) for v in pair)
    return torch.nn.functional.pad(x, flat)

kernel_name = 'sequential_preLN__linear_kernel_hedgehog__geglu_ffn__prompt'

def setup_inputs():

    _w = (lambda a: (lambda t: t.to(torch.bfloat16) if t.is_floating_point() else t)(torch.as_tensor(a)))
    def _A_setup():
        B, S, D, H = 1, 2048, 640, 32
        Dh = D // H
        return {
            "x": _w((lambda *s: torch.randn(*s, dtype=torch.bfloat16) * 0.05)(B, S, D)),
            "wqkv": _w((lambda *s: torch.randn(*s, dtype=torch.bfloat16) * 0.2)(D, 3 * D)),
            "w_phi": _w((lambda *s: torch.randn(*s, dtype=torch.bfloat16) * 0.2)(H, Dh, Dh) * (Dh ** -0.5)),
            "wo": _w((lambda *s: torch.randn(*s, dtype=torch.bfloat16) * 0.05)(D, D)),
        }
    _A_in = _A_setup()

    def _B_setup():
        B, S, D, F = 1, 2048, 640, 1728
        return {
            "x": _w((lambda *s: torch.randn(*s, dtype=torch.bfloat16) * 0.05)(B, S, D)),
            "w_gate": _w((lambda *s: torch.randn(*s, dtype=torch.bfloat16) * 0.05)(D, F)),
            "w_up": _w((lambda *s: torch.randn(*s, dtype=torch.bfloat16) * 0.05)(D, F)),
            "w_down": _w((lambda *s: torch.randn(*s, dtype=torch.bfloat16) * 0.05)(F, D)),
        }
    _B_in = _B_setup()

    return {
        "A_x": _A_in["x"],
        "A_wqkv": _A_in["wqkv"],
        "A_w_phi": _A_in["w_phi"],
        "A_wo": _A_in["wo"],
        "B_x": _B_in["x"],
        "B_w_gate": _B_in["w_gate"],
        "B_w_up": _B_in["w_up"],
        "B_w_down": _B_in["w_down"],
    }

def reference(A_x, A_wqkv, A_w_phi, A_wo, B_x, B_w_gate, B_w_up, B_w_down):
    def _A_ref(x, wqkv, w_phi, wo):
        B, S, D = x.shape
        H = 32; Dh = D // H
        qkv = (lambda x, *d: x.permute(*d))((x @ wqkv).reshape(B, S, 3, H, Dh), 2, 0, 3, 1, 4)
        q, k, v = qkv[0], qkv[1], qkv[2]
        pq = torch.einsum("bhsd,hdf->bhsf", q, w_phi)
        pk = torch.einsum("bhsd,hdf->bhsf", k, w_phi)
        phi_q = torch.concatenate([_softmax(pq, axis=-1), _softmax(-pq, axis=-1)], axis=-1)
        phi_k = torch.concatenate([_softmax(pk, axis=-1), _softmax(-pk, axis=-1)], axis=-1)
        kv = torch.einsum("bhsf,bhsd->bhfd", phi_k, v)
        z  = torch.einsum("bhsf->bhf", phi_k)
        num = torch.einsum("bhqf,bhfd->bhqd", phi_q, kv)
        den = torch.einsum("bhqf,bhf->bhq", phi_q, z)[..., None] + 1e-6
        o = num / den
        return (lambda x, *d: x.permute(*d))(o, 0, 2, 1, 3).reshape(B, S, D) @ wo

    def _B_ref(x, w_gate, w_up, w_down):
        return (_gelu(x @ w_gate) * (x @ w_up)) @ w_down

    x = A_x
    h = x + _A_ref(_layernorm(x, axis=-1), A_wqkv, A_w_phi, A_wo)
    h2 = h + _B_ref(_layernorm(h, axis=-1), B_w_gate, B_w_up, B_w_down)
    return h2
```

```asm
; @launch grid=(256,1,1) block=(512,1,1) lds=163840
.amdgcn_target "amdgcn-amd-amdhsa--gfx950"
.text
.globl sequential_preLN__linear_kernel_hedgehog__geglu_ffn__prompt_kernel
.p2align 8
.type sequential_preLN__linear_kernel_hedgehog__geglu_ffn__prompt_kernel,@function
sequential_preLN__linear_kernel_hedgehog__geglu_ffn__prompt_kernel:
  s_cmp_ge_u32 s2, 256
  s_cbranch_scc1 Lsequential_preLN__linear_kernel_hedgehog__geglu_ffn__prompt_kernel_end
  s_load_dwordx4 s[4:7], s[0:1], 0
  s_load_dwordx4 s[64:67], s[0:1], 16
  s_load_dwordx4 s[68:71], s[0:1], 40
  s_load_dwordx2 s[72:73], s[0:1], 56
  s_load_dwordx2 s[8:9], s[0:1], 80
  s_load_dwordx2 s[98:99], s[0:1], 72
  v_and_b32 v1, 63, v0
  v_lshrrev_b32 v2, 6, v0
  s_and_b32 s20, s2, 7
  s_lshr_b32 s21, s2, 3
  s_and_b32 s24, s20, 1
  s_lshl_b32 s24, s24, 3
  s_and_b32 s25, s21, 7
  s_add_u32 s24, s24, s25
  s_lshr_b32 s23, s20, 1
  s_lshl_b32 s23, s23, 2
  s_lshr_b32 s25, s21, 3
  s_add_u32 s23, s23, s25
  v_readfirstlane_b32 s22, v2
  v_lshrrev_b32 v3, 4, v1
  v_and_b32 v21, 15, v1
  s_nop 1
  s_and_b32 s25, s22, 3
  s_lshl_b32 s26, s23, 7
  s_lshl_b32 s27, s25, 5
  s_add_u32 s26, s26, s27
  s_lshr_b32 s27, s22, 2
  s_lshl_b32 s27, s27, 4
  s_add_u32 s26, s26, s27
  s_and_b32 s19, s26, 127
  s_cmp_ge_u32 s22, 4
  s_cbranch_scc1 Lsequential_preLN__linear_kernel_hedgehog__geglu_ffn__prompt_kernel_H1
  s_waitcnt lgkmcnt(0)
  v_mov_b32 v224, 0
  v_lshlrev_b32 v226, 2, v0
  v_add_u32 v226, 160640, v226
  ds_write_b32 v226, v224
  s_mul_i32 s31, s24, 1600
  v_add_u32 v48, 0, v0
  v_min_u32 v48, 959, v48
  v_mul_u32_u24 v49, 2731, v48
  v_lshrrev_b32 v49, 16, v49
  v_mul_u32_u24 v50, 24, v49
  v_sub_u32 v50, v48, v50
  v_mul_u32_u24 v51, 3277, v49
  v_lshrrev_b32 v51, 16, v51
  v_mul_u32_u24 v52, 20, v51
  v_sub_u32 v52, v49, v52
  v_mul_u32_u24 v53, 800, v51
  v_mul_u32_u24 v54, 40, v50
  v_add3_u32 v53, v53, v54, s31
  v_lshl_add_u32 v53, v52, 1, v53
  v_min_u32 v53, 25598, v53
  global_load_ushort v54, v53, s[64:65]
  v_lshlrev_b32 v48, 1, v48
  v_add_u32 v48, 158720, v48
  v_add_u32 v56, 256, v0
  v_min_u32 v56, 959, v56
  v_mul_u32_u24 v57, 2731, v56
  v_lshrrev_b32 v57, 16, v57
  v_mul_u32_u24 v58, 24, v57
  v_sub_u32 v58, v56, v58
  v_mul_u32_u24 v59, 3277, v57
  v_lshrrev_b32 v59, 16, v59
  v_mul_u32_u24 v60, 20, v59
  v_sub_u32 v60, v57, v60
  v_mul_u32_u24 v61, 800, v59
  v_mul_u32_u24 v62, 40, v58
  v_add3_u32 v61, v61, v62, s31
  v_lshl_add_u32 v61, v60, 1, v61
  v_min_u32 v61, 25598, v61
  global_load_ushort v62, v61, s[64:65]
  v_lshlrev_b32 v56, 1, v56
  v_add_u32 v56, 158720, v56
  v_add_u32 v64, 512, v0
  v_min_u32 v64, 959, v64
  v_mul_u32_u24 v65, 2731, v64
  v_lshrrev_b32 v65, 16, v65
  v_mul_u32_u24 v66, 24, v65
  v_sub_u32 v66, v64, v66
  v_mul_u32_u24 v67, 3277, v65
  v_lshrrev_b32 v67, 16, v67
  v_mul_u32_u24 v68, 20, v67
  v_sub_u32 v68, v65, v68
  v_mul_u32_u24 v69, 800, v67
  v_mul_u32_u24 v70, 40, v66
  v_add3_u32 v69, v69, v70, s31
  v_lshl_add_u32 v69, v68, 1, v69
  v_min_u32 v69, 25598, v69
  global_load_ushort v70, v69, s[64:65]
  v_lshlrev_b32 v64, 1, v64
  v_add_u32 v64, 158720, v64
  v_add_u32 v72, 768, v0
  v_min_u32 v72, 959, v72
  v_mul_u32_u24 v73, 2731, v72
  v_lshrrev_b32 v73, 16, v73
  v_mul_u32_u24 v74, 24, v73
  v_sub_u32 v74, v72, v74
  v_mul_u32_u24 v75, 3277, v73
  v_lshrrev_b32 v75, 16, v75
  v_mul_u32_u24 v76, 20, v75
  v_sub_u32 v76, v73, v76
  v_mul_u32_u24 v77, 800, v75
  v_mul_u32_u24 v78, 40, v74
  v_add3_u32 v77, v77, v78, s31
  v_lshl_add_u32 v77, v76, 1, v77
  v_min_u32 v77, 25598, v77
  global_load_ushort v78, v77, s[64:65]
  v_lshlrev_b32 v72, 1, v72
  v_add_u32 v72, 158720, v72
  s_mov_b32 s36, s4
  s_mov_b32 s37, s5
  s_mov_b32 s38, 2621440
  s_mov_b32 s39, 0x20000
  s_mov_b32 s40, s6
  s_mov_b32 s41, s7
  s_mov_b32 s42, 2457600
  s_mov_b32 s43, 0x20000
  s_lshl_b32 s52, s21, 2
  s_add_u32 s52, s52, s25
  s_and_b32 s53, s52, 1
  s_mul_i32 s53, s53, 60
  v_add_u32 v30, s53, v1
  v_min_u32 v30, 119, v30
  v_mul_u32_u24 v31, 1639, v30
  v_lshrrev_b32 v31, 16, v31
  v_mul_u32_u24 v29, 40, v31
  v_sub_u32 v30, v30, v29
  v_mul_u32_u24 v31, 1280, v31
  v_lshl_add_u32 v226, v30, 4, v31
  s_lshr_b32 s53, s52, 1
  s_mul_i32 s53, s53, 3840
  s_and_b32 s54, s20, 1
  s_mul_i32 s54, s54, 640
  s_add_u32 s53, s53, s54
  s_lshr_b32 s54, s20, 1
  s_lshl_b32 s54, s54, 9
  s_lshl_b32 s55, s52, 2
  s_add_u32 s54, s54, s55
  s_mul_i32 s54, s54, 1280
  v_mul_u32_u24 v227, 1280, v3
  v_lshl_add_u32 v227, v21, 4, v227
  v_lshrrev_b32 v22, 2, v21
  v_and_b32 v23, 3, v21
  v_mul_u32_u24 v4, 1920, v3
  v_mul_u32_u24 v148, 160, v22
  v_mul_u32_u24 v149, 40, v23
  v_add3_u32 v4, v4, v148, v149
  v_add_u32 v4, 16384, v4
  v_lshrrev_b32 v148, 1, v23
  v_add_u32 v148, 0, v148
  v_mul_u32_u24 v149, 5, v22
  v_add_u32 v148, v148, v149
  v_mul_u32_u24 v150, 3, v148
  v_mov_b32 v152, 0x5a1096a0
  v_mov_b32 v153, 0x08886226
  v_lshrrev_b64 v[152:153], v150, v[152:153]
  v_and_b32 v150, 7, v152
  v_mul_u32_u24 v148, 1920, v3
  v_mul_u32_u24 v149, 80, v22
  v_add_u32 v148, v148, v149
  v_lshl_add_u32 v148, v150, 4, v148
  v_and_b32 v149, 1, v23
  v_lshl_add_u32 v148, v149, 3, v148
  v_add_u32 v7, 17024, v148
  v_lshrrev_b32 v148, 1, v23
  v_add_u32 v148, 2, v148
  v_mul_u32_u24 v149, 5, v22
  v_add_u32 v148, v148, v149
  v_mul_u32_u24 v150, 3, v148
  v_mov_b32 v152, 0x5a1096a0
  v_mov_b32 v153, 0x08886226
  v_lshrrev_b64 v[152:153], v150, v[152:153]
  v_and_b32 v150, 7, v152
  v_mul_u32_u24 v148, 1920, v3
  v_mul_u32_u24 v149, 80, v22
  v_add_u32 v148, v148, v149
  v_lshl_add_u32 v148, v150, 4, v148
  v_and_b32 v149, 1, v23
  v_lshl_add_u32 v148, v149, 3, v148
  v_add_u32 v10, 17024, v148
  v_mov_b32 v148, 4
  v_mul_u32_u24 v149, 5, v22
  v_add_u32 v148, v148, v149
  v_mul_u32_u24 v150, 3, v148
  v_mov_b32 v152, 0x5a1096a0
  v_mov_b32 v153, 0x08886226
  v_lshrrev_b64 v[152:153], v150, v[152:153]
  v_and_b32 v150, 7, v152
  v_mul_u32_u24 v148, 1920, v3
  v_mul_u32_u24 v149, 80, v22
  v_add_u32 v148, v148, v149
  v_lshl_add_u32 v148, v150, 4, v148
  v_and_b32 v149, 1, v23
  v_lshl_add_u32 v148, v149, 3, v148
  v_add_u32 v13, 17024, v148
  s_lshl_b32 s29, s25, 12
  v_lshrrev_b32 v148, 3, v21
  v_and_b32 v149, 7, v21
  v_xor_b32 v150, v3, v149
  v_lshlrev_b32 v148, 10, v148
  v_lshl_add_u32 v148, v149, 7, v148
  v_add_u32 v148, s29, v148
  v_lshl_add_u32 v16, v150, 4, v148
  v_xor_b32 v150, 4, v150
  v_lshl_add_u32 v24, v150, 4, v148
  s_lshl_b32 s31, s25, 1
  s_add_u32 s31, s31, 0
  s_lshl_b32 s32, s31, 3
  v_add_u32 v27, s32, v4
  s_cmp_eq_u32 s31, 5
  s_cselect_b64 vcc, -1, 0
  v_cndmask_b32 v27, v27, v7, vcc
  s_cmp_eq_u32 s31, 6
  s_cselect_b64 vcc, -1, 0
  v_cndmask_b32 v27, v27, v10, vcc
  s_cmp_eq_u32 s31, 7
  s_cselect_b64 vcc, -1, 0
  v_cndmask_b32 v27, v27, v13, vcc
  s_lshl_b32 s31, s25, 1
  s_add_u32 s31, s31, 1
  s_lshl_b32 s32, s31, 3
  v_add_u32 v176, s32, v4
  s_cmp_eq_u32 s31, 5
  s_cselect_b64 vcc, -1, 0
  v_cndmask_b32 v176, v176, v7, vcc
  s_cmp_eq_u32 s31, 6
  s_cselect_b64 vcc, -1, 0
  v_cndmask_b32 v176, v176, v10, vcc
  s_cmp_eq_u32 s31, 7
  s_cselect_b64 vcc, -1, 0
  v_cndmask_b32 v176, v176, v13, vcc
  v_add_u32 v5, 63488, v4
  v_add_u32 v6, 126976, v4
  v_add_u32 v8, 63488, v7
  v_add_u32 v9, 126976, v7
  v_add_u32 v11, 63488, v10
  v_add_u32 v12, 126976, v10
  v_add_u32 v14, 63488, v13
  v_add_u32 v15, 126976, v13
  v_add_u32 v17, 63488, v16
  v_add_u32 v18, 126976, v16
  v_add_u32 v25, 63488, v24
  v_add_u32 v26, 126976, v24
  v_add_u32 v28, 63488, v27
  v_add_u32 v29, 126976, v27
  v_add_u32 v177, 63488, v176
  v_add_u32 v178, 126976, v176
  v_mov_b32 v220, 0x3f803f80
  v_mov_b32 v221, 0x3f803f80
  v_mov_b32 v222, 0x3f803f80
  v_mov_b32 v223, 0x3f803f80
  s_waitcnt lgkmcnt(0)
  s_mov_b32 s12, s8
  s_mov_b32 s13, s9
  s_mov_b32 s14, 37748736
  s_mov_b32 s15, 0x20000
  s_waitcnt vmcnt(0)
  v_cmp_gt_u32 vcc, 20, v50
  s_nop 1
  v_cndmask_b32 v54, 0, v54, vcc
  ds_write_b16 v48, v54
  v_cmp_gt_u32 vcc, 20, v58
  s_nop 1
  v_cndmask_b32 v62, 0, v62, vcc
  ds_write_b16 v56, v62
  v_cmp_gt_u32 vcc, 20, v66
  s_nop 1
  v_cndmask_b32 v70, 0, v70, vcc
  ds_write_b16 v64, v70
  v_cmp_gt_u32 vcc, 20, v74
  s_nop 1
  v_cndmask_b32 v78, 0, v78, vcc
  ds_write_b16 v72, v78
  s_cmp_lg_u32 s2, 0
  s_cbranch_scc1 Lsequential_preLN__linear_kernel_hedgehog__geglu_ffn__prompt_kernel_n1
  s_cmp_lg_u32 s22, 0
  s_cbranch_scc1 Lsequential_preLN__linear_kernel_hedgehog__geglu_ffn__prompt_kernel_n1
  v_mov_b32 v228, 0
  s_mov_b32 s97, 24637440
  buffer_load_dword v229, v228, s[12:15], s97 offen sc1
  s_waitcnt vmcnt(0)
  s_mov_b32 s96, 0x9e3779b1
  v_mul_lo_u32 v229, v229, s96
  v_add_u32 v229, 0x7f4a7c15, v229
  v_max_u32 v229, 1, v229
  buffer_store_dword v229, v228, s[12:15], s97 offen sc0 sc1
  global_store_dword v228, v229, s[98:99] sc0 sc1
Lsequential_preLN__linear_kernel_hedgehog__geglu_ffn__prompt_kernel_n1:
  s_waitcnt lgkmcnt(0)
  s_barrier
  s_add_u32 s55, s53, 491520
  buffer_load_dwordx4 v[232:235], v226, s[40:43], s55 offen
  s_add_u32 s55, s53, 737280
  buffer_load_dwordx4 v[232:235], v226, s[40:43], s55 offen
  buffer_load_dwordx4 v[232:235], v227, s[36:39], s54 offen offset:256
  s_add_u32 s55, s53, 983040
  buffer_load_dwordx4 v[232:235], v226, s[40:43], s55 offen
  s_add_u32 s55, s53, 1228800
  buffer_load_dwordx4 v[232:235], v226, s[40:43], s55 offen
  buffer_load_dwordx4 v[232:235], v227, s[36:39], s54 offen offset:512
  s_add_u32 s55, s53, 1474560
  buffer_load_dwordx4 v[232:235], v226, s[40:43], s55 offen
  s_add_u32 s55, s53, 1720320
  buffer_load_dwordx4 v[232:235], v226, s[40:43], s55 offen
  buffer_load_dwordx4 v[232:235], v227, s[36:39], s54 offen offset:768
  s_add_u32 s55, s53, 1966080
  buffer_load_dwordx4 v[232:235], v226, s[40:43], s55 offen
  s_add_u32 s55, s53, 2211840
  buffer_load_dwordx4 v[232:235], v226, s[40:43], s55 offen
  buffer_load_dwordx4 v[232:235], v227, s[36:39], s54 offen offset:1024
  ds_read_b64_tr_b16 v[48:49], v4 offset:0
  ds_read_b64_tr_b16 v[50:51], v4 offset:960
  ds_read_b64_tr_b16 v[52:53], v4 offset:8
  ds_read_b64_tr_b16 v[54:55], v4 offset:968
  ds_read_b64_tr_b16 v[56:57], v4 offset:16
  ds_read_b64_tr_b16 v[58:59], v4 offset:976
  ds_read_b64_tr_b16 v[60:61], v4 offset:24
  ds_read_b64_tr_b16 v[62:63], v4 offset:984
  ds_read_b64_tr_b16 v[64:65], v4 offset:32
  ds_read_b64_tr_b16 v[66:67], v4 offset:992
  ds_read_b64_tr_b16 v[68:69], v7 offset:0
  ds_read_b64_tr_b16 v[70:71], v7 offset:960
  ds_read_b64_tr_b16 v[72:73], v10 offset:0
  ds_read_b64_tr_b16 v[74:75], v10 offset:960
  ds_read_b64_tr_b16 v[76:77], v13 offset:0
  ds_read_b64_tr_b16 v[78:79], v13 offset:960
  ds_read_b64_tr_b16 v[180:181], v27 offset:0
  ds_read_b64_tr_b16 v[182:183], v27 offset:960
  ds_read_b64_tr_b16 v[184:185], v176 offset:0
  ds_read_b64_tr_b16 v[186:187], v176 offset:960
  ds_read_b128 v[32:35], v16 offset:0
  ds_read_b128 v[36:39], v16 offset:2048
  ds_read_b64_tr_b16 v[80:81], v4 offset:7680
  ds_read_b64_tr_b16 v[82:83], v4 offset:8640
  ds_read_b64_tr_b16 v[84:85], v4 offset:7688
  ds_read_b64_tr_b16 v[86:87], v4 offset:8648
  ds_read_b64_tr_b16 v[88:89], v4 offset:7696
  ds_read_b64_tr_b16 v[90:91], v4 offset:8656
  ds_read_b64_tr_b16 v[92:93], v4 offset:7704
  ds_read_b64_tr_b16 v[94:95], v4 offset:8664
  ds_read_b64_tr_b16 v[96:97], v4 offset:7712
  ds_read_b64_tr_b16 v[98:99], v4 offset:8672
  ds_read_b64_tr_b16 v[100:101], v7 offset:7680
  ds_read_b64_tr_b16 v[102:103], v7 offset:8640
  ds_read_b64_tr_b16 v[104:105], v10 offset:7680
  ds_read_b64_tr_b16 v[106:107], v10 offset:8640
  ds_read_b64_tr_b16 v[108:109], v13 offset:7680
  ds_read_b64_tr_b16 v[110:111], v13 offset:8640
  ds_read_b64_tr_b16 v[188:189], v27 offset:7680
  ds_read_b64_tr_b16 v[190:191], v27 offset:8640
  ds_read_b64_tr_b16 v[192:193], v176 offset:7680
  ds_read_b64_tr_b16 v[194:195], v176 offset:8640
  ds_read_b128 v[40:43], v24 offset:0
  ds_read_b128 v[44:47], v24 offset:2048
  s_waitcnt lgkmcnt(0)
  s_barrier
  v_mfma_f32_16x16x32_bf16 v[112:115], v[48:51], v[32:35], 0
  v_mfma_f32_16x16x32_bf16 v[144:147], v[48:51], v[36:39], 0
  ds_read_b64_tr_b16 v[48:49], v4 offset:31744
  v_mfma_f32_16x16x32_bf16 v[116:119], v[52:55], v[32:35], 0
  ds_read_b64_tr_b16 v[50:51], v4 offset:32704
  v_mfma_f32_16x16x32_bf16 v[148:151], v[52:55], v[36:39], 0
  ds_read_b64_tr_b16 v[52:53], v4 offset:31752
  v_mfma_f32_16x16x32_bf16 v[120:123], v[56:59], v[32:35], 0
  ds_read_b64_tr_b16 v[54:55], v4 offset:32712
  v_mfma_f32_16x16x32_bf16 v[152:155], v[56:59], v[36:39], 0
  ds_read_b64_tr_b16 v[56:57], v4 offset:31760
  v_mfma_f32_16x16x32_bf16 v[124:127], v[60:63], v[32:35], 0
  ds_read_b64_tr_b16 v[58:59], v4 offset:32720
  v_mfma_f32_16x16x32_bf16 v[156:159], v[60:63], v[36:39], 0
  ds_read_b64_tr_b16 v[60:61], v4 offset:31768
  v_mfma_f32_16x16x32_bf16 v[128:131], v[64:67], v[32:35], 0
  ds_read_b64_tr_b16 v[62:63], v4 offset:32728
  v_mfma_f32_16x16x32_bf16 v[160:163], v[64:67], v[36:39], 0
  ds_read_b64_tr_b16 v[64:65], v4 offset:31776
  v_mfma_f32_16x16x32_bf16 v[132:135], v[68:71], v[32:35], 0
  ds_read_b64_tr_b16 v[66:67], v4 offset:32736
  v_mfma_f32_16x16x32_bf16 v[164:167], v[68:71], v[36:39], 0
  ds_read_b64_tr_b16 v[68:69], v7 offset:31744
  v_mfma_f32_16x16x32_bf16 v[136:139], v[72:75], v[32:35], 0
  ds_read_b64_tr_b16 v[70:71], v7 offset:32704
  v_mfma_f32_16x16x32_bf16 v[168:171], v[72:75], v[36:39], 0
  ds_read_b64_tr_b16 v[72:73], v10 offset:31744
  v_mfma_f32_16x16x32_bf16 v[140:143], v[76:79], v[32:35], 0
  ds_read_b64_tr_b16 v[74:75], v10 offset:32704
  v_mfma_f32_16x16x32_bf16 v[172:175], v[76:79], v[36:39], 0
  ds_read_b64_tr_b16 v[76:77], v13 offset:31744
  v_mfma_f32_16x16x32_bf16 v[196:199], v[180:183], v[220:223], 0
  ds_read_b64_tr_b16 v[78:79], v13 offset:32704
  ds_read_b64_tr_b16 v[180:181], v27 offset:31744
  v_mfma_f32_16x16x32_bf16 v[200:203], v[184:187], v[220:223], 0
  ds_read_b64_tr_b16 v[182:183], v27 offset:32704
  ds_read_b64_tr_b16 v[184:185], v176 offset:31744
  v_mfma_f32_16x16x32_bf16 v[204:207], v[220:223], v[32:35], 0
  ds_read_b64_tr_b16 v[186:187], v176 offset:32704
  v_mfma_f32_16x16x32_bf16 v[212:215], v[32:35], v[32:35], 0
  ds_read_b128 v[32:35], v16 offset:31744
  v_mfma_f32_16x16x32_bf16 v[208:211], v[220:223], v[36:39], 0
  v_mfma_f32_16x16x32_bf16 v[216:219], v[36:39], v[36:39], 0
  ds_read_b128 v[36:39], v16 offset:33792
  v_mfma_f32_16x16x32_bf16 v[112:115], v[80:83], v[40:43], v[112:115]
  v_mfma_f32_16x16x32_bf16 v[144:147], v[80:83], v[44:47], v[144:147]
  ds_read_b64_tr_b16 v[80:81], v4 offset:39424
  v_mfma_f32_16x16x32_bf16 v[116:119], v[84:87], v[40:43], v[116:119]
  ds_read_b64_tr_b16 v[82:83], v4 offset:40384
  v_mfma_f32_16x16x32_bf16 v[148:151], v[84:87], v[44:47], v[148:151]
  ds_read_b64_tr_b16 v[84:85], v4 offset:39432
  v_mfma_f32_16x16x32_bf16 v[120:123], v[88:91], v[40:43], v[120:123]
  ds_read_b64_tr_b16 v[86:87], v4 offset:40392
  v_mfma_f32_16x16x32_bf16 v[152:155], v[88:91], v[44:47], v[152:155]
  ds_read_b64_tr_b16 v[88:89], v4 offset:39440
  v_mfma_f32_16x16x32_bf16 v[124:127], v[92:95], v[40:43], v[124:127]
  ds_read_b64_tr_b16 v[90:91], v4 offset:40400
  v_mfma_f32_16x16x32_bf16 v[156:159], v[92:95], v[44:47], v[156:159]
  ds_read_b64_tr_b16 v[92:93], v4 offset:39448
  v_mfma_f32_16x16x32_bf16 v[128:131], v[96:99], v[40:43], v[128:131]
  ds_read_b64_tr_b16 v[94:95], v4 offset:40408
  v_mfma_f32_16x16x32_bf16 v[160:163], v[96:99], v[44:47], v[160:163]
  ds_read_b64_tr_b16 v[96:97], v4 offset:39456
  v_mfma_f32_16x16x32_bf16 v[132:135], v[100:103], v[40:43], v[132:135]
  ds_read_b64_tr_b16 v[98:99], v4 offset:40416
  v_mfma_f32_16x16x32_bf16 v[164:167], v[100:103], v[44:47], v[164:167]
  ds_read_b64_tr_b16 v[100:101], v7 offset:39424
  v_mfma_f32_16x16x32_bf16 v[136:139], v[104:107], v[40:43], v[136:139]
  ds_read_b64_tr_b16 v[102:103], v7 offset:40384
  v_mfma_f32_16x16x32_bf16 v[168:171], v[104:107], v[44:47], v[168:171]
  ds_read_b64_tr_b16 v[104:105], v10 offset:39424
  v_mfma_f32_16x16x32_bf16 v[140:143], v[108:111], v[40:43], v[140:143]
  ds_read_b64_tr_b16 v[106:107], v10 offset:40384
  v_mfma_f32_16x16x32_bf16 v[172:175], v[108:111], v[44:47], v[172:175]
  ds_read_b64_tr_b16 v[108:109], v13 offset:39424
  v_mfma_f32_16x16x32_bf16 v[196:199], v[188:191], v[220:223], v[196:199]
  ds_read_b64_tr_b16 v[110:111], v13 offset:40384
  ds_read_b64_tr_b16 v[188:189], v27 offset:39424
  v_mfma_f32_16x16x32_bf16 v[200:203], v[192:195], v[220:223], v[200:203]
  ds_read_b64_tr_b16 v[190:191], v27 offset:40384
  ds_read_b64_tr_b16 v[192:193], v176 offset:39424
  v_mfma_f32_16x16x32_bf16 v[204:207], v[220:223], v[40:43], v[204:207]
  ds_read_b64_tr_b16 v[194:195], v176 offset:40384
  v_mfma_f32_16x16x32_bf16 v[212:215], v[40:43], v[40:43], v[212:215]
  ds_read_b128 v[40:43], v24 offset:31744
  v_mfma_f32_16x16x32_bf16 v[208:211], v[220:223], v[44:47], v[208:211]
  v_mfma_f32_16x16x32_bf16 v[216:219], v[44:47], v[44:47], v[216:219]
  ds_read_b128 v[44:47], v24 offset:33792
  s_waitcnt lgkmcnt(0)
  s_barrier
  v_mfma_f32_16x16x32_bf16 v[112:115], v[48:51], v[32:35], v[112:115]
  v_mfma_f32_16x16x32_bf16 v[144:147], v[48:51], v[36:39], v[144:147]
  ds_read_b64_tr_b16 v[48:49], v5 offset:0
  v_mfma_f32_16x16x32_bf16 v[116:119], v[52:55], v[32:35], v[116:119]
  ds_read_b64_tr_b16 v[50:51], v5 offset:960
  v_mfma_f32_16x16x32_bf16 v[148:151], v[52:55], v[36:39], v[148:151]
  ds_read_b64_tr_b16 v[52:53], v5 offset:8
  v_mfma_f32_16x16x32_bf16 v[120:123], v[56:59], v[32:35], v[120:123]
  ds_read_b64_tr_b16 v[54:55], v5 offset:968
  v_mfma_f32_16x16x32_bf16 v[152:155], v[56:59], v[36:39], v[152:155]
  ds_read_b64_tr_b16 v[56:57], v5 offset:16
  v_mfma_f32_16x16x32_bf16 v[124:127], v[60:63], v[32:35], v[124:127]
  ds_read_b64_tr_b16 v[58:59], v5 offset:976
  v_mfma_f32_16x16x32_bf16 v[156:159], v[60:63], v[36:39], v[156:159]
  ds_read_b64_tr_b16 v[60:61], v5 offset:24
  v_mfma_f32_16x16x32_bf16 v[128:131], v[64:67], v[32:35], v[128:131]
  ds_read_b64_tr_b16 v[62:63], v5 offset:984
  v_mfma_f32_16x16x32_bf16 v[160:163], v[64:67], v[36:39], v[160:163]
  ds_read_b64_tr_b16 v[64:65], v5 offset:32
  v_mfma_f32_16x16x32_bf16 v[132:135], v[68:71], v[32:35], v[132:135]
  ds_read_b64_tr_b16 v[66:67], v5 offset:992
  v_mfma_f32_16x16x32_bf16 v[164:167], v[68:71], v[36:39], v[164:167]
  ds_read_b64_tr_b16 v[68:69], v8 offset:0
  v_mfma_f32_16x16x32_bf16 v[136:139], v[72:75], v[32:35], v[136:139]
  ds_read_b64_tr_b16 v[70:71], v8 offset:960
  v_mfma_f32_16x16x32_bf16 v[168:171], v[72:75], v[36:39], v[168:171]
  ds_read_b64_tr_b16 v[72:73], v11 offset:0
  v_mfma_f32_16x16x32_bf16 v[140:143], v[76:79], v[32:35], v[140:143]
  ds_read_b64_tr_b16 v[74:75], v11 offset:960
  v_mfma_f32_16x16x32_bf16 v[172:175], v[76:79], v[36:39], v[172:175]
  ds_read_b64_tr_b16 v[76:77], v14 offset:0
  v_mfma_f32_16x16x32_bf16 v[196:199], v[180:183], v[220:223], v[196:199]
  ds_read_b64_tr_b16 v[78:79], v14 offset:960
  ds_read_b64_tr_b16 v[180:181], v28 offset:0
  v_mfma_f32_16x16x32_bf16 v[200:203], v[184:187], v[220:223], v[200:203]
  ds_read_b64_tr_b16 v[182:183], v28 offset:960
  ds_read_b64_tr_b16 v[184:185], v177 offset:0
  v_mfma_f32_16x16x32_bf16 v[204:207], v[220:223], v[32:35], v[204:207]
  ds_read_b64_tr_b16 v[186:187], v177 offset:960
  v_mfma_f32_16x16x32_bf16 v[212:215], v[32:35], v[32:35], v[212:215]
  ds_read_b128 v[32:35], v17 offset:0
  v_mfma_f32_16x16x32_bf16 v[208:211], v[220:223], v[36:39], v[208:211]
  v_mfma_f32_16x16x32_bf16 v[216:219], v[36:39], v[36:39], v[216:219]
  ds_read_b128 v[36:39], v17 offset:2048
  v_mfma_f32_16x16x32_bf16 v[112:115], v[80:83], v[40:43], v[112:115]
  v_mfma_f32_16x16x32_bf16 v[144:147], v[80:83], v[44:47], v[144:147]
  ds_read_b64_tr_b16 v[80:81], v5 offset:7680
  v_mfma_f32_16x16x32_bf16 v[116:119], v[84:87], v[40:43], v[116:119]
  ds_read_b64_tr_b16 v[82:83], v5 offset:8640
  v_mfma_f32_16x16x32_bf16 v[148:151], v[84:87], v[44:47], v[148:151]
  ds_read_b64_tr_b16 v[84:85], v5 offset:7688
  v_mfma_f32_16x16x32_bf16 v[120:123], v[88:91], v[40:43], v[120:123]
  ds_read_b64_tr_b16 v[86:87], v5 offset:8648
  v_mfma_f32_16x16x32_bf16 v[152:155], v[88:91], v[44:47], v[152:155]
  ds_read_b64_tr_b16 v[88:89], v5 offset:7696
  v_mfma_f32_16x16x32_bf16 v[124:127], v[92:95], v[40:43], v[124:127]
  ds_read_b64_tr_b16 v[90:91], v5 offset:8656
  v_mfma_f32_16x16x32_bf16 v[156:159], v[92:95], v[44:47], v[156:159]
  ds_read_b64_tr_b16 v[92:93], v5 offset:7704
  v_mfma_f32_16x16x32_bf16 v[128:131], v[96:99], v[40:43], v[128:131]
  ds_read_b64_tr_b16 v[94:95], v5 offset:8664
  v_mfma_f32_16x16x32_bf16 v[160:163], v[96:99], v[44:47], v[160:163]
  ds_read_b64_tr_b16 v[96:97], v5 offset:7712
  v_mfma_f32_16x16x32_bf16 v[132:135], v[100:103], v[40:43], v[132:135]
  ds_read_b64_tr_b16 v[98:99], v5 offset:8672
  v_mfma_f32_16x16x32_bf16 v[164:167], v[100:103], v[44:47], v[164:167]
  ds_read_b64_tr_b16 v[100:101], v8 offset:7680
  v_mfma_f32_16x16x32_bf16 v[136:139], v[104:107], v[40:43], v[136:139]
  ds_read_b64_tr_b16 v[102:103], v8 offset:8640
  v_mfma_f32_16x16x32_bf16 v[168:171], v[104:107], v[44:47], v[168:171]
  ds_read_b64_tr_b16 v[104:105], v11 offset:7680
  v_mfma_f32_16x16x32_bf16 v[140:143], v[108:111], v[40:43], v[140:143]
  ds_read_b64_tr_b16 v[106:107], v11 offset:8640
  v_mfma_f32_16x16x32_bf16 v[172:175], v[108:111], v[44:47], v[172:175]
  ds_read_b64_tr_b16 v[108:109], v14 offset:7680
  v_mfma_f32_16x16x32_bf16 v[196:199], v[188:191], v[220:223], v[196:199]
  ds_read_b64_tr_b16 v[110:111], v14 offset:8640
  ds_read_b64_tr_b16 v[188:189], v28 offset:7680
  v_mfma_f32_16x16x32_bf16 v[200:203], v[192:195], v[220:223], v[200:203]
  ds_read_b64_tr_b16 v[190:191], v28 offset:8640
  ds_read_b64_tr_b16 v[192:193], v177 offset:7680
  v_mfma_f32_16x16x32_bf16 v[204:207], v[220:223], v[40:43], v[204:207]
  ds_read_b64_tr_b16 v[194:195], v177 offset:8640
  v_mfma_f32_16x16x32_bf16 v[212:215], v[40:43], v[40:43], v[212:215]
  ds_read_b128 v[40:43], v25 offset:0
  v_mfma_f32_16x16x32_bf16 v[208:211], v[220:223], v[44:47], v[208:211]
  v_mfma_f32_16x16x32_bf16 v[216:219], v[44:47], v[44:47], v[216:219]
  ds_read_b128 v[44:47], v25 offset:2048
  s_waitcnt lgkmcnt(0)
  s_barrier
  v_mfma_f32_16x16x32_bf16 v[112:115], v[48:51], v[32:35], v[112:115]
  v_mfma_f32_16x16x32_bf16 v[144:147], v[48:51], v[36:39], v[144:147]
  ds_read_b64_tr_b16 v[48:49], v5 offset:31744
  v_mfma_f32_16x16x32_bf16 v[116:119], v[52:55], v[32:35], v[116:119]
  ds_read_b64_tr_b16 v[50:51], v5 offset:32704
  v_mfma_f32_16x16x32_bf16 v[148:151], v[52:55], v[36:39], v[148:151]
  ds_read_b64_tr_b16 v[52:53], v5 offset:31752
  v_mfma_f32_16x16x32_bf16 v[120:123], v[56:59], v[32:35], v[120:123]
  ds_read_b64_tr_b16 v[54:55], v5 offset:32712
  v_mfma_f32_16x16x32_bf16 v[152:155], v[56:59], v[36:39], v[152:155]
  ds_read_b64_tr_b16 v[56:57], v5 offset:31760
  v_mfma_f32_16x16x32_bf16 v[124:127], v[60:63], v[32:35], v[124:127]
  ds_read_b64_tr_b16 v[58:59], v5 offset:32720
  v_mfma_f32_16x16x32_bf16 v[156:159], v[60:63], v[36:39], v[156:159]
  ds_read_b64_tr_b16 v[60:61], v5 offset:31768
  v_mfma_f32_16x16x32_bf16 v[128:131], v[64:67], v[32:35], v[128:131]
  ds_read_b64_tr_b16 v[62:63], v5 offset:32728
  v_mfma_f32_16x16x32_bf16 v[160:163], v[64:67], v[36:39], v[160:163]
  ds_read_b64_tr_b16 v[64:65], v5 offset:31776
  v_mfma_f32_16x16x32_bf16 v[132:135], v[68:71], v[32:35], v[132:135]
  ds_read_b64_tr_b16 v[66:67], v5 offset:32736
  v_mfma_f32_16x16x32_bf16 v[164:167], v[68:71], v[36:39], v[164:167]
  ds_read_b64_tr_b16 v[68:69], v8 offset:31744
  v_mfma_f32_16x16x32_bf16 v[136:139], v[72:75], v[32:35], v[136:139]
  ds_read_b64_tr_b16 v[70:71], v8 offset:32704
  v_mfma_f32_16x16x32_bf16 v[168:171], v[72:75], v[36:39], v[168:171]
  ds_read_b64_tr_b16 v[72:73], v11 offset:31744
  v_mfma_f32_16x16x32_bf16 v[140:143], v[76:79], v[32:35], v[140:143]
  ds_read_b64_tr_b16 v[74:75], v11 offset:32704
  v_mfma_f32_16x16x32_bf16 v[172:175], v[76:79], v[36:39], v[172:175]
  ds_read_b64_tr_b16 v[76:77], v14 offset:31744
  v_mfma_f32_16x16x32_bf16 v[196:199], v[180:183], v[220:223], v[196:199]
  ds_read_b64_tr_b16 v[78:79], v14 offset:32704
  ds_read_b64_tr_b16 v[180:181], v28 offset:31744
  v_mfma_f32_16x16x32_bf16 v[200:203], v[184:187], v[220:223], v[200:203]
  ds_read_b64_tr_b16 v[182:183], v28 offset:32704
  ds_read_b64_tr_b16 v[184:185], v177 offset:31744
  v_mfma_f32_16x16x32_bf16 v[204:207], v[220:223], v[32:35], v[204:207]
  ds_read_b64_tr_b16 v[186:187], v177 offset:32704
  v_mfma_f32_16x16x32_bf16 v[212:215], v[32:35], v[32:35], v[212:215]
  ds_read_b128 v[32:35], v17 offset:31744
  v_mfma_f32_16x16x32_bf16 v[208:211], v[220:223], v[36:39], v[208:211]
  v_mfma_f32_16x16x32_bf16 v[216:219], v[36:39], v[36:39], v[216:219]
  ds_read_b128 v[36:39], v17 offset:33792
  v_mfma_f32_16x16x32_bf16 v[112:115], v[80:83], v[40:43], v[112:115]
  v_mfma_f32_16x16x32_bf16 v[144:147], v[80:83], v[44:47], v[144:147]
  ds_read_b64_tr_b16 v[80:81], v5 offset:39424
  v_mfma_f32_16x16x32_bf16 v[116:119], v[84:87], v[40:43], v[116:119]
  ds_read_b64_tr_b16 v[82:83], v5 offset:40384
  v_mfma_f32_16x16x32_bf16 v[148:151], v[84:87], v[44:47], v[148:151]
  ds_read_b64_tr_b16 v[84:85], v5 offset:39432
  v_mfma_f32_16x16x32_bf16 v[120:123], v[88:91], v[40:43], v[120:123]
  ds_read_b64_tr_b16 v[86:87], v5 offset:40392
  v_mfma_f32_16x16x32_bf16 v[152:155], v[88:91], v[44:47], v[152:155]
  ds_read_b64_tr_b16 v[88:89], v5 offset:39440
  v_mfma_f32_16x16x32_bf16 v[124:127], v[92:95], v[40:43], v[124:127]
  ds_read_b64_tr_b16 v[90:91], v5 offset:40400
  v_mfma_f32_16x16x32_bf16 v[156:159], v[92:95], v[44:47], v[156:159]
  ds_read_b64_tr_b16 v[92:93], v5 offset:39448
  v_mfma_f32_16x16x32_bf16 v[128:131], v[96:99], v[40:43], v[128:131]
  ds_read_b64_tr_b16 v[94:95], v5 offset:40408
  v_mfma_f32_16x16x32_bf16 v[160:163], v[96:99], v[44:47], v[160:163]
  ds_read_b64_tr_b16 v[96:97], v5 offset:39456
  v_mfma_f32_16x16x32_bf16 v[132:135], v[100:103], v[40:43], v[132:135]
  ds_read_b64_tr_b16 v[98:99], v5 offset:40416
  v_mfma_f32_16x16x32_bf16 v[164:167], v[100:103], v[44:47], v[164:167]
  ds_read_b64_tr_b16 v[100:101], v8 offset:39424
  v_mfma_f32_16x16x32_bf16 v[136:139], v[104:107], v[40:43], v[136:139]
  ds_read_b64_tr_b16 v[102:103], v8 offset:40384
  v_mfma_f32_16x16x32_bf16 v[168:171], v[104:107], v[44:47], v[168:171]
  ds_read_b64_tr_b16 v[104:105], v11 offset:39424
  v_mfma_f32_16x16x32_bf16 v[140:143], v[108:111], v[40:43], v[140:143]
  ds_read_b64_tr_b16 v[106:107], v11 offset:40384
  v_mfma_f32_16x16x32_bf16 v[172:175], v[108:111], v[44:47], v[172:175]
  ds_read_b64_tr_b16 v[108:109], v14 offset:39424
  v_mfma_f32_16x16x32_bf16 v[196:199], v[188:191], v[220:223], v[196:199]
  ds_read_b64_tr_b16 v[110:111], v14 offset:40384
  ds_read_b64_tr_b16 v[188:189], v28 offset:39424
  v_mfma_f32_16x16x32_bf16 v[200:203], v[192:195], v[220:223], v[200:203]
  ds_read_b64_tr_b16 v[190:191], v28 offset:40384
  ds_read_b64_tr_b16 v[192:193], v177 offset:39424
  v_mfma_f32_16x16x32_bf16 v[204:207], v[220:223], v[40:43], v[204:207]
  ds_read_b64_tr_b16 v[194:195], v177 offset:40384
  v_mfma_f32_16x16x32_bf16 v[212:215], v[40:43], v[40:43], v[212:215]
  ds_read_b128 v[40:43], v25 offset:31744
  v_mfma_f32_16x16x32_bf16 v[208:211], v[220:223], v[44:47], v[208:211]
  v_mfma_f32_16x16x32_bf16 v[216:219], v[44:47], v[44:47], v[216:219]
  ds_read_b128 v[44:47], v25 offset:33792
  s_waitcnt lgkmcnt(0)
  s_barrier
  v_mfma_f32_16x16x32_bf16 v[112:115], v[48:51], v[32:35], v[112:115]
  v_mfma_f32_16x16x32_bf16 v[144:147], v[48:51], v[36:39], v[144:147]
  ds_read_b64_tr_b16 v[48:49], v6 offset:0
  v_mfma_f32_16x16x32_bf16 v[116:119], v[52:55], v[32:35], v[116:119]
  ds_read_b64_tr_b16 v[50:51], v6 offset:960
  v_mfma_f32_16x16x32_bf16 v[148:151], v[52:55], v[36:39], v[148:151]
  ds_read_b64_tr_b16 v[52:53], v6 offset:8
  v_mfma_f32_16x16x32_bf16 v[120:123], v[56:59], v[32:35], v[120:123]
  ds_read_b64_tr_b16 v[54:55], v6 offset:968
  v_mfma_f32_16x16x32_bf16 v[152:155], v[56:59], v[36:39], v[152:155]
  ds_read_b64_tr_b16 v[56:57], v6 offset:16
  v_mfma_f32_16x16x32_bf16 v[124:127], v[60:63], v[32:35], v[124:127]
  ds_read_b64_tr_b16 v[58:59], v6 offset:976
  v_mfma_f32_16x16x32_bf16 v[156:159], v[60:63], v[36:39], v[156:159]
  ds_read_b64_tr_b16 v[60:61], v6 offset:24
  v_mfma_f32_16x16x32_bf16 v[128:131], v[64:67], v[32:35], v[128:131]
  ds_read_b64_tr_b16 v[62:63], v6 offset:984
  v_mfma_f32_16x16x32_bf16 v[160:163], v[64:67], v[36:39], v[160:163]
  ds_read_b64_tr_b16 v[64:65], v6 offset:32
  v_mfma_f32_16x16x32_bf16 v[132:135], v[68:71], v[32:35], v[132:135]
  ds_read_b64_tr_b16 v[66:67], v6 offset:992
  v_mfma_f32_16x16x32_bf16 v[164:167], v[68:71], v[36:39], v[164:167]
  ds_read_b64_tr_b16 v[68:69], v9 offset:0
  v_mfma_f32_16x16x32_bf16 v[136:139], v[72:75], v[32:35], v[136:139]
  ds_read_b64_tr_b16 v[70:71], v9 offset:960
  v_mfma_f32_16x16x32_bf16 v[168:171], v[72:75], v[36:39], v[168:171]
  ds_read_b64_tr_b16 v[72:73], v12 offset:0
  v_mfma_f32_16x16x32_bf16 v[140:143], v[76:79], v[32:35], v[140:143]
  ds_read_b64_tr_b16 v[74:75], v12 offset:960
  v_mfma_f32_16x16x32_bf16 v[172:175], v[76:79], v[36:39], v[172:175]
  ds_read_b64_tr_b16 v[76:77], v15 offset:0
  v_mfma_f32_16x16x32_bf16 v[196:199], v[180:183], v[220:223], v[196:199]
  ds_read_b64_tr_b16 v[78:79], v15 offset:960
  ds_read_b64_tr_b16 v[180:181], v29 offset:0
  v_mfma_f32_16x16x32_bf16 v[200:203], v[184:187], v[220:223], v[200:203]
  ds_read_b64_tr_b16 v[182:183], v29 offset:960
  ds_read_b64_tr_b16 v[184:185], v178 offset:0
  v_mfma_f32_16x16x32_bf16 v[204:207], v[220:223], v[32:35], v[204:207]
  ds_read_b64_tr_b16 v[186:187], v178 offset:960
  v_mfma_f32_16x16x32_bf16 v[212:215], v[32:35], v[32:35], v[212:215]
  ds_read_b128 v[32:35], v18 offset:0
  v_mfma_f32_16x16x32_bf16 v[208:211], v[220:223], v[36:39], v[208:211]
  v_mfma_f32_16x16x32_bf16 v[216:219], v[36:39], v[36:39], v[216:219]
  ds_read_b128 v[36:39], v18 offset:2048
  v_mfma_f32_16x16x32_bf16 v[112:115], v[80:83], v[40:43], v[112:115]
  v_mfma_f32_16x16x32_bf16 v[144:147], v[80:83], v[44:47], v[144:147]
  ds_read_b64_tr_b16 v[80:81], v6 offset:7680
  v_mfma_f32_16x16x32_bf16 v[116:119], v[84:87], v[40:43], v[116:119]
  ds_read_b64_tr_b16 v[82:83], v6 offset:8640
  v_mfma_f32_16x16x32_bf16 v[148:151], v[84:87], v[44:47], v[148:151]
  ds_read_b64_tr_b16 v[84:85], v6 offset:7688
  v_mfma_f32_16x16x32_bf16 v[120:123], v[88:91], v[40:43], v[120:123]
  ds_read_b64_tr_b16 v[86:87], v6 offset:8648
  v_mfma_f32_16x16x32_bf16 v[152:155], v[88:91], v[44:47], v[152:155]
  ds_read_b64_tr_b16 v[88:89], v6 offset:7696
  v_mfma_f32_16x16x32_bf16 v[124:127], v[92:95], v[40:43], v[124:127]
  ds_read_b64_tr_b16 v[90:91], v6 offset:8656
  v_mfma_f32_16x16x32_bf16 v[156:159], v[92:95], v[44:47], v[156:159]
  ds_read_b64_tr_b16 v[92:93], v6 offset:7704
  v_mfma_f32_16x16x32_bf16 v[128:131], v[96:99], v[40:43], v[128:131]
  ds_read_b64_tr_b16 v[94:95], v6 offset:8664
  v_mfma_f32_16x16x32_bf16 v[160:163], v[96:99], v[44:47], v[160:163]
  ds_read_b64_tr_b16 v[96:97], v6 offset:7712
  v_mfma_f32_16x16x32_bf16 v[132:135], v[100:103], v[40:43], v[132:135]
  ds_read_b64_tr_b16 v[98:99], v6 offset:8672
  v_mfma_f32_16x16x32_bf16 v[164:167], v[100:103], v[44:47], v[164:167]
  ds_read_b64_tr_b16 v[100:101], v9 offset:7680
  v_mfma_f32_16x16x32_bf16 v[136:139], v[104:107], v[40:43], v[136:139]
  ds_read_b64_tr_b16 v[102:103], v9 offset:8640
  v_mfma_f32_16x16x32_bf16 v[168:171], v[104:107], v[44:47], v[168:171]
  ds_read_b64_tr_b16 v[104:105], v12 offset:7680
  v_mfma_f32_16x16x32_bf16 v[140:143], v[108:111], v[40:43], v[140:143]
  ds_read_b64_tr_b16 v[106:107], v12 offset:8640
  v_mfma_f32_16x16x32_bf16 v[172:175], v[108:111], v[44:47], v[172:175]
  ds_read_b64_tr_b16 v[108:109], v15 offset:7680
  v_mfma_f32_16x16x32_bf16 v[196:199], v[188:191], v[220:223], v[196:199]
  ds_read_b64_tr_b16 v[110:111], v15 offset:8640
  ds_read_b64_tr_b16 v[188:189], v29 offset:7680
  v_mfma_f32_16x16x32_bf16 v[200:203], v[192:195], v[220:223], v[200:203]
  ds_read_b64_tr_b16 v[190:191], v29 offset:8640
  ds_read_b64_tr_b16 v[192:193], v178 offset:7680
  v_mfma_f32_16x16x32_bf16 v[204:207], v[220:223], v[40:43], v[204:207]
  ds_read_b64_tr_b16 v[194:195], v178 offset:8640
  v_mfma_f32_16x16x32_bf16 v[212:215], v[40:43], v[40:43], v[212:215]
  ds_read_b128 v[40:43], v26 offset:0
  v_mfma_f32_16x16x32_bf16 v[208:211], v[220:223], v[44:47], v[208:211]
  v_mfma_f32_16x16x32_bf16 v[216:219], v[44:47], v[44:47], v[216:219]
  ds_read_b128 v[44:47], v26 offset:2048
  s_waitcnt lgkmcnt(0)
  s_barrier
  v_mfma_f32_16x16x32_bf16 v[112:115], v[48:51], v[32:35], v[112:115]
  v_mfma_f32_16x16x32_bf16 v[144:147], v[48:51], v[36:39], v[144:147]
  ds_read_b64_tr_b16 v[48:49], v4 offset:0
  v_mfma_f32_16x16x32_bf16 v[116:119], v[52:55], v[32:35], v[116:119]
  ds_read_b64_tr_b16 v[50:51], v4 offset:960
  v_mfma_f32_16x16x32_bf16 v[148:151], v[52:55], v[36:39], v[148:151]
  ds_read_b64_tr_b16 v[52:53], v4 offset:8
  v_mfma_f32_16x16x32_bf16 v[120:123], v[56:59], v[32:35], v[120:123]
  ds_read_b64_tr_b16 v[54:55], v4 offset:968
  v_mfma_f32_16x16x32_bf16 v[152:155], v[56:59], v[36:39], v[152:155]
  ds_read_b64_tr_b16 v[56:57], v4 offset:16
  v_mfma_f32_16x16x32_bf16 v[124:127], v[60:63], v[32:35], v[124:127]
  ds_read_b64_tr_b16 v[58:59], v4 offset:976
  v_mfma_f32_16x16x32_bf16 v[156:159], v[60:63], v[36:39], v[156:159]
  ds_read_b64_tr_b16 v[60:61], v4 offset:24
  v_mfma_f32_16x16x32_bf16 v[128:131], v[64:67], v[32:35], v[128:131]
  ds_read_b64_tr_b16 v[62:63], v4 offset:984
  v_mfma_f32_16x16x32_bf16 v[160:163], v[64:67], v[36:39], v[160:163]
  ds_read_b64_tr_b16 v[64:65], v4 offset:32
  v_mfma_f32_16x16x32_bf16 v[132:135], v[68:71], v[32:35], v[132:135]
  ds_read_b64_tr_b16 v[66:67], v4 offset:992
  v_mfma_f32_16x16x32_bf16 v[164:167], v[68:71], v[36:39], v[164:167]
  ds_read_b64_tr_b16 v[68:69], v7 offset:0
  v_mfma_f32_16x16x32_bf16 v[136:139], v[72:75], v[32:35], v[136:139]
  ds_read_b64_tr_b16 v[70:71], v7 offset:960
  v_mfma_f32_16x16x32_bf16 v[168:171], v[72:75], v[36:39], v[168:171]
  ds_read_b64_tr_b16 v[72:73], v10 offset:0
  v_mfma_f32_16x16x32_bf16 v[140:143], v[76:79], v[32:35], v[140:143]
  ds_read_b64_tr_b16 v[74:75], v10 offset:960
  v_mfma_f32_16x16x32_bf16 v[172:175], v[76:79], v[36:39], v[172:175]
  ds_read_b64_tr_b16 v[76:77], v13 offset:0
  v_mfma_f32_16x16x32_bf16 v[196:199], v[180:183], v[220:223], v[196:199]
  ds_read_b64_tr_b16 v[78:79], v13 offset:960
  ds_read_b64_tr_b16 v[180:181], v27 offset:0
  v_mfma_f32_16x16x32_bf16 v[200:203], v[184:187], v[220:223], v[200:203]
  ds_read_b64_tr_b16 v[182:183], v27 offset:960
  ds_read_b64_tr_b16 v[184:185], v176 offset:0
  v_mfma_f32_16x16x32_bf16 v[204:207], v[220:223], v[32:35], v[204:207]
  ds_read_b64_tr_b16 v[186:187], v176 offset:960
  v_mfma_f32_16x16x32_bf16 v[212:215], v[32:35], v[32:35], v[212:215]
  ds_read_b128 v[32:35], v16 offset:0
  v_mfma_f32_16x16x32_bf16 v[208:211], v[220:223], v[36:39], v[208:211]
  v_mfma_f32_16x16x32_bf16 v[216:219], v[36:39], v[36:39], v[216:219]
  ds_read_b128 v[36:39], v16 offset:2048
  v_mfma_f32_16x16x32_bf16 v[112:115], v[80:83], v[40:43], v[112:115]
  v_mfma_f32_16x16x32_bf16 v[144:147], v[80:83], v[44:47], v[144:147]
  ds_read_b64_tr_b16 v[80:81], v4 offset:7680
  v_mfma_f32_16x16x32_bf16 v[116:119], v[84:87], v[40:43], v[116:119]
  ds_read_b64_tr_b16 v[82:83], v4 offset:8640
  v_mfma_f32_16x16x32_bf16 v[148:151], v[84:87], v[44:47], v[148:151]
  ds_read_b64_tr_b16 v[84:85], v4 offset:7688
  v_mfma_f32_16x16x32_bf16 v[120:123], v[88:91], v[40:43], v[120:123]
  ds_read_b64_tr_b16 v[86:87], v4 offset:8648
  v_mfma_f32_16x16x32_bf16 v[152:155], v[88:91], v[44:47], v[152:155]
  ds_read_b64_tr_b16 v[88:89], v4 offset:7696
  v_mfma_f32_16x16x32_bf16 v[124:127], v[92:95], v[40:43], v[124:127]
  ds_read_b64_tr_b16 v[90:91], v4 offset:8656
  v_mfma_f32_16x16x32_bf16 v[156:159], v[92:95], v[44:47], v[156:159]
  ds_read_b64_tr_b16 v[92:93], v4 offset:7704
  v_mfma_f32_16x16x32_bf16 v[128:131], v[96:99], v[40:43], v[128:131]
  ds_read_b64_tr_b16 v[94:95], v4 offset:8664
  v_mfma_f32_16x16x32_bf16 v[160:163], v[96:99], v[44:47], v[160:163]
  ds_read_b64_tr_b16 v[96:97], v4 offset:7712
  v_mfma_f32_16x16x32_bf16 v[132:135], v[100:103], v[40:43], v[132:135]
  ds_read_b64_tr_b16 v[98:99], v4 offset:8672
  v_mfma_f32_16x16x32_bf16 v[164:167], v[100:103], v[44:47], v[164:167]
  ds_read_b64_tr_b16 v[100:101], v7 offset:7680
  v_mfma_f32_16x16x32_bf16 v[136:139], v[104:107], v[40:43], v[136:139]
  ds_read_b64_tr_b16 v[102:103], v7 offset:8640
  v_mfma_f32_16x16x32_bf16 v[168:171], v[104:107], v[44:47], v[168:171]
  ds_read_b64_tr_b16 v[104:105], v10 offset:7680
  v_mfma_f32_16x16x32_bf16 v[140:143], v[108:111], v[40:43], v[140:143]
  ds_read_b64_tr_b16 v[106:107], v10 offset:8640
  v_mfma_f32_16x16x32_bf16 v[172:175], v[108:111], v[44:47], v[172:175]
  ds_read_b64_tr_b16 v[108:109], v13 offset:7680
  v_mfma_f32_16x16x32_bf16 v[196:199], v[188:191], v[220:223], v[196:199]
  ds_read_b64_tr_b16 v[110:111], v13 offset:8640
  ds_read_b64_tr_b16 v[188:189], v27 offset:7680
  v_mfma_f32_16x16x32_bf16 v[200:203], v[192:195], v[220:223], v[200:203]
  ds_read_b64_tr_b16 v[190:191], v27 offset:8640
  ds_read_b64_tr_b16 v[192:193], v176 offset:7680
  v_mfma_f32_16x16x32_bf16 v[204:207], v[220:223], v[40:43], v[204:207]
  ds_read_b64_tr_b16 v[194:195], v176 offset:8640
  v_mfma_f32_16x16x32_bf16 v[212:215], v[40:43], v[40:43], v[212:215]
  ds_read_b128 v[40:43], v24 offset:0
  v_mfma_f32_16x16x32_bf16 v[208:211], v[220:223], v[44:47], v[208:211]
  v_mfma_f32_16x16x32_bf16 v[216:219], v[44:47], v[44:47], v[216:219]
  ds_read_b128 v[44:47], v24 offset:2048
  s_waitcnt lgkmcnt(0)
  s_barrier
  v_mfma_f32_16x16x32_bf16 v[112:115], v[48:51], v[32:35], v[112:115]
  v_mfma_f32_16x16x32_bf16 v[144:147], v[48:51], v[36:39], v[144:147]
  ds_read_b64_tr_b16 v[48:49], v4 offset:31744
  v_mfma_f32_16x16x32_bf16 v[116:119], v[52:55], v[32:35], v[116:119]
  ds_read_b64_tr_b16 v[50:51], v4 offset:32704
  v_mfma_f32_16x16x32_bf16 v[148:151], v[52:55], v[36:39], v[148:151]
  ds_read_b64_tr_b16 v[52:53], v4 offset:31752
  v_mfma_f32_16x16x32_bf16 v[120:123], v[56:59], v[32:35], v[120:123]
  ds_read_b64_tr_b16 v[54:55], v4 offset:32712
  v_mfma_f32_16x16x32_bf16 v[152:155], v[56:59], v[36:39], v[152:155]
  ds_read_b64_tr_b16 v[56:57], v4 offset:31760
  v_mfma_f32_16x16x32_bf16 v[124:127], v[60:63], v[32:35], v[124:127]
  ds_read_b64_tr_b16 v[58:59], v4 offset:32720
  v_mfma_f32_16x16x32_bf16 v[156:159], v[60:63], v[36:39], v[156:159]
  ds_read_b64_tr_b16 v[60:61], v4 offset:31768
  v_mfma_f32_16x16x32_bf16 v[128:131], v[64:67], v[32:35], v[128:131]
  ds_read_b64_tr_b16 v[62:63], v4 offset:32728
  v_mfma_f32_16x16x32_bf16 v[160:163], v[64:67], v[36:39], v[160:163]
  ds_read_b64_tr_b16 v[64:65], v4 offset:31776
  v_mfma_f32_16x16x32_bf16 v[132:135], v[68:71], v[32:35], v[132:135]
  ds_read_b64_tr_b16 v[66:67], v4 offset:32736
  v_mfma_f32_16x16x32_bf16 v[164:167], v[68:71], v[36:39], v[164:167]
  ds_read_b64_tr_b16 v[68:69], v7 offset:31744
  v_mfma_f32_16x16x32_bf16 v[136:139], v[72:75], v[32:35], v[136:139]
  ds_read_b64_tr_b16 v[70:71], v7 offset:32704
  v_mfma_f32_16x16x32_bf16 v[168:171], v[72:75], v[36:39], v[168:171]
  ds_read_b64_tr_b16 v[72:73], v10 offset:31744
  v_mfma_f32_16x16x32_bf16 v[140:143], v[76:79], v[32:35], v[140:143]
  ds_read_b64_tr_b16 v[74:75], v10 offset:32704
  v_mfma_f32_16x16x32_bf16 v[172:175], v[76:79], v[36:39], v[172:175]
  ds_read_b64_tr_b16 v[76:77], v13 offset:31744
  v_mfma_f32_16x16x32_bf16 v[196:199], v[180:183], v[220:223], v[196:199]
  ds_read_b64_tr_b16 v[78:79], v13 offset:32704
  ds_read_b64_tr_b16 v[180:181], v27 offset:31744
  v_mfma_f32_16x16x32_bf16 v[200:203], v[184:187], v[220:223], v[200:203]
  ds_read_b64_tr_b16 v[182:183], v27 offset:32704
  ds_read_b64_tr_b16 v[184:185], v176 offset:31744
  v_mfma_f32_16x16x32_bf16 v[204:207], v[220:223], v[32:35], v[204:207]
  ds_read_b64_tr_b16 v[186:187], v176 offset:32704
  v_mfma_f32_16x16x32_bf16 v[212:215], v[32:35], v[32:35], v[212:215]
  ds_read_b128 v[32:35], v16 offset:31744
  v_mfma_f32_16x16x32_bf16 v[208:211], v[220:223], v[36:39], v[208:211]
  v_mfma_f32_16x16x32_bf16 v[216:219], v[36:39], v[36:39], v[216:219]
  ds_read_b128 v[36:39], v16 offset:33792
  v_mfma_f32_16x16x32_bf16 v[112:115], v[80:83], v[40:43], v[112:115]
  v_mfma_f32_16x16x32_bf16 v[144:147], v[80:83], v[44:47], v[144:147]
  ds_read_b64_tr_b16 v[80:81], v4 offset:39424
  v_mfma_f32_16x16x32_bf16 v[116:119], v[84:87], v[40:43], v[116:119]
  ds_read_b64_tr_b16 v[82:83], v4 offset:40384
  v_mfma_f32_16x16x32_bf16 v[148:151], v[84:87], v[44:47], v[148:151]
  ds_read_b64_tr_b16 v[84:85], v4 offset:39432
  v_mfma_f32_16x16x32_bf16 v[120:123], v[88:91], v[40:43], v[120:123]
  ds_read_b64_tr_b16 v[86:87], v4 offset:40392
  v_mfma_f32_16x16x32_bf16 v[152:155], v[88:91], v[44:47], v[152:155]
  ds_read_b64_tr_b16 v[88:89], v4 offset:39440
  v_mfma_f32_16x16x32_bf16 v[124:127], v[92:95], v[40:43], v[124:127]
  ds_read_b64_tr_b16 v[90:91], v4 offset:40400
  v_mfma_f32_16x16x32_bf16 v[156:159], v[92:95], v[44:47], v[156:159]
  ds_read_b64_tr_b16 v[92:93], v4 offset:39448
  v_mfma_f32_16x16x32_bf16 v[128:131], v[96:99], v[40:43], v[128:131]
  ds_read_b64_tr_b16 v[94:95], v4 offset:40408
  v_mfma_f32_16x16x32_bf16 v[160:163], v[96:99], v[44:47], v[160:163]
  ds_read_b64_tr_b16 v[96:97], v4 offset:39456
  v_mfma_f32_16x16x32_bf16 v[132:135], v[100:103], v[40:43], v[132:135]
  ds_read_b64_tr_b16 v[98:99], v4 offset:40416
  v_mfma_f32_16x16x32_bf16 v[164:167], v[100:103], v[44:47], v[164:167]
  ds_read_b64_tr_b16 v[100:101], v7 offset:39424
  v_mfma_f32_16x16x32_bf16 v[136:139], v[104:107], v[40:43], v[136:139]
  ds_read_b64_tr_b16 v[102:103], v7 offset:40384
  v_mfma_f32_16x16x32_bf16 v[168:171], v[104:107], v[44:47], v[168:171]
  ds_read_b64_tr_b16 v[104:105], v10 offset:39424
  v_mfma_f32_16x16x32_bf16 v[140:143], v[108:111], v[40:43], v[140:143]
  ds_read_b64_tr_b16 v[106:107], v10 offset:40384
  v_mfma_f32_16x16x32_bf16 v[172:175], v[108:111], v[44:47], v[172:175]
  ds_read_b64_tr_b16 v[108:109], v13 offset:39424
  v_mfma_f32_16x16x32_bf16 v[196:199], v[188:191], v[220:223], v[196:199]
  ds_read_b64_tr_b16 v[110:111], v13 offset:40384
  ds_read_b64_tr_b16 v[188:189], v27 offset:39424
  v_mfma_f32_16x16x32_bf16 v[200:203], v[192:195], v[220:223], v[200:203]
  ds_read_b64_tr_b16 v[190:191], v27 offset:40384
  ds_read_b64_tr_b16 v[192:193], v176 offset:39424
  v_mfma_f32_16x16x32_bf16 v[204:207], v[220:223], v[40:43], v[204:207]
  ds_read_b64_tr_b16 v[194:195], v176 offset:40384
  v_mfma_f32_16x16x32_bf16 v[212:215], v[40:43], v[40:43], v[212:215]
  ds_read_b128 v[40:43], v24 offset:31744
  v_mfma_f32_16x16x32_bf16 v[208:211], v[220:223], v[44:47], v[208:211]
  v_mfma_f32_16x16x32_bf16 v[216:219], v[44:47], v[44:47], v[216:219]
  ds_read_b128 v[44:47], v24 offset:33792
  s_waitcnt lgkmcnt(0)
  s_barrier
  v_mov_b32 v253, 0
  global_load_dword v253, v253, s[98:99] sc1
  v_mfma_f32_16x16x32_bf16 v[112:115], v[48:51], v[32:35], v[112:115]
  v_mfma_f32_16x16x32_bf16 v[144:147], v[48:51], v[36:39], v[144:147]
  ds_read_b64_tr_b16 v[48:49], v5 offset:0
  v_mfma_f32_16x16x32_bf16 v[116:119], v[52:55], v[32:35], v[116:119]
  ds_read_b64_tr_b16 v[50:51], v5 offset:960
  v_mfma_f32_16x16x32_bf16 v[148:151], v[52:55], v[36:39], v[148:151]
  ds_read_b64_tr_b16 v[52:53], v5 offset:8
  v_mfma_f32_16x16x32_bf16 v[120:123], v[56:59], v[32:35], v[120:123]
  ds_read_b64_tr_b16 v[54:55], v5 offset:968
  v_mfma_f32_16x16x32_bf16 v[152:155], v[56:59], v[36:39], v[152:155]
  ds_read_b64_tr_b16 v[56:57], v5 offset:16
  v_mfma_f32_16x16x32_bf16 v[124:127], v[60:63], v[32:35], v[124:127]
  ds_read_b64_tr_b16 v[58:59], v5 offset:976
  v_mfma_f32_16x16x32_bf16 v[156:159], v[60:63], v[36:39], v[156:159]
  ds_read_b64_tr_b16 v[60:61], v5 offset:24
  v_mfma_f32_16x16x32_bf16 v[128:131], v[64:67], v[32:35], v[128:131]
  ds_read_b64_tr_b16 v[62:63], v5 offset:984
  v_mfma_f32_16x16x32_bf16 v[160:163], v[64:67], v[36:39], v[160:163]
  ds_read_b64_tr_b16 v[64:65], v5 offset:32
  v_mfma_f32_16x16x32_bf16 v[132:135], v[68:71], v[32:35], v[132:135]
  ds_read_b64_tr_b16 v[66:67], v5 offset:992
  v_mfma_f32_16x16x32_bf16 v[164:167], v[68:71], v[36:39], v[164:167]
  ds_read_b64_tr_b16 v[68:69], v8 offset:0
  v_mfma_f32_16x16x32_bf16 v[136:139], v[72:75], v[32:35], v[136:139]
  ds_read_b64_tr_b16 v[70:71], v8 offset:960
  v_mfma_f32_16x16x32_bf16 v[168:171], v[72:75], v[36:39], v[168:171]
  ds_read_b64_tr_b16 v[72:73], v11 offset:0
  v_mfma_f32_16x16x32_bf16 v[140:143], v[76:79], v[32:35], v[140:143]
  ds_read_b64_tr_b16 v[74:75], v11 offset:960
  v_mfma_f32_16x16x32_bf16 v[172:175], v[76:79], v[36:39], v[172:175]
  ds_read_b64_tr_b16 v[76:77], v14 offset:0
  v_mfma_f32_16x16x32_bf16 v[196:199], v[180:183], v[220:223], v[196:199]
  ds_read_b64_tr_b16 v[78:79], v14 offset:960
  ds_read_b64_tr_b16 v[180:181], v28 offset:0
  v_mfma_f32_16x16x32_bf16 v[200:203], v[184:187], v[220:223], v[200:203]
  ds_read_b64_tr_b16 v[182:183], v28 offset:960
  ds_read_b64_tr_b16 v[184:185], v177 offset:0
  v_mfma_f32_16x16x32_bf16 v[204:207], v[220:223], v[32:35], v[204:207]
  ds_read_b64_tr_b16 v[186:187], v177 offset:960
  v_mfma_f32_16x16x32_bf16 v[212:215], v[32:35], v[32:35], v[212:215]
  ds_read_b128 v[32:35], v17 offset:0
  v_mfma_f32_16x16x32_bf16 v[208:211], v[220:223], v[36:39], v[208:211]
  v_mfma_f32_16x16x32_bf16 v[216:219], v[36:39], v[36:39], v[216:219]
  ds_read_b128 v[36:39], v17 offset:2048
  v_mfma_f32_16x16x32_bf16 v[112:115], v[80:83], v[40:43], v[112:115]
  v_mfma_f32_16x16x32_bf16 v[144:147], v[80:83], v[44:47], v[144:147]
  ds_read_b64_tr_b16 v[80:81], v5 offset:7680
  v_mfma_f32_16x16x32_bf16 v[116:119], v[84:87], v[40:43], v[116:119]
  ds_read_b64_tr_b16 v[82:83], v5 offset:8640
  v_mfma_f32_16x16x32_bf16 v[148:151], v[84:87], v[44:47], v[148:151]
  ds_read_b64_tr_b16 v[84:85], v5 offset:7688
  v_mfma_f32_16x16x32_bf16 v[120:123], v[88:91], v[40:43], v[120:123]
  ds_read_b64_tr_b16 v[86:87], v5 offset:8648
  v_mfma_f32_16x16x32_bf16 v[152:155], v[88:91], v[44:47], v[152:155]
  ds_read_b64_tr_b16 v[88:89], v5 offset:7696
  v_mfma_f32_16x16x32_bf16 v[124:127], v[92:95], v[40:43], v[124:127]
  ds_read_b64_tr_b16 v[90:91], v5 offset:8656
  v_mfma_f32_16x16x32_bf16 v[156:159], v[92:95], v[44:47], v[156:159]
  ds_read_b64_tr_b16 v[92:93], v5 offset:7704
  v_mfma_f32_16x16x32_bf16 v[128:131], v[96:99], v[40:43], v[128:131]
  ds_read_b64_tr_b16 v[94:95], v5 offset:8664
  v_mfma_f32_16x16x32_bf16 v[160:163], v[96:99], v[44:47], v[160:163]
  ds_read_b64_tr_b16 v[96:97], v5 offset:7712
  v_mfma_f32_16x16x32_bf16 v[132:135], v[100:103], v[40:43], v[132:135]
  ds_read_b64_tr_b16 v[98:99], v5 offset:8672
  v_mfma_f32_16x16x32_bf16 v[164:167], v[100:103], v[44:47], v[164:167]
  ds_read_b64_tr_b16 v[100:101], v8 offset:7680
  v_mfma_f32_16x16x32_bf16 v[136:139], v[104:107], v[40:43], v[136:139]
  ds_read_b64_tr_b16 v[102:103], v8 offset:8640
  v_mfma_f32_16x16x32_bf16 v[168:171], v[104:107], v[44:47], v[168:171]
  ds_read_b64_tr_b16 v[104:105], v11 offset:7680
  v_mfma_f32_16x16x32_bf16 v[140:143], v[108:111], v[40:43], v[140:143]
  ds_read_b64_tr_b16 v[106:107], v11 offset:8640
  v_mfma_f32_16x16x32_bf16 v[172:175], v[108:111], v[44:47], v[172:175]
  ds_read_b64_tr_b16 v[108:109], v14 offset:7680
  v_mfma_f32_16x16x32_bf16 v[196:199], v[188:191], v[220:223], v[196:199]
  ds_read_b64_tr_b16 v[110:111], v14 offset:8640
  ds_read_b64_tr_b16 v[188:189], v28 offset:7680
  v_mfma_f32_16x16x32_bf16 v[200:203], v[192:195], v[220:223], v[200:203]
  ds_read_b64_tr_b16 v[190:191], v28 offset:8640
  ds_read_b64_tr_b16 v[192:193], v177 offset:7680
  v_mfma_f32_16x16x32_bf16 v[204:207], v[220:223], v[40:43], v[204:207]
  ds_read_b64_tr_b16 v[194:195], v177 offset:8640
  v_mfma_f32_16x16x32_bf16 v[212:215], v[40:43], v[40:43], v[212:215]
  ds_read_b128 v[40:43], v25 offset:0
  v_mfma_f32_16x16x32_bf16 v[208:211], v[220:223], v[44:47], v[208:211]
  v_mfma_f32_16x16x32_bf16 v[216:219], v[44:47], v[44:47], v[216:219]
  ds_read_b128 v[44:47], v25 offset:2048
  s_waitcnt lgkmcnt(0)
  s_barrier
  v_mfma_f32_16x16x32_bf16 v[112:115], v[48:51], v[32:35], v[112:115]
  v_mfma_f32_16x16x32_bf16 v[144:147], v[48:51], v[36:39], v[144:147]
  ds_read_b64_tr_b16 v[48:49], v5 offset:31744
  v_mfma_f32_16x16x32_bf16 v[116:119], v[52:55], v[32:35], v[116:119]
  ds_read_b64_tr_b16 v[50:51], v5 offset:32704
  v_mfma_f32_16x16x32_bf16 v[148:151], v[52:55], v[36:39], v[148:151]
  ds_read_b64_tr_b16 v[52:53], v5 offset:31752
  v_mfma_f32_16x16x32_bf16 v[120:123], v[56:59], v[32:35], v[120:123]
  ds_read_b64_tr_b16 v[54:55], v5 offset:32712
  v_mfma_f32_16x16x32_bf16 v[152:155], v[56:59], v[36:39], v[152:155]
  ds_read_b64_tr_b16 v[56:57], v5 offset:31760
  v_mfma_f32_16x16x32_bf16 v[124:127], v[60:63], v[32:35], v[124:127]
  ds_read_b64_tr_b16 v[58:59], v5 offset:32720
  v_mfma_f32_16x16x32_bf16 v[156:159], v[60:63], v[36:39], v[156:159]
  ds_read_b64_tr_b16 v[60:61], v5 offset:31768
  v_mfma_f32_16x16x32_bf16 v[128:131], v[64:67], v[32:35], v[128:131]
  ds_read_b64_tr_b16 v[62:63], v5 offset:32728
  v_mfma_f32_16x16x32_bf16 v[160:163], v[64:67], v[36:39], v[160:163]
  ds_read_b64_tr_b16 v[64:65], v5 offset:31776
  v_mfma_f32_16x16x32_bf16 v[132:135], v[68:71], v[32:35], v[132:135]
  ds_read_b64_tr_b16 v[66:67], v5 offset:32736
  v_mfma_f32_16x16x32_bf16 v[164:167], v[68:71], v[36:39], v[164:167]
  ds_read_b64_tr_b16 v[68:69], v8 offset:31744
  v_mfma_f32_16x16x32_bf16 v[136:139], v[72:75], v[32:35], v[136:139]
  ds_read_b64_tr_b16 v[70:71], v8 offset:32704
  v_mfma_f32_16x16x32_bf16 v[168:171], v[72:75], v[36:39], v[168:171]
  ds_read_b64_tr_b16 v[72:73], v11 offset:31744
  v_mfma_f32_16x16x32_bf16 v[140:143], v[76:79], v[32:35], v[140:143]
  ds_read_b64_tr_b16 v[74:75], v11 offset:32704
  v_mfma_f32_16x16x32_bf16 v[172:175], v[76:79], v[36:39], v[172:175]
  ds_read_b64_tr_b16 v[76:77], v14 offset:31744
  v_mfma_f32_16x16x32_bf16 v[196:199], v[180:183], v[220:223], v[196:199]
  ds_read_b64_tr_b16 v[78:79], v14 offset:32704
  ds_read_b64_tr_b16 v[180:181], v28 offset:31744
  v_mfma_f32_16x16x32_bf16 v[200:203], v[184:187], v[220:223], v[200:203]
  ds_read_b64_tr_b16 v[182:183], v28 offset:32704
  ds_read_b64_tr_b16 v[184:185], v177 offset:31744
  v_mfma_f32_16x16x32_bf16 v[204:207], v[220:223], v[32:35], v[204:207]
  ds_read_b64_tr_b16 v[186:187], v177 offset:32704
  v_mfma_f32_16x16x32_bf16 v[212:215], v[32:35], v[32:35], v[212:215]
  ds_read_b128 v[32:35], v17 offset:31744
  v_mfma_f32_16x16x32_bf16 v[208:211], v[220:223], v[36:39], v[208:211]
  v_mfma_f32_16x16x32_bf16 v[216:219], v[36:39], v[36:39], v[216:219]
  ds_read_b128 v[36:39], v17 offset:33792
  v_mfma_f32_16x16x32_bf16 v[112:115], v[80:83], v[40:43], v[112:115]
  v_mfma_f32_16x16x32_bf16 v[144:147], v[80:83], v[44:47], v[144:147]
  ds_read_b64_tr_b16 v[80:81], v5 offset:39424
  v_mfma_f32_16x16x32_bf16 v[116:119], v[84:87], v[40:43], v[116:119]
  ds_read_b64_tr_b16 v[82:83], v5 offset:40384
  v_mfma_f32_16x16x32_bf16 v[148:151], v[84:87], v[44:47], v[148:151]
  ds_read_b64_tr_b16 v[84:85], v5 offset:39432
  v_mfma_f32_16x16x32_bf16 v[120:123], v[88:91], v[40:43], v[120:123]
  ds_read_b64_tr_b16 v[86:87], v5 offset:40392
  v_mfma_f32_16x16x32_bf16 v[152:155], v[88:91], v[44:47], v[152:155]
  ds_read_b64_tr_b16 v[88:89], v5 offset:39440
  v_mfma_f32_16x16x32_bf16 v[124:127], v[92:95], v[40:43], v[124:127]
  ds_read_b64_tr_b16 v[90:91], v5 offset:40400
  v_mfma_f32_16x16x32_bf16 v[156:159], v[92:95], v[44:47], v[156:159]
  ds_read_b64_tr_b16 v[92:93], v5 offset:39448
  v_mfma_f32_16x16x32_bf16 v[128:131], v[96:99], v[40:43], v[128:131]
  ds_read_b64_tr_b16 v[94:95], v5 offset:40408
  v_mfma_f32_16x16x32_bf16 v[160:163], v[96:99], v[44:47], v[160:163]
  ds_read_b64_tr_b16 v[96:97], v5 offset:39456
  v_mfma_f32_16x16x32_bf16 v[132:135], v[100:103], v[40:43], v[132:135]
  ds_read_b64_tr_b16 v[98:99], v5 offset:40416
  v_mfma_f32_16x16x32_bf16 v[164:167], v[100:103], v[44:47], v[164:167]
  ds_read_b64_tr_b16 v[100:101], v8 offset:39424
  v_mfma_f32_16x16x32_bf16 v[136:139], v[104:107], v[40:43], v[136:139]
  ds_read_b64_tr_b16 v[102:103], v8 offset:40384
  v_mfma_f32_16x16x32_bf16 v[168:171], v[104:107], v[44:47], v[168:171]
  ds_read_b64_tr_b16 v[104:105], v11 offset:39424
  v_mfma_f32_16x16x32_bf16 v[140:143], v[108:111], v[40:43], v[140:143]
  ds_read_b64_tr_b16 v[106:107], v11 offset:40384
  v_mfma_f32_16x16x32_bf16 v[172:175], v[108:111], v[44:47], v[172:175]
  ds_read_b64_tr_b16 v[108:109], v14 offset:39424
  v_mfma_f32_16x16x32_bf16 v[196:199], v[188:191], v[220:223], v[196:199]
  ds_read_b64_tr_b16 v[110:111], v14 offset:40384
  ds_read_b64_tr_b16 v[188:189], v28 offset:39424
  v_mfma_f32_16x16x32_bf16 v[200:203], v[192:195], v[220:223], v[200:203]
  ds_read_b64_tr_b16 v[190:191], v28 offset:40384
  ds_read_b64_tr_b16 v[192:193], v177 offset:39424
  v_mfma_f32_16x16x32_bf16 v[204:207], v[220:223], v[40:43], v[204:207]
  ds_read_b64_tr_b16 v[194:195], v177 offset:40384
  v_mfma_f32_16x16x32_bf16 v[212:215], v[40:43], v[40:43], v[212:215]
  ds_read_b128 v[40:43], v25 offset:31744
  v_mfma_f32_16x16x32_bf16 v[208:211], v[220:223], v[44:47], v[208:211]
  v_mfma_f32_16x16x32_bf16 v[216:219], v[44:47], v[44:47], v[216:219]
  ds_read_b128 v[44:47], v25 offset:33792
  s_waitcnt lgkmcnt(0)
  s_barrier
  v_mfma_f32_16x16x32_bf16 v[112:115], v[48:51], v[32:35], v[112:115]
  v_mfma_f32_16x16x32_bf16 v[144:147], v[48:51], v[36:39], v[144:147]
  ds_read_b64_tr_b16 v[48:49], v6 offset:0
  v_mfma_f32_16x16x32_bf16 v[116:119], v[52:55], v[32:35], v[116:119]
  ds_read_b64_tr_b16 v[50:51], v6 offset:960
  v_mfma_f32_16x16x32_bf16 v[148:151], v[52:55], v[36:39], v[148:151]
  ds_read_b64_tr_b16 v[52:53], v6 offset:8
  v_mfma_f32_16x16x32_bf16 v[120:123], v[56:59], v[32:35], v[120:123]
  ds_read_b64_tr_b16 v[54:55], v6 offset:968
  v_mfma_f32_16x16x32_bf16 v[152:155], v[56:59], v[36:39], v[152:155]
  ds_read_b64_tr_b16 v[56:57], v6 offset:16
  v_mfma_f32_16x16x32_bf16 v[124:127], v[60:63], v[32:35], v[124:127]
  ds_read_b64_tr_b16 v[58:59], v6 offset:976
  v_mfma_f32_16x16x32_bf16 v[156:159], v[60:63], v[36:39], v[156:159]
  ds_read_b64_tr_b16 v[60:61], v6 offset:24
  v_mfma_f32_16x16x32_bf16 v[128:131], v[64:67], v[32:35], v[128:131]
  ds_read_b64_tr_b16 v[62:63], v6 offset:984
  v_mfma_f32_16x16x32_bf16 v[160:163], v[64:67], v[36:39], v[160:163]
  ds_read_b64_tr_b16 v[64:65], v6 offset:32
  v_mfma_f32_16x16x32_bf16 v[132:135], v[68:71], v[32:35], v[132:135]
  ds_read_b64_tr_b16 v[66:67], v6 offset:992
  v_mfma_f32_16x16x32_bf16 v[164:167], v[68:71], v[36:39], v[164:167]
  ds_read_b64_tr_b16 v[68:69], v9 offset:0
  v_mfma_f32_16x16x32_bf16 v[136:139], v[72:75], v[32:35], v[136:139]
  ds_read_b64_tr_b16 v[70:71], v9 offset:960
  v_mfma_f32_16x16x32_bf16 v[168:171], v[72:75], v[36:39], v[168:171]
  ds_read_b64_tr_b16 v[72:73], v12 offset:0
  v_mfma_f32_16x16x32_bf16 v[140:143], v[76:79], v[32:35], v[140:143]
  ds_read_b64_tr_b16 v[74:75], v12 offset:960
  v_mfma_f32_16x16x32_bf16 v[172:175], v[76:79], v[36:39], v[172:175]
  ds_read_b64_tr_b16 v[76:77], v15 offset:0
  v_mfma_f32_16x16x32_bf16 v[196:199], v[180:183], v[220:223], v[196:199]
  ds_read_b64_tr_b16 v[78:79], v15 offset:960
  ds_read_b64_tr_b16 v[180:181], v29 offset:0
  v_mfma_f32_16x16x32_bf16 v[200:203], v[184:187], v[220:223], v[200:203]
  ds_read_b64_tr_b16 v[182:183], v29 offset:960
  ds_read_b64_tr_b16 v[184:185], v178 offset:0
  v_mfma_f32_16x16x32_bf16 v[204:207], v[220:223], v[32:35], v[204:207]
  ds_read_b64_tr_b16 v[186:187], v178 offset:960
  v_mfma_f32_16x16x32_bf16 v[212:215], v[32:35], v[32:35], v[212:215]
  ds_read_b128 v[32:35], v18 offset:0
  v_mfma_f32_16x16x32_bf16 v[208:211], v[220:223], v[36:39], v[208:211]
  v_mfma_f32_16x16x32_bf16 v[216:219], v[36:39], v[36:39], v[216:219]
  ds_read_b128 v[36:39], v18 offset:2048
  v_mfma_f32_16x16x32_bf16 v[112:115], v[80:83], v[40:43], v[112:115]
  v_mfma_f32_16x16x32_bf16 v[144:147], v[80:83], v[44:47], v[144:147]
  ds_read_b64_tr_b16 v[80:81], v6 offset:7680
  v_mfma_f32_16x16x32_bf16 v[116:119], v[84:87], v[40:43], v[116:119]
  ds_read_b64_tr_b16 v[82:83], v6 offset:8640
  v_mfma_f32_16x16x32_bf16 v[148:151], v[84:87], v[44:47], v[148:151]
  ds_read_b64_tr_b16 v[84:85], v6 offset:7688
  v_mfma_f32_16x16x32_bf16 v[120:123], v[88:91], v[40:43], v[120:123]
  ds_read_b64_tr_b16 v[86:87], v6 offset:8648
  v_mfma_f32_16x16x32_bf16 v[152:155], v[88:91], v[44:47], v[152:155]
  ds_read_b64_tr_b16 v[88:89], v6 offset:7696
  v_mfma_f32_16x16x32_bf16 v[124:127], v[92:95], v[40:43], v[124:127]
  ds_read_b64_tr_b16 v[90:91], v6 offset:8656
  v_mfma_f32_16x16x32_bf16 v[156:159], v[92:95], v[44:47], v[156:159]
  ds_read_b64_tr_b16 v[92:93], v6 offset:7704
  v_mfma_f32_16x16x32_bf16 v[128:131], v[96:99], v[40:43], v[128:131]
  ds_read_b64_tr_b16 v[94:95], v6 offset:8664
  v_mfma_f32_16x16x32_bf16 v[160:163], v[96:99], v[44:47], v[160:163]
  ds_read_b64_tr_b16 v[96:97], v6 offset:7712
  v_mfma_f32_16x16x32_bf16 v[132:135], v[100:103], v[40:43], v[132:135]
  ds_read_b64_tr_b16 v[98:99], v6 offset:8672
  v_mfma_f32_16x16x32_bf16 v[164:167], v[100:103], v[44:47], v[164:167]
  ds_read_b64_tr_b16 v[100:101], v9 offset:7680
  v_mfma_f32_16x16x32_bf16 v[136:139], v[104:107], v[40:43], v[136:139]
  ds_read_b64_tr_b16 v[102:103], v9 offset:8640
  v_mfma_f32_16x16x32_bf16 v[168:171], v[104:107], v[44:47], v[168:171]
  ds_read_b64_tr_b16 v[104:105], v12 offset:7680
  v_mfma_f32_16x16x32_bf16 v[140:143], v[108:111], v[40:43], v[140:143]
  ds_read_b64_tr_b16 v[106:107], v12 offset:8640
  v_mfma_f32_16x16x32_bf16 v[172:175], v[108:111], v[44:47], v[172:175]
  ds_read_b64_tr_b16 v[108:109], v15 offset:7680
  v_mfma_f32_16x16x32_bf16 v[196:199], v[188:191], v[220:223], v[196:199]
  ds_read_b64_tr_b16 v[110:111], v15 offset:8640
  ds_read_b64_tr_b16 v[188:189], v29 offset:7680
  v_mfma_f32_16x16x32_bf16 v[200:203], v[192:195], v[220:223], v[200:203]
  ds_read_b64_tr_b16 v[190:191], v29 offset:8640
  ds_read_b64_tr_b16 v[192:193], v178 offset:7680
  v_mfma_f32_16x16x32_bf16 v[204:207], v[220:223], v[40:43], v[204:207]
  ds_read_b64_tr_b16 v[194:195], v178 offset:8640
  v_mfma_f32_16x16x32_bf16 v[212:215], v[40:43], v[40:43], v[212:215]
  ds_read_b128 v[40:43], v26 offset:0
  v_mfma_f32_16x16x32_bf16 v[208:211], v[220:223], v[44:47], v[208:211]
  v_mfma_f32_16x16x32_bf16 v[216:219], v[44:47], v[44:47], v[216:219]
  ds_read_b128 v[44:47], v26 offset:2048
  s_waitcnt lgkmcnt(0)
  s_barrier
  v_mfma_f32_16x16x32_bf16 v[112:115], v[48:51], v[32:35], v[112:115]
  v_mfma_f32_16x16x32_bf16 v[144:147], v[48:51], v[36:39], v[144:147]
  v_mfma_f32_16x16x32_bf16 v[116:119], v[52:55], v[32:35], v[116:119]
  v_mfma_f32_16x16x32_bf16 v[148:151], v[52:55], v[36:39], v[148:151]
  v_mfma_f32_16x16x32_bf16 v[120:123], v[56:59], v[32:35], v[120:123]
  v_mfma_f32_16x16x32_bf16 v[152:155], v[56:59], v[36:39], v[152:155]
  v_mfma_f32_16x16x32_bf16 v[124:127], v[60:63], v[32:35], v[124:127]
  v_mfma_f32_16x16x32_bf16 v[156:159], v[60:63], v[36:39], v[156:159]
  v_mfma_f32_16x16x32_bf16 v[128:131], v[64:67], v[32:35], v[128:131]
  v_mfma_f32_16x16x32_bf16 v[160:163], v[64:67], v[36:39], v[160:163]
  v_mfma_f32_16x16x32_bf16 v[132:135], v[68:71], v[32:35], v[132:135]
  v_mfma_f32_16x16x32_bf16 v[164:167], v[68:71], v[36:39], v[164:167]
  v_mfma_f32_16x16x32_bf16 v[136:139], v[72:75], v[32:35], v[136:139]
  v_mfma_f32_16x16x32_bf16 v[168:171], v[72:75], v[36:39], v[168:171]
  v_mfma_f32_16x16x32_bf16 v[140:143], v[76:79], v[32:35], v[140:143]
  v_mfma_f32_16x16x32_bf16 v[172:175], v[76:79], v[36:39], v[172:175]
  v_mfma_f32_16x16x32_bf16 v[196:199], v[180:183], v[220:223], v[196:199]
  v_mfma_f32_16x16x32_bf16 v[200:203], v[184:187], v[220:223], v[200:203]
  v_mfma_f32_16x16x32_bf16 v[204:207], v[220:223], v[32:35], v[204:207]
  v_mfma_f32_16x16x32_bf16 v[212:215], v[32:35], v[32:35], v[212:215]
  v_mfma_f32_16x16x32_bf16 v[208:211], v[220:223], v[36:39], v[208:211]
  v_mfma_f32_16x16x32_bf16 v[216:219], v[36:39], v[36:39], v[216:219]
  v_mfma_f32_16x16x32_bf16 v[112:115], v[80:83], v[40:43], v[112:115]
  v_mfma_f32_16x16x32_bf16 v[144:147], v[80:83], v[44:47], v[144:147]
  v_mfma_f32_16x16x32_bf16 v[116:119], v[84:87], v[40:43], v[116:119]
  v_mfma_f32_16x16x32_bf16 v[148:151], v[84:87], v[44:47], v[148:151]
  v_mfma_f32_16x16x32_bf16 v[120:123], v[88:91], v[40:43], v[120:123]
  v_mfma_f32_16x16x32_bf16 v[152:155], v[88:91], v[44:47], v[152:155]
  v_mfma_f32_16x16x32_bf16 v[124:127], v[92:95], v[40:43], v[124:127]
  v_mfma_f32_16x16x32_bf16 v[156:159], v[92:95], v[44:47], v[156:159]
  v_mfma_f32_16x16x32_bf16 v[128:131], v[96:99], v[40:43], v[128:131]
  v_mfma_f32_16x16x32_bf16 v[160:163], v[96:99], v[44:47], v[160:163]
  v_mfma_f32_16x16x32_bf16 v[132:135], v[100:103], v[40:43], v[132:135]
  v_mfma_f32_16x16x32_bf16 v[164:167], v[100:103], v[44:47], v[164:167]
  v_mfma_f32_16x16x32_bf16 v[136:139], v[104:107], v[40:43], v[136:139]
  v_mfma_f32_16x16x32_bf16 v[168:171], v[104:107], v[44:47], v[168:171]
  v_mfma_f32_16x16x32_bf16 v[140:143], v[108:111], v[40:43], v[140:143]
  v_mfma_f32_16x16x32_bf16 v[172:175], v[108:111], v[44:47], v[172:175]
  v_mfma_f32_16x16x32_bf16 v[196:199], v[188:191], v[220:223], v[196:199]
  v_mfma_f32_16x16x32_bf16 v[200:203], v[192:195], v[220:223], v[200:203]
  v_mfma_f32_16x16x32_bf16 v[204:207], v[220:223], v[40:43], v[204:207]
  v_mfma_f32_16x16x32_bf16 v[212:215], v[40:43], v[40:43], v[212:215]
  v_mfma_f32_16x16x32_bf16 v[208:211], v[220:223], v[44:47], v[208:211]
  v_mfma_f32_16x16x32_bf16 v[216:219], v[44:47], v[44:47], v[216:219]
  s_waitcnt vmcnt(0)
  v_readfirstlane_b32 s96, v253
  s_lshl_b32 s16, s2, 2
  s_add_u32 s16, s16, s25
  s_add_u32 s16, s16, 2048
  s_mov_b32 s17, 4000
  s_cmp_ge_u32 s2, 30
  s_cbranch_scc1 Lsequential_preLN__linear_kernel_hedgehog__geglu_ffn__prompt_kernel_r2skip
  v_lshlrev_b32 v224, 3, v1
  v_mul_u32_u24 v226, 1280, v3
  v_lshl_add_u32 v226, v21, 4, v226
  s_mov_b32 s44, 5
  s_mov_b32 s45, 0
  s_mov_b32 s46, 0
  s_cmp_ge_u32 s16, 560
  s_cselect_b32 s49, 560, 0
  s_cselect_b32 s44, 1, 0
  s_sub_u32 s49, s16, s49
  s_mul_i32 s45, s49, 9363
  s_lshr_b32 s45, s45, 16
  s_mul_i32 s50, s45, 7
  s_sub_u32 s46, s49, s50
  s_cmp_ge_u32 s16, 1768
  s_cselect_b32 s50, 3, 2
  s_cselect_b32 s49, 648, 0
  s_add_u32 s49, s49, 1120
  s_sub_u32 s49, s16, s49
  s_mul_i32 s51, s49, 21846
  s_lshr_b32 s51, s51, 16
  s_mul_i32 s52, s51, 3
  s_sub_u32 s52, s49, s52
  s_cmp_ge_u32 s16, 1120
  s_cselect_b32 s44, s50, s44
  s_cselect_b32 s45, s51, s45
  s_cselect_b32 s46, s52, s46
  s_sub_u32 s49, s16, 2008
  s_cmp_ge_u32 s16, 2008
  s_cselect_b32 s44, 4, s44
  s_cselect_b32 s45, s49, s45
  s_cmp_ge_u32 s16, 2168
  s_cselect_b32 s44, 5, s44
  s_lshr_b32 s47, s45, 2
  s_and_b32 s48, s45, 3
  s_mov_b32 s55, 0x20000
  s_lshl_b32 s56, s46, 9
  s_cmp_eq_u32 s44, 4
  s_cbranch_scc1 Lsequential_preLN__linear_kernel_hedgehog__geglu_ffn__prompt_kernel_r2_wb
  s_cmp_eq_u32 s44, 5
  s_cbranch_scc1 Lsequential_preLN__linear_kernel_hedgehog__geglu_ffn__prompt_kernel_r2_no
  s_mul_i32 s49, s47, 13
  s_lshr_b32 s49, s49, 6
  s_mul_i32 s50, s49, 5
  s_sub_u32 s50, s47, s50
  s_mul_i32 s49, s49, 160
  s_cmp_ge_u32 s44, 2
  s_cbranch_scc1 Lsequential_preLN__linear_kernel_hedgehog__geglu_ffn__prompt_kernel_r2_dw
  s_cmp_eq_u32 s44, 1
  s_cselect_b32 s52, s70, s68
  s_cselect_b32 s53, s71, s69
  s_mov_b32 s54, 2211840
  s_mul_i32 s51, s48, 20
  s_add_u32 s49, s49, s51
  s_lshl_b32 s50, s50, 3
  s_add_u32 s49, s49, s50
  s_add_u32 s51, s50, 0
  s_cmp_ge_u32 s51, 20
  s_cselect_b32 s51, 60, 0
  s_add_u32 s51, s51, s49
  s_mul_i32 s51, s51, 3456
  s_add_u32 s51, s51, s56
  buffer_load_dwordx2 v[236:237], v224, s[52:55], s51 offen
  s_add_u32 s51, s50, 1
  s_cmp_ge_u32 s51, 20
  s_cselect_b32 s51, 60, 0
  s_add_u32 s51, s51, s49
  s_add_u32 s51, s51, 1
  s_mul_i32 s51, s51, 3456
  s_add_u32 s51, s51, s56
  buffer_load_dwordx2 v[238:239], v224, s[52:55], s51 offen
  s_add_u32 s51, s50, 2
  s_cmp_ge_u32 s51, 20
  s_cselect_b32 s51, 60, 0
  s_add_u32 s51, s51, s49
  s_add_u32 s51, s51, 2
  s_mul_i32 s51, s51, 3456
  s_add_u32 s51, s51, s56
  buffer_load_dwordx2 v[240:241], v224, s[52:55], s51 offen
  s_add_u32 s51, s50, 3
  s_cmp_ge_u32 s51, 20
  s_cselect_b32 s51, 60, 0
  s_add_u32 s51, s51, s49
  s_add_u32 s51, s51, 3
  s_mul_i32 s51, s51, 3456
  s_add_u32 s51, s51, s56
  buffer_load_dwordx2 v[242:243], v224, s[52:55], s51 offen
  s_add_u32 s51, s50, 4
  s_cmp_ge_u32 s51, 20
  s_cselect_b32 s51, 60, 0
  s_add_u32 s51, s51, s49
  s_add_u32 s51, s51, 4
  s_mul_i32 s51, s51, 3456
  s_add_u32 s51, s51, s56
  buffer_load_dwordx2 v[244:245], v224, s[52:55], s51 offen
  s_add_u32 s51, s50, 5
  s_cmp_ge_u32 s51, 20
  s_cselect_b32 s51, 60, 0
  s_add_u32 s51, s51, s49
  s_add_u32 s51, s51, 5
  s_mul_i32 s51, s51, 3456
  s_add_u32 s51, s51, s56
  buffer_load_dwordx2 v[246:247], v224, s[52:55], s51 offen
  s_add_u32 s51, s50, 6
  s_cmp_ge_u32 s51, 20
  s_cselect_b32 s51, 60, 0
  s_add_u32 s51, s51, s49
  s_add_u32 s51, s51, 6
  s_mul_i32 s51, s51, 3456
  s_add_u32 s51, s51, s56
  buffer_load_dwordx2 v[248:249], v224, s[52:55], s51 offen
  s_add_u32 s51, s50, 7
  s_cmp_ge_u32 s51, 20
  s_cselect_b32 s51, 60, 0
  s_add_u32 s51, s51, s49
  s_add_u32 s51, s51, 7
  s_mul_i32 s51, s51, 3456
  s_add_u32 s51, s51, s56
  buffer_load_dwordx2 v[250:251], v224, s[52:55], s51 offen
  s_branch Lsequential_preLN__linear_kernel_hedgehog__geglu_ffn__prompt_kernel_r2_dn
Lsequential_preLN__linear_kernel_hedgehog__geglu_ffn__prompt_kernel_r2_dw:
  s_cmp_eq_u32 s44, 3
  s_cselect_b32 s52, s66, s72
  s_cselect_b32 s53, s67, s73
  s_mov_b32 s54, 2211840
  s_cselect_b32 s54, 819200, s54
  s_mul_i32 s51, s48, 40
  s_add_u32 s61, s49, s51
  s_mul_i32 s51, s48, 10
  s_add_u32 s49, s49, s51
  s_mul_i32 s51, s50, 40
  s_add_u32 s57, s49, s51
  s_lshl_b32 s58, s47, 5
  s_lshl_b32 s51, s48, 2
  s_add_u32 s58, s58, s51
  s_add_u32 s51, s57, 0
  s_add_u32 s59, s61, 8
  s_cmp_eq_u32 s50, 4
  s_cselect_b32 s51, s59, s51
  s_add_u32 s59, s58, 0
  s_cmp_eq_u32 s44, 2
  s_cselect_b32 s51, s59, s51
  s_mul_i32 s51, s51, 1280
  s_add_u32 s51, s51, s56
  buffer_load_dwordx2 v[236:237], v224, s[52:55], s51 offen
  s_add_u32 s51, s57, 1
  s_add_u32 s59, s61, 9
  s_cmp_eq_u32 s50, 4
  s_cselect_b32 s51, s59, s51
  s_add_u32 s59, s58, 1
  s_cmp_eq_u32 s44, 2
  s_cselect_b32 s51, s59, s51
  s_mul_i32 s51, s51, 1280
  s_add_u32 s51, s51, s56
  buffer_load_dwordx2 v[238:239], v224, s[52:55], s51 offen
  s_add_u32 s51, s57, 2
  s_add_u32 s59, s61, 18
  s_cmp_eq_u32 s50, 4
  s_cselect_b32 s51, s59, s51
  s_add_u32 s59, s58, 2
  s_cmp_eq_u32 s44, 2
  s_cselect_b32 s51, s59, s51
  s_mul_i32 s51, s51, 1280
  s_add_u32 s51, s51, s56
  buffer_load_dwordx2 v[240:241], v224, s[52:55], s51 offen
  s_add_u32 s51, s57, 3
  s_add_u32 s59, s61, 19
  s_cmp_eq_u32 s50, 4
  s_cselect_b32 s51, s59, s51
  s_add_u32 s59, s58, 3
  s_cmp_eq_u32 s44, 2
  s_cselect_b32 s51, s59, s51
  s_mul_i32 s51, s51, 1280
  s_add_u32 s51, s51, s56
  buffer_load_dwordx2 v[242:243], v224, s[52:55], s51 offen
  s_add_u32 s51, s57, 4
  s_add_u32 s59, s61, 28
  s_cmp_eq_u32 s50, 4
  s_cselect_b32 s51, s59, s51
  s_add_u32 s59, s58, 16
  s_cmp_eq_u32 s44, 2
  s_cselect_b32 s51, s59, s51
  s_mul_i32 s51, s51, 1280
  s_add_u32 s51, s51, s56
  buffer_load_dwordx2 v[244:245], v224, s[52:55], s51 offen
  s_add_u32 s51, s57, 5
  s_add_u32 s59, s61, 29
  s_cmp_eq_u32 s50, 4
  s_cselect_b32 s51, s59, s51
  s_add_u32 s59, s58, 17
  s_cmp_eq_u32 s44, 2
  s_cselect_b32 s51, s59, s51
  s_mul_i32 s51, s51, 1280
  s_add_u32 s51, s51, s56
  buffer_load_dwordx2 v[246:247], v224, s[52:55], s51 offen
  s_add_u32 s51, s57, 6
  s_add_u32 s59, s61, 38
  s_cmp_eq_u32 s50, 4
  s_cselect_b32 s51, s59, s51
  s_add_u32 s59, s58, 18
  s_cmp_eq_u32 s44, 2
  s_cselect_b32 s51, s59, s51
  s_mul_i32 s51, s51, 1280
  s_add_u32 s51, s51, s56
  buffer_load_dwordx2 v[248:249], v224, s[52:55], s51 offen
  s_add_u32 s51, s57, 7
  s_add_u32 s59, s61, 39
  s_cmp_eq_u32 s50, 4
  s_cselect_b32 s51, s59, s51
  s_add_u32 s59, s58, 19
  s_cmp_eq_u32 s44, 2
  s_cselect_b32 s51, s59, s51
  s_mul_i32 s51, s51, 1280
  s_add_u32 s51, s51, s56
  buffer_load_dwordx2 v[250:251], v224, s[52:55], s51 offen
  s_branch Lsequential_preLN__linear_kernel_hedgehog__geglu_ffn__prompt_kernel_r2_dn
Lsequential_preLN__linear_kernel_hedgehog__geglu_ffn__prompt_kernel_r2_wb:
  s_mov_b32 s52, s66
  s_mov_b32 s53, s67
  s_mov_b32 s54, 819200
  s_mul_i32 s51, s45, 5120
  buffer_load_dwordx4 v[236:239], v226, s[52:55], s51 offen offset:0
  buffer_load_dwordx4 v[240:243], v226, s[52:55], s51 offen offset:256
  buffer_load_dwordx4 v[244:247], v226, s[52:55], s51 offen offset:512
  buffer_load_dwordx4 v[248:251], v226, s[52:55], s51 offen offset:768
  buffer_load_dwordx4 v[252:255], v226, s[52:55], s51 offen offset:1024
  buffer_load_dword v30, v226, s[52:55], s51 offen
  buffer_load_dword v30, v226, s[52:55], s51 offen
  buffer_load_dword v30, v226, s[52:55], s51 offen
  s_branch Lsequential_preLN__linear_kernel_hedgehog__geglu_ffn__prompt_kernel_r2_dn
Lsequential_preLN__linear_kernel_hedgehog__geglu_ffn__prompt_kernel_r2_no:
  buffer_load_dword v30, v224, s[12:15], 0 offen
  buffer_load_dword v30, v224, s[12:15], 0 offen
  buffer_load_dword v30, v224, s[12:15], 0 offen
  buffer_load_dword v30, v224, s[12:15], 0 offen
  buffer_load_dword v30, v224, s[12:15], 0 offen
  buffer_load_dword v30, v224, s[12:15], 0 offen
  buffer_load_dword v30, v224, s[12:15], 0 offen
  buffer_load_dword v30, v224, s[12:15], 0 offen
Lsequential_preLN__linear_kernel_hedgehog__geglu_ffn__prompt_kernel_r2_dn:
Lsequential_preLN__linear_kernel_hedgehog__geglu_ffn__prompt_kernel_r2skip:
  s_mul_i32 s31, s25, 9216
  v_lshlrev_b32 v228, 4, v1
  v_add_u32 v228, s31, v228
  ds_write_b128 v228, v[144:147] offset:40960
  ds_write_b128 v228, v[148:151] offset:41984
  ds_write_b128 v228, v[152:155] offset:43008
  ds_write_b128 v228, v[156:159] offset:44032
  ds_write_b128 v228, v[160:163] offset:45056
  ds_write_b128 v228, v[164:167] offset:46080
  ds_write_b128 v228, v[168:171] offset:47104
  ds_write_b128 v228, v[172:175] offset:48128
  s_lshl_b32 s31, s25, 11
  s_add_u32 s31, s31, 77824
  v_lshlrev_b32 v229, 4, v1
  v_add_u32 v229, s31, v229
  ds_write_b128 v229, v[216:219]
  ds_write_b128 v229, v[208:211] offset:1024
  v_lshlrev_b32 v230, 4, v3
  s_lshl_b32 s31, s25, 7
  s_add_u32 s31, s31, 161664
  v_add_u32 v230, s31, v230
  ds_write_b128 v230, v[196:199] offset:0
  ds_write_b128 v230, v[200:203] offset:64
  s_waitcnt lgkmcnt(0)
  s_barrier
  s_branch Lsequential_preLN__linear_kernel_hedgehog__geglu_ffn__prompt_kernel_epi
Lsequential_preLN__linear_kernel_hedgehog__geglu_ffn__prompt_kernel_H1:
  v_lshrrev_b32 v22, 3, v1
  v_and_b32 v23, 7, v1
  v_xor_b32 v23, v23, v22
  v_mul_u32_u24 v19, 1280, v22
  v_lshl_add_u32 v19, v23, 4, v19
  v_mul_u32_u24 v148, 6554, v1
  v_lshrrev_b32 v148, 16, v148
  v_mul_u32_u24 v149, 10, v148
  v_sub_u32 v149, v1, v149
  v_lshlrev_b32 v150, 4, v149
  v_add_u32 v151, 1200, v150
  v_cmp_gt_u32 vcc, 5, v149
  s_nop 1
  v_cndmask_b32 v150, v151, v150, vcc
  v_mul_u32_u24 v20, 3840, v148
  v_add_u32 v20, v20, v150
  v_subrev_u32 v152, 40, v1
  v_max_i32 v152, 0, v152
  v_min_u32 v152, 19, v152
  v_mul_u32_u24 v153, 3, v152
  v_mov_b32 v154, 0x0c6116a0
  v_mov_b32 v155, 0x081a2ca1
  v_lshrrev_b64 v[154:155], v153, v[154:155]
  v_and_b32 v153, 7, v154
  v_mul_u32_u24 v156, 13108, v152
  v_lshrrev_b32 v156, 16, v156
  v_mul_u32_u24 v156, 3840, v156
  v_lshl_add_u32 v156, v153, 4, v156
  v_add_u32 v156, 2560, v156
  v_cmp_gt_u32 vcc, 40, v1
  s_nop 1
  v_cndmask_b32 v20, v156, v20, vcc
  s_lshl_b32 s27, s23, 7
  s_lshl_b32 s28, s25, 5
  s_add_u32 s27, s27, s28
  s_mul_i32 s27, s27, 1280
  s_mul_i32 s28, s24, 80
  s_mul_i32 s29, s25, 61440
  s_add_u32 s28, s28, s29
  s_lshl_b32 s29, s25, 12
  s_mul_i32 s30, s25, 3840
  s_add_u32 s30, s30, 16384
  s_waitcnt lgkmcnt(0)
  s_mov_b32 s36, s4
  s_mov_b32 s37, s5
  s_mov_b32 s38, 2621440
  s_mov_b32 s39, 0x20000
  s_mov_b32 s40, s6
  s_mov_b32 s41, s7
  s_mov_b32 s42, 2457600
  s_mov_b32 s43, 0x20000
  s_mov_b32 s12, s8
  s_mov_b32 s13, s9
  s_mov_b32 s14, 37748736
  s_mov_b32 s15, 0x20000
  s_mov_b32 s34, -1
  s_mov_b32 s35, 0x0fffffff
  s_mov_b32 s33, 0x3f803f80
  s_add_u32 m0, s30, 0
  s_add_u32 s32, s28, 0
  s_mov_b64 exec, s[34:35]
  buffer_load_dwordx4 v20, s[40:43], s32 offen lds
  s_mov_b64 exec, -1
  s_add_u32 m0, s29, 0
  s_add_u32 s32, s27, 0
  buffer_load_dwordx4 v19, s[36:39], s32 offen lds
  s_add_u32 m0, s30, 960
  s_add_u32 s32, s28, 15360
  s_mov_b64 exec, s[34:35]
  buffer_load_dwordx4 v20, s[40:43], s32 offen lds
  s_mov_b64 exec, -1
  s_add_u32 m0, s29, 1024
  s_add_u32 s32, s27, 10240
  buffer_load_dwordx4 v19, s[36:39], s32 offen lds
  s_add_u32 m0, s30, 1920
  s_add_u32 s32, s28, 30720
  s_mov_b64 exec, s[34:35]
  buffer_load_dwordx4 v20, s[40:43], s32 offen lds
  s_mov_b64 exec, -1
  s_add_u32 m0, s29, 2048
  s_add_u32 s32, s27, 20480
  buffer_load_dwordx4 v19, s[36:39], s32 offen lds
  s_add_u32 m0, s30, 2880
  s_add_u32 s32, s28, 46080
  s_mov_b64 exec, s[34:35]
  buffer_load_dwordx4 v20, s[40:43], s32 offen lds
  s_mov_b64 exec, -1
  s_add_u32 m0, s29, 3072
  s_add_u32 s32, s27, 30720
  buffer_load_dwordx4 v19, s[36:39], s32 offen lds
  s_add_u32 m0, s30, 31744
  s_add_u32 s32, s28, 245760
  s_mov_b64 exec, s[34:35]
  buffer_load_dwordx4 v20, s[40:43], s32 offen lds
  s_mov_b64 exec, -1
  s_add_u32 m0, s29, 31744
  s_add_u32 s32, s27, 128
  buffer_load_dwordx4 v19, s[36:39], s32 offen lds
  s_add_u32 m0, s30, 32704
  s_add_u32 s32, s28, 261120
  s_mov_b64 exec, s[34:35]
  buffer_load_dwordx4 v20, s[40:43], s32 offen lds
  s_mov_b64 exec, -1
  s_add_u32 m0, s29, 32768
  s_add_u32 s32, s27, 10368
  buffer_load_dwordx4 v19, s[36:39], s32 offen lds
  s_add_u32 m0, s30, 33664
  s_add_u32 s32, s28, 276480
  s_mov_b64 exec, s[34:35]
  buffer_load_dwordx4 v20, s[40:43], s32 offen lds
  s_mov_b64 exec, -1
  s_add_u32 m0, s29, 33792
  s_add_u32 s32, s27, 20608
  buffer_load_dwordx4 v19, s[36:39], s32 offen lds
  s_add_u32 m0, s30, 34624
  s_add_u32 s32, s28, 291840
  s_mov_b64 exec, s[34:35]
  buffer_load_dwordx4 v20, s[40:43], s32 offen lds
  s_mov_b64 exec, -1
  s_add_u32 m0, s29, 34816
  s_add_u32 s32, s27, 30848
  buffer_load_dwordx4 v19, s[36:39], s32 offen lds
  s_waitcnt vmcnt(8)
  s_barrier
  s_add_u32 m0, s30, 63488
  s_add_u32 s32, s28, 491520
  s_mov_b64 exec, s[34:35]
  buffer_load_dwordx4 v20, s[40:43], s32 offen lds
  s_mov_b64 exec, -1
  s_add_u32 m0, s29, 63488
  s_add_u32 s32, s27, 256
  buffer_load_dwordx4 v19, s[36:39], s32 offen lds
  s_add_u32 m0, s30, 64448
  s_add_u32 s32, s28, 506880
  s_mov_b64 exec, s[34:35]
  buffer_load_dwordx4 v20, s[40:43], s32 offen lds
  s_mov_b64 exec, -1
  s_add_u32 m0, s29, 64512
  s_add_u32 s32, s27, 10496
  buffer_load_dwordx4 v19, s[36:39], s32 offen lds
  s_add_u32 m0, s30, 65408
  s_add_u32 s32, s28, 522240
  s_mov_b64 exec, s[34:35]
  buffer_load_dwordx4 v20, s[40:43], s32 offen lds
  s_mov_b64 exec, -1
  s_add_u32 m0, s29, 65536
  s_add_u32 s32, s27, 20736
  buffer_load_dwordx4 v19, s[36:39], s32 offen lds
  s_add_u32 m0, s30, 66368
  s_add_u32 s32, s28, 537600
  s_mov_b64 exec, s[34:35]
  buffer_load_dwordx4 v20, s[40:43], s32 offen lds
  s_mov_b64 exec, -1
  s_add_u32 m0, s29, 66560
  s_add_u32 s32, s27, 30976
  buffer_load_dwordx4 v19, s[36:39], s32 offen lds
  s_waitcnt vmcnt(8)
  s_barrier
  s_add_u32 m0, s30, 95232
  s_add_u32 s32, s28, 737280
  s_mov_b64 exec, s[34:35]
  buffer_load_dwordx4 v20, s[40:43], s32 offen lds
  s_mov_b64 exec, -1
  s_add_u32 m0, s29, 95232
  s_add_u32 s32, s27, 384
  buffer_load_dwordx4 v19, s[36:39], s32 offen lds
  s_add_u32 m0, s30, 96192
  s_add_u32 s32, s28, 752640
  s_mov_b64 exec, s[34:35]
  buffer_load_dwordx4 v20, s[40:43], s32 offen lds
  s_mov_b64 exec, -1
  s_add_u32 m0, s29, 96256
  s_add_u32 s32, s27, 10624
  buffer_load_dwordx4 v19, s[36:39], s32 offen lds
  s_add_u32 m0, s30, 97152
  s_add_u32 s32, s28, 768000
  s_mov_b64 exec, s[34:35]
  buffer_load_dwordx4 v20, s[40:43], s32 offen lds
  s_mov_b64 exec, -1
  s_add_u32 m0, s29, 97280
  s_add_u32 s32, s27, 20864
  buffer_load_dwordx4 v19, s[36:39], s32 offen lds
  s_add_u32 m0, s30, 98112
  s_add_u32 s32, s28, 783360
  s_mov_b64 exec, s[34:35]
  buffer_load_dwordx4 v20, s[40:43], s32 offen lds
  s_mov_b64 exec, -1
  s_add_u32 m0, s29, 98304
  s_add_u32 s32, s27, 31104
  buffer_load_dwordx4 v19, s[36:39], s32 offen lds
  s_add_u32 m0, s30, 126976
  s_add_u32 s32, s28, 983040
  s_mov_b64 exec, s[34:35]
  buffer_load_dwordx4 v20, s[40:43], s32 offen lds
  s_mov_b64 exec, -1
  s_add_u32 m0, s29, 126976
  s_add_u32 s32, s27, 512
  buffer_load_dwordx4 v19, s[36:39], s32 offen lds
  s_add_u32 m0, s30, 127936
  s_add_u32 s32, s28, 998400
  s_mov_b64 exec, s[34:35]
  buffer_load_dwordx4 v20, s[40:43], s32 offen lds
  s_mov_b64 exec, -1
  s_add_u32 m0, s29, 128000
  s_add_u32 s32, s27, 10752
  buffer_load_dwordx4 v19, s[36:39], s32 offen lds
  s_add_u32 m0, s30, 128896
  s_add_u32 s32, s28, 1013760
  s_mov_b64 exec, s[34:35]
  buffer_load_dwordx4 v20, s[40:43], s32 offen lds
  s_mov_b64 exec, -1
  s_add_u32 m0, s29, 129024
  s_add_u32 s32, s27, 20992
  buffer_load_dwordx4 v19, s[36:39], s32 offen lds
  s_add_u32 m0, s30, 129856
  s_add_u32 s32, s28, 1029120
  s_mov_b64 exec, s[34:35]
  buffer_load_dwordx4 v20, s[40:43], s32 offen lds
  s_mov_b64 exec, -1
  s_add_u32 m0, s29, 130048
  s_add_u32 s32, s27, 31232
  buffer_load_dwordx4 v19, s[36:39], s32 offen lds
  s_waitcnt vmcnt(16)
  s_barrier
  s_add_u32 m0, s30, 0
  s_add_u32 s32, s28, 1228800
  s_mov_b64 exec, s[34:35]
  buffer_load_dwordx4 v20, s[40:43], s32 offen lds
  s_mov_b64 exec, -1
  s_add_u32 m0, s29, 0
  s_add_u32 s32, s27, 640
  buffer_load_dwordx4 v19, s[36:39], s32 offen lds
  s_add_u32 m0, s30, 960
  s_add_u32 s32, s28, 1244160
  s_mov_b64 exec, s[34:35]
  buffer_load_dwordx4 v20, s[40:43], s32 offen lds
  s_mov_b64 exec, -1
  s_add_u32 m0, s29, 1024
  s_add_u32 s32, s27, 10880
  buffer_load_dwordx4 v19, s[36:39], s32 offen lds
  s_add_u32 m0, s30, 1920
  s_add_u32 s32, s28, 1259520
  s_mov_b64 exec, s[34:35]
  buffer_load_dwordx4 v20, s[40:43], s32 offen lds
  s_mov_b64 exec, -1
  s_add_u32 m0, s29, 2048
  s_add_u32 s32, s27, 21120
  buffer_load_dwordx4 v19, s[36:39], s32 offen lds
  s_add_u32 m0, s30, 2880
  s_add_u32 s32, s28, 1274880
  s_mov_b64 exec, s[34:35]
  buffer_load_dwordx4 v20, s[40:43], s32 offen lds
  s_mov_b64 exec, -1
  s_add_u32 m0, s29, 3072
  s_add_u32 s32, s27, 31360
  buffer_load_dwordx4 v19, s[36:39], s32 offen lds
  s_waitcnt vmcnt(16)
  s_barrier
  s_add_u32 m0, s30, 31744
  s_add_u32 s32, s28, 1474560
  s_mov_b64 exec, s[34:35]
  buffer_load_dwordx4 v20, s[40:43], s32 offen lds
  s_mov_b64 exec, -1
  s_add_u32 m0, s29, 31744
  s_add_u32 s32, s27, 768
  buffer_load_dwordx4 v19, s[36:39], s32 offen lds
  s_add_u32 m0, s30, 32704
  s_add_u32 s32, s28, 1489920
  s_mov_b64 exec, s[34:35]
  buffer_load_dwordx4 v20, s[40:43], s32 offen lds
  s_mov_b64 exec, -1
  s_add_u32 m0, s29, 32768
  s_add_u32 s32, s27, 11008
  buffer_load_dwordx4 v19, s[36:39], s32 offen lds
  s_add_u32 m0, s30, 33664
  s_add_u32 s32, s28, 1505280
  s_mov_b64 exec, s[34:35]
  buffer_load_dwordx4 v20, s[40:43], s32 offen lds
  s_mov_b64 exec, -1
  s_add_u32 m0, s29, 33792
  s_add_u32 s32, s27, 21248
  buffer_load_dwordx4 v19, s[36:39], s32 offen lds
  s_add_u32 m0, s30, 34624
  s_add_u32 s32, s28, 1520640
  s_mov_b64 exec, s[34:35]
  buffer_load_dwordx4 v20, s[40:43], s32 offen lds
  s_mov_b64 exec, -1
  s_add_u32 m0, s29, 34816
  s_add_u32 s32, s27, 31488
  buffer_load_dwordx4 v19, s[36:39], s32 offen lds
  s_waitcnt vmcnt(16)
  s_barrier
  s_add_u32 m0, s30, 63488
  s_add_u32 s32, s28, 1720320
  s_mov_b64 exec, s[34:35]
  buffer_load_dwordx4 v20, s[40:43], s32 offen lds
  s_mov_b64 exec, -1
  s_add_u32 m0, s29, 63488
  s_add_u32 s32, s27, 896
  buffer_load_dwordx4 v19, s[36:39], s32 offen lds
  s_add_u32 m0, s30, 64448
  s_add_u32 s32, s28, 1735680
  s_mov_b64 exec, s[34:35]
  buffer_load_dwordx4 v20, s[40:43], s32 offen lds
  s_mov_b64 exec, -1
  s_add_u32 m0, s29, 64512
  s_add_u32 s32, s27, 11136
  buffer_load_dwordx4 v19, s[36:39], s32 offen lds
  s_add_u32 m0, s30, 65408
  s_add_u32 s32, s28, 1751040
  s_mov_b64 exec, s[34:35]
  buffer_load_dwordx4 v20, s[40:43], s32 offen lds
  s_mov_b64 exec, -1
  s_add_u32 m0, s29, 65536
  s_add_u32 s32, s27, 21376
  buffer_load_dwordx4 v19, s[36:39], s32 offen lds
  s_add_u32 m0, s30, 66368
  s_add_u32 s32, s28, 1766400
  s_mov_b64 exec, s[34:35]
  buffer_load_dwordx4 v20, s[40:43], s32 offen lds
  s_mov_b64 exec, -1
  s_add_u32 m0, s29, 66560
  s_add_u32 s32, s27, 31616
  buffer_load_dwordx4 v19, s[36:39], s32 offen lds
  s_waitcnt vmcnt(16)
  s_barrier
  s_add_u32 m0, s30, 95232
  s_add_u32 s32, s28, 1966080
  s_mov_b64 exec, s[34:35]
  buffer_load_dwordx4 v20, s[40:43], s32 offen lds
  s_mov_b64 exec, -1
  s_add_u32 m0, s29, 95232
  s_add_u32 s32, s27, 1024
  buffer_load_dwordx4 v19, s[36:39], s32 offen lds
  s_add_u32 m0, s30, 96192
  s_add_u32 s32, s28, 1981440
  s_mov_b64 exec, s[34:35]
  buffer_load_dwordx4 v20, s[40:43], s32 offen lds
  s_mov_b64 exec, -1
  s_add_u32 m0, s29, 96256
  s_add_u32 s32, s27, 11264
  buffer_load_dwordx4 v19, s[36:39], s32 offen lds
  s_add_u32 m0, s30, 97152
  s_add_u32 s32, s28, 1996800
  s_mov_b64 exec, s[34:35]
  buffer_load_dwordx4 v20, s[40:43], s32 offen lds
  s_mov_b64 exec, -1
  s_add_u32 m0, s29, 97280
  s_add_u32 s32, s27, 21504
  buffer_load_dwordx4 v19, s[36:39], s32 offen lds
  s_add_u32 m0, s30, 98112
  s_add_u32 s32, s28, 2012160
  s_mov_b64 exec, s[34:35]
  buffer_load_dwordx4 v20, s[40:43], s32 offen lds
  s_mov_b64 exec, -1
  s_add_u32 m0, s29, 98304
  s_add_u32 s32, s27, 31744
  buffer_load_dwordx4 v19, s[36:39], s32 offen lds
  s_waitcnt vmcnt(16)
  s_barrier
  s_add_u32 m0, s30, 126976
  s_add_u32 s32, s28, 2211840
  s_mov_b64 exec, s[34:35]
  buffer_load_dwordx4 v20, s[40:43], s32 offen lds
  s_mov_b64 exec, -1
  s_add_u32 m0, s29, 126976
  s_add_u32 s32, s27, 1152
  buffer_load_dwordx4 v19, s[36:39], s32 offen lds
  s_add_u32 m0, s30, 127936
  s_add_u32 s32, s28, 2227200
  s_mov_b64 exec, s[34:35]
  buffer_load_dwordx4 v20, s[40:43], s32 offen lds
  s_mov_b64 exec, -1
  s_add_u32 m0, s29, 128000
  s_add_u32 s32, s27, 11392
  buffer_load_dwordx4 v19, s[36:39], s32 offen lds
  s_add_u32 m0, s30, 128896
  s_add_u32 s32, s28, 2242560
  s_mov_b64 exec, s[34:35]
  buffer_load_dwordx4 v20, s[40:43], s32 offen lds
  s_mov_b64 exec, -1
  s_add_u32 m0, s29, 129024
  s_add_u32 s32, s27, 21632
  buffer_load_dwordx4 v19, s[36:39], s32 offen lds
  s_add_u32 m0, s30, 129856
  s_add_u32 s32, s28, 2257920
  s_mov_b64 exec, s[34:35]
  buffer_load_dwordx4 v20, s[40:43], s32 offen lds
  s_mov_b64 exec, -1
  s_add_u32 m0, s29, 130048
  s_add_u32 s32, s27, 31872
  buffer_load_dwordx4 v19, s[36:39], s32 offen lds
  s_waitcnt vmcnt(16)
  s_barrier
  v_lshlrev_b32 v26, 3, v1
  v_mul_u32_u24 v28, 1280, v3
  v_lshl_add_u32 v28, v21, 4, v28
  s_lshl_b32 s16, s2, 2
  s_add_u32 s16, s16, s25
  s_add_u32 s17, s16, 1024
  s_mov_b32 s44, 5
  s_mov_b32 s45, 0
  s_mov_b32 s46, 0
  s_cmp_ge_u32 s16, 560
  s_cselect_b32 s49, 560, 0
  s_cselect_b32 s44, 1, 0
  s_sub_u32 s49, s16, s49
  s_mul_i32 s45, s49, 9363
  s_lshr_b32 s45, s45, 16
  s_mul_i32 s50, s45, 7
  s_sub_u32 s46, s49, s50
  s_cmp_ge_u32 s16, 1768
  s_cselect_b32 s50, 3, 2
  s_cselect_b32 s49, 648, 0
  s_add_u32 s49, s49, 1120
  s_sub_u32 s49, s16, s49
  s_mul_i32 s51, s49, 21846
  s_lshr_b32 s51, s51, 16
  s_mul_i32 s52, s51, 3
  s_sub_u32 s52, s49, s52
  s_cmp_ge_u32 s16, 1120
  s_cselect_b32 s44, s50, s44
  s_cselect_b32 s45, s51, s45
  s_cselect_b32 s46, s52, s46
  s_sub_u32 s49, s16, 2008
  s_cmp_ge_u32 s16, 2008
  s_cselect_b32 s44, 4, s44
  s_cselect_b32 s45, s49, s45
  s_cmp_ge_u32 s16, 2168
  s_cselect_b32 s44, 5, s44
  s_lshr_b32 s47, s45, 2
  s_and_b32 s48, s45, 3
  s_mov_b32 s55, 0x20000
  s_lshl_b32 s56, s46, 9
  s_cmp_eq_u32 s44, 4
  s_cbranch_scc1 Lsequential_preLN__linear_kernel_hedgehog__geglu_ffn__prompt_kernel_r0_wb
  s_cmp_eq_u32 s44, 5
  s_cbranch_scc1 Lsequential_preLN__linear_kernel_hedgehog__geglu_ffn__prompt_kernel_r0_no
  s_mul_i32 s49, s47, 13
  s_lshr_b32 s49, s49, 6
  s_mul_i32 s50, s49, 5
  s_sub_u32 s50, s47, s50
  s_mul_i32 s49, s49, 160
  s_cmp_ge_u32 s44, 2
  s_cbranch_scc1 Lsequential_preLN__linear_kernel_hedgehog__geglu_ffn__prompt_kernel_r0_dw
  s_cmp_eq_u32 s44, 1
  s_cselect_b32 s52, s70, s68
  s_cselect_b32 s53, s71, s69
  s_mov_b32 s54, 2211840
  s_mul_i32 s51, s48, 20
  s_add_u32 s49, s49, s51
  s_lshl_b32 s50, s50, 3
  s_add_u32 s49, s49, s50
  s_add_u32 s51, s50, 0
  s_cmp_ge_u32 s51, 20
  s_cselect_b32 s51, 60, 0
  s_add_u32 s51, s51, s49
  s_mul_i32 s51, s51, 3456
  s_add_u32 s51, s51, s56
  buffer_load_dwordx2 v[236:237], v26, s[52:55], s51 offen
  s_add_u32 s51, s50, 1
  s_cmp_ge_u32 s51, 20
  s_cselect_b32 s51, 60, 0
  s_add_u32 s51, s51, s49
  s_add_u32 s51, s51, 1
  s_mul_i32 s51, s51, 3456
  s_add_u32 s51, s51, s56
  buffer_load_dwordx2 v[238:239], v26, s[52:55], s51 offen
  s_add_u32 s51, s50, 2
  s_cmp_ge_u32 s51, 20
  s_cselect_b32 s51, 60, 0
  s_add_u32 s51, s51, s49
  s_add_u32 s51, s51, 2
  s_mul_i32 s51, s51, 3456
  s_add_u32 s51, s51, s56
  buffer_load_dwordx2 v[240:241], v26, s[52:55], s51 offen
  s_add_u32 s51, s50, 3
  s_cmp_ge_u32 s51, 20
  s_cselect_b32 s51, 60, 0
  s_add_u32 s51, s51, s49
  s_add_u32 s51, s51, 3
  s_mul_i32 s51, s51, 3456
  s_add_u32 s51, s51, s56
  buffer_load_dwordx2 v[242:243], v26, s[52:55], s51 offen
  s_add_u32 s51, s50, 4
  s_cmp_ge_u32 s51, 20
  s_cselect_b32 s51, 60, 0
  s_add_u32 s51, s51, s49
  s_add_u32 s51, s51, 4
  s_mul_i32 s51, s51, 3456
  s_add_u32 s51, s51, s56
  buffer_load_dwordx2 v[244:245], v26, s[52:55], s51 offen
  s_add_u32 s51, s50, 5
  s_cmp_ge_u32 s51, 20
  s_cselect_b32 s51, 60, 0
  s_add_u32 s51, s51, s49
  s_add_u32 s51, s51, 5
  s_mul_i32 s51, s51, 3456
  s_add_u32 s51, s51, s56
  buffer_load_dwordx2 v[246:247], v26, s[52:55], s51 offen
  s_add_u32 s51, s50, 6
  s_cmp_ge_u32 s51, 20
  s_cselect_b32 s51, 60, 0
  s_add_u32 s51, s51, s49
  s_add_u32 s51, s51, 6
  s_mul_i32 s51, s51, 3456
  s_add_u32 s51, s51, s56
  buffer_load_dwordx2 v[248:249], v26, s[52:55], s51 offen
  s_add_u32 s51, s50, 7
  s_cmp_ge_u32 s51, 20
  s_cselect_b32 s51, 60, 0
  s_add_u32 s51, s51, s49
  s_add_u32 s51, s51, 7
  s_mul_i32 s51, s51, 3456
  s_add_u32 s51, s51, s56
  buffer_load_dwordx2 v[250:251], v26, s[52:55], s51 offen
  s_branch Lsequential_preLN__linear_kernel_hedgehog__geglu_ffn__prompt_kernel_r0_dn
Lsequential_preLN__linear_kernel_hedgehog__geglu_ffn__prompt_kernel_r0_dw:
  s_cmp_eq_u32 s44, 3
  s_cselect_b32 s52, s66, s72
  s_cselect_b32 s53, s67, s73
  s_mov_b32 s54, 2211840
  s_cselect_b32 s54, 819200, s54
  s_mul_i32 s51, s48, 40
  s_add_u32 s61, s49, s51
  s_mul_i32 s51, s48, 10
  s_add_u32 s49, s49, s51
  s_mul_i32 s51, s50, 40
  s_add_u32 s57, s49, s51
  s_lshl_b32 s58, s47, 5
  s_lshl_b32 s51, s48, 2
  s_add_u32 s58, s58, s51
  s_add_u32 s51, s57, 0
  s_add_u32 s59, s61, 8
  s_cmp_eq_u32 s50, 4
  s_cselect_b32 s51, s59, s51
  s_add_u32 s59, s58, 0
  s_cmp_eq_u32 s44, 2
  s_cselect_b32 s51, s59, s51
  s_mul_i32 s51, s51, 1280
  s_add_u32 s51, s51, s56
  buffer_load_dwordx2 v[236:237], v26, s[52:55], s51 offen
  s_add_u32 s51, s57, 1
  s_add_u32 s59, s61, 9
  s_cmp_eq_u32 s50, 4
  s_cselect_b32 s51, s59, s51
  s_add_u32 s59, s58, 1
  s_cmp_eq_u32 s44, 2
  s_cselect_b32 s51, s59, s51
  s_mul_i32 s51, s51, 1280
  s_add_u32 s51, s51, s56
  buffer_load_dwordx2 v[238:239], v26, s[52:55], s51 offen
  s_add_u32 s51, s57, 2
  s_add_u32 s59, s61, 18
  s_cmp_eq_u32 s50, 4
  s_cselect_b32 s51, s59, s51
  s_add_u32 s59, s58, 2
  s_cmp_eq_u32 s44, 2
  s_cselect_b32 s51, s59, s51
  s_mul_i32 s51, s51, 1280
  s_add_u32 s51, s51, s56
  buffer_load_dwordx2 v[240:241], v26, s[52:55], s51 offen
  s_add_u32 s51, s57, 3
  s_add_u32 s59, s61, 19
  s_cmp_eq_u32 s50, 4
  s_cselect_b32 s51, s59, s51
  s_add_u32 s59, s58, 3
  s_cmp_eq_u32 s44, 2
  s_cselect_b32 s51, s59, s51
  s_mul_i32 s51, s51, 1280
  s_add_u32 s51, s51, s56
  buffer_load_dwordx2 v[242:243], v26, s[52:55], s51 offen
  s_add_u32 s51, s57, 4
  s_add_u32 s59, s61, 28
  s_cmp_eq_u32 s50, 4
  s_cselect_b32 s51, s59, s51
  s_add_u32 s59, s58, 16
  s_cmp_eq_u32 s44, 2
  s_cselect_b32 s51, s59, s51
  s_mul_i32 s51, s51, 1280
  s_add_u32 s51, s51, s56
  buffer_load_dwordx2 v[244:245], v26, s[52:55], s51 offen
  s_add_u32 s51, s57, 5
  s_add_u32 s59, s61, 29
  s_cmp_eq_u32 s50, 4
  s_cselect_b32 s51, s59, s51
  s_add_u32 s59, s58, 17
  s_cmp_eq_u32 s44, 2
  s_cselect_b32 s51, s59, s51
  s_mul_i32 s51, s51, 1280
  s_add_u32 s51, s51, s56
  buffer_load_dwordx2 v[246:247], v26, s[52:55], s51 offen
  s_add_u32 s51, s57, 6
  s_add_u32 s59, s61, 38
  s_cmp_eq_u32 s50, 4
  s_cselect_b32 s51, s59, s51
  s_add_u32 s59, s58, 18
  s_cmp_eq_u32 s44, 2
  s_cselect_b32 s51, s59, s51
  s_mul_i32 s51, s51, 1280
  s_add_u32 s51, s51, s56
  buffer_load_dwordx2 v[248:249], v26, s[52:55], s51 offen
  s_add_u32 s51, s57, 7
  s_add_u32 s59, s61, 39
  s_cmp_eq_u32 s50, 4
  s_cselect_b32 s51, s59, s51
  s_add_u32 s59, s58, 19
  s_cmp_eq_u32 s44, 2
  s_cselect_b32 s51, s59, s51
  s_mul_i32 s51, s51, 1280
  s_add_u32 s51, s51, s56
  buffer_load_dwordx2 v[250:251], v26, s[52:55], s51 offen
  s_branch Lsequential_preLN__linear_kernel_hedgehog__geglu_ffn__prompt_kernel_r0_dn
Lsequential_preLN__linear_kernel_hedgehog__geglu_ffn__prompt_kernel_r0_wb:
  s_mov_b32 s52, s66
  s_mov_b32 s53, s67
  s_mov_b32 s54, 819200
  s_mul_i32 s51, s45, 5120
  buffer_load_dwordx4 v[236:239], v28, s[52:55], s51 offen offset:0
  buffer_load_dwordx4 v[240:243], v28, s[52:55], s51 offen offset:256
  buffer_load_dwordx4 v[244:247], v28, s[52:55], s51 offen offset:512
  buffer_load_dwordx4 v[248:251], v28, s[52:55], s51 offen offset:768
  buffer_load_dwordx4 v[252:255], v28, s[52:55], s51 offen offset:1024
  buffer_load_dword v27, v28, s[52:55], s51 offen
  buffer_load_dword v27, v28, s[52:55], s51 offen
  buffer_load_dword v27, v28, s[52:55], s51 offen
  s_branch Lsequential_preLN__linear_kernel_hedgehog__geglu_ffn__prompt_kernel_r0_dn
Lsequential_preLN__linear_kernel_hedgehog__geglu_ffn__prompt_kernel_r0_no:
  buffer_load_dword v27, v26, s[12:15], 0 offen
  buffer_load_dword v27, v26, s[12:15], 0 offen
  buffer_load_dword v27, v26, s[12:15], 0 offen
  buffer_load_dword v27, v26, s[12:15], 0 offen
  buffer_load_dword v27, v26, s[12:15], 0 offen
  buffer_load_dword v27, v26, s[12:15], 0 offen
  buffer_load_dword v27, v26, s[12:15], 0 offen
  buffer_load_dword v27, v26, s[12:15], 0 offen
Lsequential_preLN__linear_kernel_hedgehog__geglu_ffn__prompt_kernel_r0_dn:
  s_waitcnt vmcnt(16)
  s_barrier
  s_mov_b32 s44, 5
  s_mov_b32 s45, 0
  s_mov_b32 s46, 0
  s_cmp_ge_u32 s17, 560
  s_cselect_b32 s49, 560, 0
  s_cselect_b32 s44, 1, 0
  s_sub_u32 s49, s17, s49
  s_mul_i32 s45, s49, 9363
  s_lshr_b32 s45, s45, 16
  s_mul_i32 s50, s45, 7
  s_sub_u32 s46, s49, s50
  s_cmp_ge_u32 s17, 1768
  s_cselect_b32 s50, 3, 2
  s_cselect_b32 s49, 648, 0
  s_add_u32 s49, s49, 1120
  s_sub_u32 s49, s17, s49
  s_mul_i32 s51, s49, 21846
  s_lshr_b32 s51, s51, 16
  s_mul_i32 s52, s51, 3
  s_sub_u32 s52, s49, s52
  s_cmp_ge_u32 s17, 1120
  s_cselect_b32 s44, s50, s44
  s_cselect_b32 s45, s51, s45
  s_cselect_b32 s46, s52, s46
  s_sub_u32 s49, s17, 2008
  s_cmp_ge_u32 s17, 2008
  s_cselect_b32 s44, 4, s44
  s_cselect_b32 s45, s49, s45
  s_cmp_ge_u32 s17, 2168
  s_cselect_b32 s44, 5, s44
  s_lshr_b32 s47, s45, 2
  s_and_b32 s48, s45, 3
  s_mov_b32 s55, 0x20000
  s_lshl_b32 s56, s46, 9
  s_cmp_eq_u32 s44, 4
  s_cbranch_scc1 Lsequential_preLN__linear_kernel_hedgehog__geglu_ffn__prompt_kernel_r1_wb
  s_cmp_eq_u32 s44, 5
  s_cbranch_scc1 Lsequential_preLN__linear_kernel_hedgehog__geglu_ffn__prompt_kernel_r1_no
  s_mul_i32 s49, s47, 13
  s_lshr_b32 s49, s49, 6
  s_mul_i32 s50, s49, 5
  s_sub_u32 s50, s47, s50
  s_mul_i32 s49, s49, 160
  s_cmp_ge_u32 s44, 2
  s_cbranch_scc1 Lsequential_preLN__linear_kernel_hedgehog__geglu_ffn__prompt_kernel_r1_dw
  s_cmp_eq_u32 s44, 1
  s_cselect_b32 s52, s70, s68
  s_cselect_b32 s53, s71, s69
  s_mov_b32 s54, 2211840
  s_mul_i32 s51, s48, 20
  s_add_u32 s49, s49, s51
  s_lshl_b32 s50, s50, 3
  s_add_u32 s49, s49, s50
  s_add_u32 s51, s50, 0
  s_cmp_ge_u32 s51, 20
  s_cselect_b32 s51, 60, 0
  s_add_u32 s51, s51, s49
  s_mul_i32 s51, s51, 3456
  s_add_u32 s51, s51, s56
  buffer_load_dwordx2 v[152:153], v26, s[52:55], s51 offen
  s_add_u32 s51, s50, 1
  s_cmp_ge_u32 s51, 20
  s_cselect_b32 s51, 60, 0
  s_add_u32 s51, s51, s49
  s_add_u32 s51, s51, 1
  s_mul_i32 s51, s51, 3456
  s_add_u32 s51, s51, s56
  buffer_load_dwordx2 v[154:155], v26, s[52:55], s51 offen
  s_add_u32 s51, s50, 2
  s_cmp_ge_u32 s51, 20
  s_cselect_b32 s51, 60, 0
  s_add_u32 s51, s51, s49
  s_add_u32 s51, s51, 2
  s_mul_i32 s51, s51, 3456
  s_add_u32 s51, s51, s56
  buffer_load_dwordx2 v[156:157], v26, s[52:55], s51 offen
  s_add_u32 s51, s50, 3
  s_cmp_ge_u32 s51, 20
  s_cselect_b32 s51, 60, 0
  s_add_u32 s51, s51, s49
  s_add_u32 s51, s51, 3
  s_mul_i32 s51, s51, 3456
  s_add_u32 s51, s51, s56
  buffer_load_dwordx2 v[158:159], v26, s[52:55], s51 offen
  s_add_u32 s51, s50, 4
  s_cmp_ge_u32 s51, 20
  s_cselect_b32 s51, 60, 0
  s_add_u32 s51, s51, s49
  s_add_u32 s51, s51, 4
  s_mul_i32 s51, s51, 3456
  s_add_u32 s51, s51, s56
  buffer_load_dwordx2 v[160:161], v26, s[52:55], s51 offen
  s_add_u32 s51, s50, 5
  s_cmp_ge_u32 s51, 20
  s_cselect_b32 s51, 60, 0
  s_add_u32 s51, s51, s49
  s_add_u32 s51, s51, 5
  s_mul_i32 s51, s51, 3456
  s_add_u32 s51, s51, s56
  buffer_load_dwordx2 v[162:163], v26, s[52:55], s51 offen
  s_add_u32 s51, s50, 6
  s_cmp_ge_u32 s51, 20
  s_cselect_b32 s51, 60, 0
  s_add_u32 s51, s51, s49
  s_add_u32 s51, s51, 6
  s_mul_i32 s51, s51, 3456
  s_add_u32 s51, s51, s56
  buffer_load_dwordx2 v[164:165], v26, s[52:55], s51 offen
  s_add_u32 s51, s50, 7
  s_cmp_ge_u32 s51, 20
  s_cselect_b32 s51, 60, 0
  s_add_u32 s51, s51, s49
  s_add_u32 s51, s51, 7
  s_mul_i32 s51, s51, 3456
  s_add_u32 s51, s51, s56
  buffer_load_dwordx2 v[166:167], v26, s[52:55], s51 offen
  s_branch Lsequential_preLN__linear_kernel_hedgehog__geglu_ffn__prompt_kernel_r1_dn
Lsequential_preLN__linear_kernel_hedgehog__geglu_ffn__prompt_kernel_r1_dw:
  s_cmp_eq_u32 s44, 3
  s_cselect_b32 s52, s66, s72
  s_cselect_b32 s53, s67, s73
  s_mov_b32 s54, 2211840
  s_cselect_b32 s54, 819200, s54
  s_mul_i32 s51, s48, 40
  s_add_u32 s61, s49, s51
  s_mul_i32 s51, s48, 10
  s_add_u32 s49, s49, s51
  s_mul_i32 s51, s50, 40
  s_add_u32 s57, s49, s51
  s_lshl_b32 s58, s47, 5
  s_lshl_b32 s51, s48, 2
  s_add_u32 s58, s58, s51
  s_add_u32 s51, s57, 0
  s_add_u32 s59, s61, 8
  s_cmp_eq_u32 s50, 4
  s_cselect_b32 s51, s59, s51
  s_add_u32 s59, s58, 0
  s_cmp_eq_u32 s44, 2
  s_cselect_b32 s51, s59, s51
  s_mul_i32 s51, s51, 1280
  s_add_u32 s51, s51, s56
  buffer_load_dwordx2 v[152:153], v26, s[52:55], s51 offen
  s_add_u32 s51, s57, 1
  s_add_u32 s59, s61, 9
  s_cmp_eq_u32 s50, 4
  s_cselect_b32 s51, s59, s51
  s_add_u32 s59, s58, 1
  s_cmp_eq_u32 s44, 2
  s_cselect_b32 s51, s59, s51
  s_mul_i32 s51, s51, 1280
  s_add_u32 s51, s51, s56
  buffer_load_dwordx2 v[154:155], v26, s[52:55], s51 offen
  s_add_u32 s51, s57, 2
  s_add_u32 s59, s61, 18
  s_cmp_eq_u32 s50, 4
  s_cselect_b32 s51, s59, s51
  s_add_u32 s59, s58, 2
  s_cmp_eq_u32 s44, 2
  s_cselect_b32 s51, s59, s51
  s_mul_i32 s51, s51, 1280
  s_add_u32 s51, s51, s56
  buffer_load_dwordx2 v[156:157], v26, s[52:55], s51 offen
  s_add_u32 s51, s57, 3
  s_add_u32 s59, s61, 19
  s_cmp_eq_u32 s50, 4
  s_cselect_b32 s51, s59, s51
  s_add_u32 s59, s58, 3
  s_cmp_eq_u32 s44, 2
  s_cselect_b32 s51, s59, s51
  s_mul_i32 s51, s51, 1280
  s_add_u32 s51, s51, s56
  buffer_load_dwordx2 v[158:159], v26, s[52:55], s51 offen
  s_add_u32 s51, s57, 4
  s_add_u32 s59, s61, 28
  s_cmp_eq_u32 s50, 4
  s_cselect_b32 s51, s59, s51
  s_add_u32 s59, s58, 16
  s_cmp_eq_u32 s44, 2
  s_cselect_b32 s51, s59, s51
  s_mul_i32 s51, s51, 1280
  s_add_u32 s51, s51, s56
  buffer_load_dwordx2 v[160:161], v26, s[52:55], s51 offen
  s_add_u32 s51, s57, 5
  s_add_u32 s59, s61, 29
  s_cmp_eq_u32 s50, 4
  s_cselect_b32 s51, s59, s51
  s_add_u32 s59, s58, 17
  s_cmp_eq_u32 s44, 2
  s_cselect_b32 s51, s59, s51
  s_mul_i32 s51, s51, 1280
  s_add_u32 s51, s51, s56
  buffer_load_dwordx2 v[162:163], v26, s[52:55], s51 offen
  s_add_u32 s51, s57, 6
  s_add_u32 s59, s61, 38
  s_cmp_eq_u32 s50, 4
  s_cselect_b32 s51, s59, s51
  s_add_u32 s59, s58, 18
  s_cmp_eq_u32 s44, 2
  s_cselect_b32 s51, s59, s51
  s_mul_i32 s51, s51, 1280
  s_add_u32 s51, s51, s56
  buffer_load_dwordx2 v[164:165], v26, s[52:55], s51 offen
  s_add_u32 s51, s57, 7
  s_add_u32 s59, s61, 39
  s_cmp_eq_u32 s50, 4
  s_cselect_b32 s51, s59, s51
  s_add_u32 s59, s58, 19
  s_cmp_eq_u32 s44, 2
  s_cselect_b32 s51, s59, s51
  s_mul_i32 s51, s51, 1280
  s_add_u32 s51, s51, s56
  buffer_load_dwordx2 v[166:167], v26, s[52:55], s51 offen
  s_branch Lsequential_preLN__linear_kernel_hedgehog__geglu_ffn__prompt_kernel_r1_dn
Lsequential_preLN__linear_kernel_hedgehog__geglu_ffn__prompt_kernel_r1_wb:
  s_mov_b32 s52, s66
  s_mov_b32 s53, s67
  s_mov_b32 s54, 819200
  s_mul_i32 s51, s45, 5120
  buffer_load_dwordx4 v[152:155], v28, s[52:55], s51 offen offset:0
  buffer_load_dwordx4 v[156:159], v28, s[52:55], s51 offen offset:256
  buffer_load_dwordx4 v[160:163], v28, s[52:55], s51 offen offset:512
  buffer_load_dwordx4 v[164:167], v28, s[52:55], s51 offen offset:768
  buffer_load_dwordx4 v[168:171], v28, s[52:55], s51 offen offset:1024
  buffer_load_dword v27, v28, s[52:55], s51 offen
  buffer_load_dword v27, v28, s[52:55], s51 offen
  buffer_load_dword v27, v28, s[52:55], s51 offen
  s_branch Lsequential_preLN__linear_kernel_hedgehog__geglu_ffn__prompt_kernel_r1_dn
Lsequential_preLN__linear_kernel_hedgehog__geglu_ffn__prompt_kernel_r1_no:
  buffer_load_dword v27, v26, s[12:15], 0 offen
  buffer_load_dword v27, v26, s[12:15], 0 offen
  buffer_load_dword v27, v26, s[12:15], 0 offen
  buffer_load_dword v27, v26, s[12:15], 0 offen
  buffer_load_dword v27, v26, s[12:15], 0 offen
  buffer_load_dword v27, v26, s[12:15], 0 offen
  buffer_load_dword v27, v26, s[12:15], 0 offen
  buffer_load_dword v27, v26, s[12:15], 0 offen
Lsequential_preLN__linear_kernel_hedgehog__geglu_ffn__prompt_kernel_r1_dn:
  s_waitcnt vmcnt(16)
  s_barrier
  s_waitcnt lgkmcnt(0)
  s_barrier
  s_barrier
  s_mul_i32 s31, s25, 9216
  v_lshlrev_b32 v228, 4, v1
  v_add_u32 v228, s31, v228
  ds_read_b128 v[112:115], v228 offset:40960
  ds_read_b128 v[116:119], v228 offset:41984
  ds_read_b128 v[120:123], v228 offset:43008
  ds_read_b128 v[124:127], v228 offset:44032
  ds_read_b128 v[128:131], v228 offset:45056
  ds_read_b128 v[132:135], v228 offset:46080
  ds_read_b128 v[136:139], v228 offset:47104
  ds_read_b128 v[140:143], v228 offset:48128
  s_lshl_b32 s31, s25, 11
  s_add_u32 s31, s31, 77824
  v_lshlrev_b32 v229, 4, v1
  v_add_u32 v229, s31, v229
  ds_read_b128 v[212:215], v229
  ds_read_b128 v[204:207], v229 offset:1024
  s_waitcnt lgkmcnt(0)
Lsequential_preLN__linear_kernel_hedgehog__geglu_ffn__prompt_kernel_epi:
  s_nop 7
  v_and_b32 v33, 3, v21
  v_cmp_eq_u32 vcc, 1, v33
  s_nop 1
  v_cndmask_b32 v34, v212, v213, vcc
  v_cmp_eq_u32 vcc, 2, v33
  s_nop 1
  v_cndmask_b32 v34, v34, v214, vcc
  v_cmp_eq_u32 vcc, 3, v33
  s_nop 1
  v_cndmask_b32 v34, v34, v215, vcc
  v_lshrrev_b32 v33, 2, v21
  v_cmp_eq_u32 vcc, v33, v3
  s_nop 1
  v_cndmask_b32 v34, 0, v34, vcc
  v_lshlrev_b32 v40, 4, v3
  v_add_u32 v40, 161664, v40
  ds_read_b128 v[44:47], v40 offset:0
  ds_read_b128 v[48:51], v40 offset:64
  ds_read_b128 v[52:55], v40 offset:128
  ds_read_b128 v[56:59], v40 offset:192
  ds_read_b128 v[60:63], v40 offset:256
  ds_read_b128 v[64:67], v40 offset:320
  ds_read_b128 v[68:71], v40 offset:384
  ds_read_b128 v[72:75], v40 offset:448
  v_mov_b32 v35, v34
  s_nop 1
  v_permlane16_swap_b32 v35, v34
  v_add_f32 v34, v34, v35
  v_mov_b32 v35, v34
  s_nop 1
  v_permlane32_swap_b32 v35, v34
  v_add_f32 v34, v34, v35
  v_mul_f32 v32, 0x3acccccd, v204
  v_mul_f32 v34, 0x3acccccd, v34
  v_fma_f32 v34, -v32, v32, v34
  v_max_f32 v34, 0, v34
  v_cvt_pk_bf16_f32 v33, v34, v34
  v_lshlrev_b32 v34, 16, v33
  v_add_f32 v34, 0x3727c5ac, v34
  v_cvt_pk_bf16_f32 v33, v34, v34
  v_lshlrev_b32 v34, 16, v33
  v_sqrt_f32 v34, v34
  s_nop 0
  v_cvt_pk_bf16_f32 v33, v34, v34
  v_lshlrev_b32 v34, 16, v33
  v_rcp_f32 v34, v34
  v_cvt_pk_bf16_f32 v35, v32, v32
  v_lshlrev_b32 v33, 16, v35
  s_cmp_lg_u32 s24, 0
  s_cbranch_scc1 Lsequential_preLN__linear_kernel_hedgehog__geglu_ffn__prompt_kernel_nomean
  v_add_u32 v41, s26, v21
  v_lshlrev_b32 v41, 2, v41
  s_mov_b32 s31, 24559616
  buffer_store_dword v32, v41, s[12:15], s31 offen sc0 sc1
Lsequential_preLN__linear_kernel_hedgehog__geglu_ffn__prompt_kernel_nomean:
  v_lshrrev_b32 v42, 2, v21
  v_and_b32 v43, 3, v21
  v_mul_u32_u24 v43, 48, v43
  v_and_b32 v41, 1, v3
  v_mul_u32_u24 v41, 960, v41
  v_add_u32 v41, v41, v43
  v_add_u32 v41, 158720, v41
  v_cmp_eq_u32 vcc, v42, v3
  v_mov_b32 v43, 160640
  s_nop 0
  v_cndmask_b32 v41, v43, v41, vcc
  ds_read_b128 v[176:179], v41 offset:0
  ds_read_b128 v[180:183], v41 offset:16
  ds_read_b128 v[184:187], v41 offset:32
  ds_read_b128 v[188:191], v41 offset:192
  ds_read_b128 v[192:195], v41 offset:208
  ds_read_b128 v[196:199], v41 offset:224
  ds_read_b128 v[200:203], v41 offset:384
  ds_read_b128 v[204:207], v41 offset:400
  ds_read_b128 v[208:211], v41 offset:416
  ds_read_b128 v[212:215], v41 offset:576
  ds_read_b128 v[216:219], v41 offset:592
  ds_read_b128 v[220:223], v41 offset:608
  ds_read_b128 v[224:227], v41 offset:768
  ds_read_b128 v[228:231], v41 offset:784
  ds_read_b128 v[232:235], v41 offset:800
  s_waitcnt lgkmcnt(15)
  v_pk_fma_f32 v[112:113], v[32:33], v[44:45], v[112:113] op_sel:[1,0,0] op_sel_hi:[1,1,1] neg_lo:[1,0,0] neg_hi:[1,0,0]
  v_pk_fma_f32 v[114:115], v[32:33], v[46:47], v[114:115] op_sel:[1,0,0] op_sel_hi:[1,1,1] neg_lo:[1,0,0] neg_hi:[1,0,0]
  v_pk_fma_f32 v[116:117], v[32:33], v[48:49], v[116:117] op_sel:[1,0,0] op_sel_hi:[1,1,1] neg_lo:[1,0,0] neg_hi:[1,0,0]
  v_pk_fma_f32 v[118:119], v[32:33], v[50:51], v[118:119] op_sel:[1,0,0] op_sel_hi:[1,1,1] neg_lo:[1,0,0] neg_hi:[1,0,0]
  v_pk_fma_f32 v[120:121], v[32:33], v[52:53], v[120:121] op_sel:[1,0,0] op_sel_hi:[1,1,1] neg_lo:[1,0,0] neg_hi:[1,0,0]
  v_pk_fma_f32 v[122:123], v[32:33], v[54:55], v[122:123] op_sel:[1,0,0] op_sel_hi:[1,1,1] neg_lo:[1,0,0] neg_hi:[1,0,0]
  v_pk_fma_f32 v[124:125], v[32:33], v[56:57], v[124:125] op_sel:[1,0,0] op_sel_hi:[1,1,1] neg_lo:[1,0,0] neg_hi:[1,0,0]
  v_pk_fma_f32 v[126:127], v[32:33], v[58:59], v[126:127] op_sel:[1,0,0] op_sel_hi:[1,1,1] neg_lo:[1,0,0] neg_hi:[1,0,0]
  v_pk_fma_f32 v[128:129], v[32:33], v[60:61], v[128:129] op_sel:[1,0,0] op_sel_hi:[1,1,1] neg_lo:[1,0,0] neg_hi:[1,0,0]
  v_pk_fma_f32 v[130:131], v[32:33], v[62:63], v[130:131] op_sel:[1,0,0] op_sel_hi:[1,1,1] neg_lo:[1,0,0] neg_hi:[1,0,0]
  v_pk_fma_f32 v[132:133], v[32:33], v[64:65], v[132:133] op_sel:[1,0,0] op_sel_hi:[1,1,1] neg_lo:[1,0,0] neg_hi:[1,0,0]
  v_pk_fma_f32 v[134:135], v[32:33], v[66:67], v[134:135] op_sel:[1,0,0] op_sel_hi:[1,1,1] neg_lo:[1,0,0] neg_hi:[1,0,0]
  v_pk_fma_f32 v[136:137], v[32:33], v[68:69], v[136:137] op_sel:[1,0,0] op_sel_hi:[1,1,1] neg_lo:[1,0,0] neg_hi:[1,0,0]
  v_pk_fma_f32 v[138:139], v[32:33], v[70:71], v[138:139] op_sel:[1,0,0] op_sel_hi:[1,1,1] neg_lo:[1,0,0] neg_hi:[1,0,0]
  v_pk_fma_f32 v[140:141], v[32:33], v[72:73], v[140:141] op_sel:[1,0,0] op_sel_hi:[1,1,1] neg_lo:[1,0,0] neg_hi:[1,0,0]
  v_pk_fma_f32 v[142:143], v[32:33], v[74:75], v[142:143] op_sel:[1,0,0] op_sel_hi:[1,1,1] neg_lo:[1,0,0] neg_hi:[1,0,0]
  v_pk_mul_f32 v[132:133], v[132:133], v[34:35] op_sel_hi:[1,0]
  v_pk_mul_f32 v[134:135], v[134:135], v[34:35] op_sel_hi:[1,0]
  v_pk_mul_f32 v[136:137], v[136:137], v[34:35] op_sel_hi:[1,0]
  v_pk_mul_f32 v[138:139], v[138:139], v[34:35] op_sel_hi:[1,0]
  v_pk_mul_f32 v[140:141], v[140:141], v[34:35] op_sel_hi:[1,0]
  v_pk_mul_f32 v[142:143], v[142:143], v[34:35] op_sel_hi:[1,0]
  v_cvt_pk_bf16_f32 v76, v112, v113
  v_cvt_pk_bf16_f32 v77, v114, v115
  v_cvt_pk_bf16_f32 v78, v116, v117
  v_cvt_pk_bf16_f32 v79, v118, v119
  v_cvt_pk_bf16_f32 v80, v120, v121
  v_cvt_pk_bf16_f32 v81, v122, v123
  v_cvt_pk_bf16_f32 v82, v124, v125
  v_cvt_pk_bf16_f32 v83, v126, v127
  v_cvt_pk_bf16_f32 v84, v128, v129
  v_cvt_pk_bf16_f32 v85, v130, v131
  v_mov_b32 v86, 0
  v_mov_b32 v87, 0
  v_cvt_pk_bf16_f32 v88, v132, v133
  v_cvt_pk_bf16_f32 v89, v134, v135
  v_cvt_pk_bf16_f32 v90, v136, v137
  v_cvt_pk_bf16_f32 v91, v138, v139
  v_cvt_pk_bf16_f32 v92, v140, v141
  v_cvt_pk_bf16_f32 v93, v142, v143
  v_cmp_eq_u32 vcc, 2, v3
  v_mov_b32 v42, 0x3f80
  s_nop 0
  v_cndmask_b32 v42, 0, v42, vcc
  v_cmp_gt_u32 vcc, 2, v3
  s_nop 1
  v_cndmask_b32 v92, v42, v92, vcc
  v_cndmask_b32 v93, 0, v93, vcc
  s_waitcnt lgkmcnt(0)
  v_mfma_f32_16x16x32_bf16 v[112:115], v[176:179], v[76:79], 0
  v_mfma_f32_16x16x32_bf16 v[116:119], v[188:191], v[76:79], 0
  v_mfma_f32_16x16x32_bf16 v[120:123], v[200:203], v[76:79], 0
  v_mfma_f32_16x16x32_bf16 v[124:127], v[212:215], v[76:79], 0
  v_mfma_f32_16x16x32_bf16 v[128:131], v[224:227], v[76:79], 0
  v_mfma_f32_16x16x32_bf16 v[112:115], v[180:183], v[80:83], v[112:115]
  v_mfma_f32_16x16x32_bf16 v[116:119], v[192:195], v[80:83], v[116:119]
  v_mfma_f32_16x16x32_bf16 v[120:123], v[204:207], v[80:83], v[120:123]
  v_mfma_f32_16x16x32_bf16 v[124:127], v[216:219], v[80:83], v[124:127]
  v_mfma_f32_16x16x32_bf16 v[128:131], v[228:231], v[80:83], v[128:131]
  v_mfma_f32_16x16x32_bf16 v[112:115], v[184:187], v[84:87], v[112:115]
  v_mfma_f32_16x16x32_bf16 v[116:119], v[196:199], v[84:87], v[116:119]
  v_mfma_f32_16x16x32_bf16 v[120:123], v[208:211], v[84:87], v[120:123]
  v_mfma_f32_16x16x32_bf16 v[124:127], v[220:223], v[84:87], v[124:127]
  v_mfma_f32_16x16x32_bf16 v[128:131], v[232:235], v[84:87], v[128:131]
  v_add_u32 v42, s19, v21
  v_mul_u32_u24 v43, 96, v42
  v_lshl_add_u32 v43, v3, 3, v43
  ds_write_b64 v43, v[88:89] offset:20480
  ds_write_b64 v43, v[90:91] offset:20512
  ds_write_b64 v43, v[92:93] offset:20544
  v_mul_f32 v100, 0x3fb8aa3b, v34
  v_max3_f32 v94, v112, v113, v114
  v_min3_f32 v95, v112, v113, v114
  v_max3_f32 v94, v94, v115, v116
  v_min3_f32 v95, v95, v115, v116
  v_max3_f32 v94, v94, v117, v118
  v_min3_f32 v95, v95, v117, v118
  v_max3_f32 v94, v94, v119, v120
  v_min3_f32 v95, v95, v119, v120
  v_max3_f32 v94, v94, v121, v122
  v_min3_f32 v95, v95, v121, v122
  v_max3_f32 v94, v94, v123, v124
  v_min3_f32 v95, v95, v123, v124
  v_max3_f32 v94, v94, v125, v126
  v_min3_f32 v95, v95, v125, v126
  v_max3_f32 v94, v94, v127, v128
  v_min3_f32 v95, v95, v127, v128
  v_max3_f32 v94, v94, v129, v130
  v_min3_f32 v95, v95, v129, v130
  v_max_f32 v94, v94, v131
  v_min_f32 v95, v95, v131
  v_mul_f32 v94, v100, v94
  v_mul_f32 v95, v100, v95
  v_pk_fma_f32 v[176:177], v[112:113], v[100:101], v[94:95] op_sel:[0,0,0] op_sel_hi:[1,0,0] neg_lo:[0,0,1] neg_hi:[0,0,1]
  v_pk_fma_f32 v[196:197], v[112:113], v[100:101], v[94:95] op_sel:[0,0,1] op_sel_hi:[1,0,1] neg_lo:[1,0,0] neg_hi:[1,0,0]
  v_pk_fma_f32 v[178:179], v[114:115], v[100:101], v[94:95] op_sel:[0,0,0] op_sel_hi:[1,0,0] neg_lo:[0,0,1] neg_hi:[0,0,1]
  v_pk_fma_f32 v[198:199], v[114:115], v[100:101], v[94:95] op_sel:[0,0,1] op_sel_hi:[1,0,1] neg_lo:[1,0,0] neg_hi:[1,0,0]
  v_pk_fma_f32 v[180:181], v[116:117], v[100:101], v[94:95] op_sel:[0,0,0] op_sel_hi:[1,0,0] neg_lo:[0,0,1] neg_hi:[0,0,1]
  v_pk_fma_f32 v[200:201], v[116:117], v[100:101], v[94:95] op_sel:[0,0,1] op_sel_hi:[1,0,1] neg_lo:[1,0,0] neg_hi:[1,0,0]
  v_pk_fma_f32 v[182:183], v[118:119], v[100:101], v[94:95] op_sel:[0,0,0] op_sel_hi:[1,0,0] neg_lo:[0,0,1] neg_hi:[0,0,1]
  v_pk_fma_f32 v[202:203], v[118:119], v[100:101], v[94:95] op_sel:[0,0,1] op_sel_hi:[1,0,1] neg_lo:[1,0,0] neg_hi:[1,0,0]
  v_pk_fma_f32 v[184:185], v[120:121], v[100:101], v[94:95] op_sel:[0,0,0] op_sel_hi:[1,0,0] neg_lo:[0,0,1] neg_hi:[0,0,1]
  v_pk_fma_f32 v[204:205], v[120:121], v[100:101], v[94:95] op_sel:[0,0,1] op_sel_hi:[1,0,1] neg_lo:[1,0,0] neg_hi:[1,0,0]
  v_pk_fma_f32 v[186:187], v[122:123], v[100:101], v[94:95] op_sel:[0,0,0] op_sel_hi:[1,0,0] neg_lo:[0,0,1] neg_hi:[0,0,1]
  v_pk_fma_f32 v[206:207], v[122:123], v[100:101], v[94:95] op_sel:[0,0,1] op_sel_hi:[1,0,1] neg_lo:[1,0,0] neg_hi:[1,0,0]
  v_pk_fma_f32 v[188:189], v[124:125], v[100:101], v[94:95] op_sel:[0,0,0] op_sel_hi:[1,0,0] neg_lo:[0,0,1] neg_hi:[0,0,1]
  v_pk_fma_f32 v[208:209], v[124:125], v[100:101], v[94:95] op_sel:[0,0,1] op_sel_hi:[1,0,1] neg_lo:[1,0,0] neg_hi:[1,0,0]
  v_pk_fma_f32 v[190:191], v[126:127], v[100:101], v[94:95] op_sel:[0,0,0] op_sel_hi:[1,0,0] neg_lo:[0,0,1] neg_hi:[0,0,1]
  v_pk_fma_f32 v[210:211], v[126:127], v[100:101], v[94:95] op_sel:[0,0,1] op_sel_hi:[1,0,1] neg_lo:[1,0,0] neg_hi:[1,0,0]
  v_pk_fma_f32 v[192:193], v[128:129], v[100:101], v[94:95] op_sel:[0,0,0] op_sel_hi:[1,0,0] neg_lo:[0,0,1] neg_hi:[0,0,1]
  v_pk_fma_f32 v[212:213], v[128:129], v[100:101], v[94:95] op_sel:[0,0,1] op_sel_hi:[1,0,1] neg_lo:[1,0,0] neg_hi:[1,0,0]
  v_pk_fma_f32 v[194:195], v[130:131], v[100:101], v[94:95] op_sel:[0,0,0] op_sel_hi:[1,0,0] neg_lo:[0,0,1] neg_hi:[0,0,1]
  v_pk_fma_f32 v[214:215], v[130:131], v[100:101], v[94:95] op_sel:[0,0,1] op_sel_hi:[1,0,1] neg_lo:[1,0,0] neg_hi:[1,0,0]
  v_exp_f32 v176, v176
  v_exp_f32 v196, v196
  v_exp_f32 v177, v177
  v_exp_f32 v197, v197
  v_exp_f32 v178, v178
  v_exp_f32 v198, v198
  v_exp_f32 v179, v179
  v_exp_f32 v199, v199
  v_exp_f32 v180, v180
  v_exp_f32 v200, v200
  v_exp_f32 v181, v181
  v_exp_f32 v201, v201
  v_exp_f32 v182, v182
  v_exp_f32 v202, v202
  v_exp_f32 v183, v183
  v_exp_f32 v203, v203
  v_exp_f32 v184, v184
  v_exp_f32 v204, v204
  v_exp_f32 v185, v185
  v_exp_f32 v205, v205
  v_exp_f32 v186, v186
  v_exp_f32 v206, v206
  v_exp_f32 v187, v187
  v_exp_f32 v207, v207
  v_exp_f32 v188, v188
  v_exp_f32 v208, v208
  v_exp_f32 v189, v189
  v_exp_f32 v209, v209
  v_exp_f32 v190, v190
  v_exp_f32 v210, v210
  v_exp_f32 v191, v191
  v_exp_f32 v211, v211
  v_exp_f32 v192, v192
  v_exp_f32 v212, v212
  v_exp_f32 v193, v193
  v_exp_f32 v213, v213
  v_exp_f32 v194, v194
  v_exp_f32 v214, v214
  v_exp_f32 v195, v195
  v_exp_f32 v215, v215
  v_pk_add_f32 v[96:97], v[176:177], v[178:179]
  v_pk_add_f32 v[98:99], v[196:197], v[198:199]
  v_pk_add_f32 v[96:97], v[96:97], v[180:181]
  v_pk_add_f32 v[98:99], v[98:99], v[200:201]
  v_pk_add_f32 v[96:97], v[96:97], v[182:183]
  v_pk_add_f32 v[98:99], v[98:99], v[202:203]
  v_pk_add_f32 v[96:97], v[96:97], v[184:185]
  v_pk_add_f32 v[98:99], v[98:99], v[204:205]
  v_pk_add_f32 v[96:97], v[96:97], v[186:187]
  v_pk_add_f32 v[98:99], v[98:99], v[206:207]
  v_pk_add_f32 v[96:97], v[96:97], v[188:189]
  v_pk_add_f32 v[98:99], v[98:99], v[208:209]
  v_pk_add_f32 v[96:97], v[96:97], v[190:191]
  v_pk_add_f32 v[98:99], v[98:99], v[210:211]
  v_pk_add_f32 v[96:97], v[96:97], v[192:193]
  v_pk_add_f32 v[98:99], v[98:99], v[212:213]
  v_pk_add_f32 v[96:97], v[96:97], v[194:195]
  v_pk_add_f32 v[98:99], v[98:99], v[214:215]
  v_add_f32 v96, v96, v97
  v_add_f32 v98, v98, v99
  v_rcp_f32 v96, v96
  v_rcp_f32 v98, v98
  v_pk_mul_f32 v[176:177], v[176:177], v[96:97] op_sel_hi:[1,0]
  v_pk_mul_f32 v[196:197], v[196:197], v[98:99] op_sel_hi:[1,0]
  v_pk_mul_f32 v[178:179], v[178:179], v[96:97] op_sel_hi:[1,0]
  v_pk_mul_f32 v[198:199], v[198:199], v[98:99] op_sel_hi:[1,0]
  v_pk_mul_f32 v[180:181], v[180:181], v[96:97] op_sel_hi:[1,0]
  v_pk_mul_f32 v[200:201], v[200:201], v[98:99] op_sel_hi:[1,0]
  v_pk_mul_f32 v[182:183], v[182:183], v[96:97] op_sel_hi:[1,0]
  v_pk_mul_f32 v[202:203], v[202:203], v[98:99] op_sel_hi:[1,0]
  v_pk_mul_f32 v[184:185], v[184:185], v[96:97] op_sel_hi:[1,0]
  v_pk_mul_f32 v[204:205], v[204:205], v[98:99] op_sel_hi:[1,0]
  v_pk_mul_f32 v[186:187], v[186:187], v[96:97] op_sel_hi:[1,0]
  v_pk_mul_f32 v[206:207], v[206:207], v[98:99] op_sel_hi:[1,0]
  v_pk_mul_f32 v[188:189], v[188:189], v[96:97] op_sel_hi:[1,0]
  v_pk_mul_f32 v[208:209], v[208:209], v[98:99] op_sel_hi:[1,0]
  v_pk_mul_f32 v[190:191], v[190:191], v[96:97] op_sel_hi:[1,0]
  v_pk_mul_f32 v[210:211], v[210:211], v[98:99] op_sel_hi:[1,0]
  v_pk_mul_f32 v[192:193], v[192:193], v[96:97] op_sel_hi:[1,0]
  v_pk_mul_f32 v[212:213], v[212:213], v[98:99] op_sel_hi:[1,0]
  v_pk_mul_f32 v[194:195], v[194:195], v[96:97] op_sel_hi:[1,0]
  v_pk_mul_f32 v[214:215], v[214:215], v[98:99] op_sel_hi:[1,0]
  v_cvt_pk_bf16_f32 v44, v176, v177
  v_cvt_pk_bf16_f32 v45, v178, v179
  v_cvt_pk_bf16_f32 v46, v180, v181
  v_cvt_pk_bf16_f32 v47, v182, v183
  v_cvt_pk_bf16_f32 v48, v184, v185
  v_cvt_pk_bf16_f32 v49, v186, v187
  v_cvt_pk_bf16_f32 v50, v188, v189
  v_cvt_pk_bf16_f32 v51, v190, v191
  v_cvt_pk_bf16_f32 v52, v192, v193
  v_cvt_pk_bf16_f32 v53, v194, v195
  v_cvt_pk_bf16_f32 v54, v196, v197
  v_cvt_pk_bf16_f32 v55, v198, v199
  v_cvt_pk_bf16_f32 v56, v200, v201
  v_cvt_pk_bf16_f32 v57, v202, v203
  v_cvt_pk_bf16_f32 v58, v204, v205
  v_cvt_pk_bf16_f32 v59, v206, v207
  v_cvt_pk_bf16_f32 v60, v208, v209
  v_cvt_pk_bf16_f32 v61, v210, v211
  v_cvt_pk_bf16_f32 v62, v212, v213
  v_cvt_pk_bf16_f32 v63, v214, v215
  v_mul_u32_u24 v43, 160, v42
  v_and_b32 v41, 1, v3
  v_mul_u32_u24 v41, 80, v41
  v_add_u32 v43, v43, v41
  s_mov_b32 exec_lo, 0
  ds_write_b128 v43, v[44:47] offset:0
  ds_write_b128 v43, v[48:51] offset:16
  ds_write_b128 v43, v[52:55] offset:32
  ds_write_b128 v43, v[56:59] offset:48
  ds_write_b128 v43, v[60:63] offset:64
  s_mov_b64 exec, -1
  s_mov_b32 s52, 0x22111000
  s_mov_b32 s53, 0x44444332
  s_mov_b32 s54, 0x10210210
  s_mov_b32 s55, 0x22221212
  s_lshl_b32 s56, s22, 3
  s_lshr_b64 s[52:53], s[52:53], s56
  s_lshr_b64 s[54:55], s[54:55], s56
  v_lshrrev_b32 v64, 2, v21
  v_lshl_add_u32 v64, v3, 2, v64
  v_and_b32 v65, 3, v21
  v_lshlrev_b32 v65, 3, v65
  v_mul_u32_u24 v66, 160, v64
  v_add_u32 v66, v66, v65
  v_mul_u32_u24 v67, 96, v64
  v_add_u32 v67, v67, v65
  v_add_u32 v67, 20480, v67
  s_lshr_b32 s57, s52, 0
  s_and_b32 s57, s57, 15
  s_lshl_b32 s58, s57, 5
  s_lshr_b32 s59, s54, 0
  s_and_b32 s59, s59, 15
  s_lshl_b32 s60, s59, 5
  v_add_u32 v68, s58, v66
  v_add_u32 v69, s60, v67
  s_lshl_b32 s61, s57, 4
  v_lshl_add_u32 v74, v3, 2, s61
  s_lshl_b32 s61, s59, 4
  v_add_u32 v75, s61, v21
  v_cmp_le_u32 vcc, 40, v74
  s_nop 1
  v_cndmask_b32 v76, 0, 1, vcc
  v_mul_u32_u24 v77, 40, v76
  v_sub_u32 v74, v74, v77
  v_mul_u32_u24 v77, 20, v76
  v_sub_u32 v77, v75, v77
  v_cmp_eq_u32 vcc, 40, v75
  v_mov_b32 v72, 20
  s_nop 0
  v_cndmask_b32 v77, v77, v72, vcc
  v_cmp_gt_u32 s[62:63], 20, v77
  v_cmp_gt_u32 s[74:75], 40, v75
  s_nop 3
  s_and_b64 s[62:63], s[62:63], s[74:75]
  s_or_b64 s[62:63], s[62:63], vcc
  v_mul_u32_u24 v72, 21, v76
  v_add_u32 v72, v72, v77
  v_mul_u32_u24 v72, 160, v72
  v_lshl_add_u32 v72, v74, 2, v72
  v_mov_b32 v74, 0x40000000
  v_cndmask_b32 v72, v74, v72, s[62:63]
  s_lshl_b32 s61, s22, 1
  s_add_u32 s61, s61, 0
  s_cmp_ge_u32 s61, 13
  s_cselect_b64 vcc, -1, 0
  v_cndmask_b32 v72, v72, v74, vcc
  s_lshr_b32 s57, s52, 4
  s_and_b32 s57, s57, 15
  s_lshl_b32 s58, s57, 5
  s_lshr_b32 s59, s54, 4
  s_and_b32 s59, s59, 15
  s_lshl_b32 s60, s59, 5
  v_add_u32 v70, s58, v66
  v_add_u32 v71, s60, v67
  s_lshl_b32 s61, s57, 4
  v_lshl_add_u32 v74, v3, 2, s61
  s_lshl_b32 s61, s59, 4
  v_add_u32 v75, s61, v21
  v_cmp_le_u32 vcc, 40, v74
  s_nop 1
  v_cndmask_b32 v76, 0, 1, vcc
  v_mul_u32_u24 v77, 40, v76
  v_sub_u32 v74, v74, v77
  v_mul_u32_u24 v77, 20, v76
  v_sub_u32 v77, v75, v77
  v_cmp_eq_u32 vcc, 40, v75
  v_mov_b32 v73, 20
  s_nop 0
  v_cndmask_b32 v77, v77, v73, vcc
  v_cmp_gt_u32 s[62:63], 20, v77
  v_cmp_gt_u32 s[74:75], 40, v75
  s_nop 3
  s_and_b64 s[62:63], s[62:63], s[74:75]
  s_or_b64 s[62:63], s[62:63], vcc
  v_mul_u32_u24 v73, 21, v76
  v_add_u32 v73, v73, v77
  v_mul_u32_u24 v73, 160, v73
  v_lshl_add_u32 v73, v74, 2, v73
  v_mov_b32 v74, 0x40000000
  v_cndmask_b32 v73, v74, v73, s[62:63]
  s_lshl_b32 s61, s22, 1
  s_add_u32 s61, s61, 1
  s_cmp_ge_u32 s61, 13
  s_cselect_b64 vcc, -1, 0
  v_cndmask_b32 v73, v73, v74, vcc
  s_waitcnt lgkmcnt(0)
  s_barrier
  ds_read_b64_tr_b16 v[80:81], v68 offset:0
  ds_read_b64_tr_b16 v[112:113], v69 offset:0
  ds_read_b64_tr_b16 v[82:83], v68 offset:2560
  ds_read_b64_tr_b16 v[114:115], v69 offset:1536
  ds_read_b64_tr_b16 v[84:85], v68 offset:5120
  ds_read_b64_tr_b16 v[116:117], v69 offset:3072
  ds_read_b64_tr_b16 v[86:87], v68 offset:7680
  ds_read_b64_tr_b16 v[118:119], v69 offset:4608
  ds_read_b64_tr_b16 v[88:89], v68 offset:10240
  ds_read_b64_tr_b16 v[120:121], v69 offset:6144
  ds_read_b64_tr_b16 v[90:91], v68 offset:12800
  ds_read_b64_tr_b16 v[122:123], v69 offset:7680
  ds_read_b64_tr_b16 v[92:93], v68 offset:15360
  ds_read_b64_tr_b16 v[124:125], v69 offset:9216
  ds_read_b64_tr_b16 v[94:95], v68 offset:17920
  ds_read_b64_tr_b16 v[126:127], v69 offset:10752
  ds_read_b64_tr_b16 v[96:97], v70 offset:0
  ds_read_b64_tr_b16 v[128:129], v71 offset:0
  ds_read_b64_tr_b16 v[98:99], v70 offset:2560
  ds_read_b64_tr_b16 v[130:131], v71 offset:1536
  ds_read_b64_tr_b16 v[100:101], v70 offset:5120
  ds_read_b64_tr_b16 v[132:133], v71 offset:3072
  ds_read_b64_tr_b16 v[102:103], v70 offset:7680
  ds_read_b64_tr_b16 v[134:135], v71 offset:4608
  ds_read_b64_tr_b16 v[104:105], v70 offset:10240
  ds_read_b64_tr_b16 v[136:137], v71 offset:6144
  ds_read_b64_tr_b16 v[106:107], v70 offset:12800
  ds_read_b64_tr_b16 v[138:139], v71 offset:7680
  ds_read_b64_tr_b16 v[108:109], v70 offset:15360
  ds_read_b64_tr_b16 v[140:141], v71 offset:9216
  ds_read_b64_tr_b16 v[110:111], v70 offset:17920
  ds_read_b64_tr_b16 v[142:143], v71 offset:10752
  s_lshl_b32 s31, s24, 4
  s_add_u32 s31, s31, s23
  s_mul_i32 s31, s31, 8192
  s_add_u32 s31, s31, 22462464
  s_waitcnt lgkmcnt(15)
  v_mfma_f32_16x16x32_bf16 v[144:147], v[80:83], v[112:115], 0
  v_mfma_f32_16x16x32_bf16 v[144:147], v[84:87], v[116:119], v[144:147]
  v_mfma_f32_16x16x32_bf16 v[144:147], v[88:91], v[120:123], v[144:147]
  v_mfma_f32_16x16x32_bf16 v[144:147], v[92:95], v[124:127], v[144:147]
  s_waitcnt lgkmcnt(0)
  v_mfma_f32_16x16x32_bf16 v[148:151], v[96:99], v[128:131], 0
  v_mfma_f32_16x16x32_bf16 v[148:151], v[100:103], v[132:135], v[148:151]
  v_mfma_f32_16x16x32_bf16 v[148:151], v[104:107], v[136:139], v[148:151]
  v_mfma_f32_16x16x32_bf16 v[148:151], v[108:111], v[140:143], v[148:151]
  s_nop 2
  buffer_store_dwordx4 v[144:147], v72, s[12:15], s31 offen sc0 sc1
  s_nop 3
  buffer_store_dwordx4 v[148:151], v73, s[12:15], s31 offen sc0 sc1
  s_waitcnt vmcnt(0)
  s_barrier
  v_mov_b32 v8, 0
  v_mov_b32 v9, 0
  v_mov_b32 v10, 0
  v_mov_b32 v11, 0
  v_lshlrev_b32 v12, 4, v0
  ds_write_b128 v12, v[8:11] offset:32768
  ds_write_b128 v12, v[8:11] offset:40960
  s_cmp_lg_u32 s22, 0
  s_cbranch_scc1 Lsequential_preLN__linear_kernel_hedgehog__geglu_ffn__prompt_kernel_a0
  s_cmp_lg_u32 s96, 0
  s_cbranch_scc1 Lsequential_preLN__linear_kernel_hedgehog__geglu_ffn__prompt_kernel_n3
  v_mov_b32 v8, 0
  s_mov_b32 s97, 0
Lsequential_preLN__linear_kernel_hedgehog__geglu_ffn__prompt_kernel_n2:
  global_load_dword v9, v8, s[98:99] sc1
  s_add_u32 s97, s97, 1
  s_waitcnt vmcnt(0)
  v_readfirstlane_b32 s96, v9
  s_cmp_gt_u32 s97, 0x40000
  s_cbranch_scc1 Lsequential_preLN__linear_kernel_hedgehog__geglu_ffn__prompt_kernel_n3
  s_nop 1
  s_cmp_eq_u32 s96, 0
  s_cbranch_scc1 Lsequential_preLN__linear_kernel_hedgehog__geglu_ffn__prompt_kernel_n2
Lsequential_preLN__linear_kernel_hedgehog__geglu_ffn__prompt_kernel_n3:
  s_lshl_b32 s33, s24, 4
  s_add_u32 s33, s33, s23
  s_lshl_b32 s31, s33, 7
  s_add_u32 s31, s31, 24641536
  v_mov_b32 v8, 0
  v_mov_b32 v9, s96
  s_mov_b64 exec, 1
  buffer_store_dword v9, v8, s[12:15], s31 offen sc0 sc1
  s_mov_b64 exec, -1
  v_mov_b32 v8, 163824
  v_mov_b32 v9, s96
  ds_write_b32 v8, v9
  v_mov_b32 v9, 0
  ds_write_b32 v8, v9 offset:4
  ds_write_b32 v8, v9 offset:8
Lsequential_preLN__linear_kernel_hedgehog__geglu_ffn__prompt_kernel_a0:
  s_lshl_b32 s60, s22, 12
  s_add_u32 s60, s60, 98304
  s_cmp_ge_u32 s16, 2168
  s_cbranch_scc1 Lsequential_preLN__linear_kernel_hedgehog__geglu_ffn__prompt_kernel_f0x
  s_mov_b32 s44, 5
  s_mov_b32 s45, 0
  s_mov_b32 s46, 0
  s_cmp_ge_u32 s16, 560
  s_cselect_b32 s49, 560, 0
  s_cselect_b32 s44, 1, 0
  s_sub_u32 s49, s16, s49
  s_mul_i32 s45, s49, 9363
  s_lshr_b32 s45, s45, 16
  s_mul_i32 s50, s45, 7
  s_sub_u32 s46, s49, s50
  s_cmp_ge_u32 s16, 1768
  s_cselect_b32 s50, 3, 2
  s_cselect_b32 s49, 648, 0
  s_add_u32 s49, s49, 1120
  s_sub_u32 s49, s16, s49
  s_mul_i32 s51, s49, 21846
  s_lshr_b32 s51, s51, 16
  s_mul_i32 s52, s51, 3
  s_sub_u32 s52, s49, s52
  s_cmp_ge_u32 s16, 1120
  s_cselect_b32 s44, s50, s44
  s_cselect_b32 s45, s51, s45
  s_cselect_b32 s46, s52, s46
  s_sub_u32 s49, s16, 2008
  s_cmp_ge_u32 s16, 2008
  s_cselect_b32 s44, 4, s44
  s_cselect_b32 s45, s49, s45
  s_cmp_ge_u32 s16, 2168
  s_cselect_b32 s44, 5, s44
  s_lshr_b32 s47, s45, 2
  s_and_b32 s48, s45, 3
  s_cmp_eq_u32 s44, 4
  s_cbranch_scc1 Lsequential_preLN__linear_kernel_hedgehog__geglu_ffn__prompt_kernel_f0_wb
  s_cmp_eq_u32 s44, 5
  s_cbranch_scc1 Lsequential_preLN__linear_kernel_hedgehog__geglu_ffn__prompt_kernel_f0_no
  s_mov_b32 s52, 0x05040100
  s_mov_b32 s53, 0x07060302
  v_perm_b32 v64, v238, v236, s52
  v_perm_b32 v65, v242, v240, s52
  v_perm_b32 v66, v246, v244, s52
  v_perm_b32 v67, v250, v248, s52
  v_perm_b32 v68, v238, v236, s53
  v_perm_b32 v69, v242, v240, s53
  v_perm_b32 v70, v246, v244, s53
  v_perm_b32 v71, v250, v248, s53
  v_perm_b32 v72, v239, v237, s52
  v_perm_b32 v73, v243, v241, s52
  v_perm_b32 v74, v247, v245, s52
  v_perm_b32 v75, v251, v249, s52
  v_perm_b32 v76, v239, v237, s53
  v_perm_b32 v77, v243, v241, s53
  v_perm_b32 v78, v247, v245, s53
  v_perm_b32 v79, v251, v249, s53
  v_lshlrev_b32 v80, 6, v1
  v_add_u32 v80, s60, v80
  ds_write_b128 v80, v[64:67] offset:0
  ds_write_b128 v80, v[68:71] offset:16
  ds_write_b128 v80, v[72:75] offset:32
  ds_write_b128 v80, v[76:79] offset:48
  v_lshlrev_b32 v80, 4, v1
  v_add_u32 v80, s60, v80
  s_cmp_ge_u32 s44, 2
  s_cbranch_scc1 Lsequential_preLN__linear_kernel_hedgehog__geglu_ffn__prompt_kernel_f0_dw
  v_mul_u32_u24 v84, 40960, v3
  v_lshl_add_u32 v84, v21, 4, v84
  s_mul_i32 s49, s46, 655360
  s_lshl_b32 s50, s47, 11
  s_add_u32 s49, s49, s50
  s_lshl_b32 s50, s44, 10
  s_add_u32 s49, s49, s50
  s_lshl_b32 s50, s48, 8
  s_add_u32 s49, s49, s50
  s_add_u32 s49, s49, 15761408
  s_waitcnt lgkmcnt(0)
  ds_read_b128 v[64:67], v80 offset:0
  ds_read_b128 v[68:71], v80 offset:1024
  ds_read_b128 v[72:75], v80 offset:2048
  ds_read_b128 v[76:79], v80 offset:3072
  s_waitcnt lgkmcnt(0)
  s_add_u32 s50, s49, 0
  buffer_store_dwordx4 v[64:67], v84, s[12:15], s50 offen sc0 sc1
  s_add_u32 s50, s49, 163840
  buffer_store_dwordx4 v[68:71], v84, s[12:15], s50 offen sc0 sc1
  s_add_u32 s50, s49, 327680
  buffer_store_dwordx4 v[72:75], v84, s[12:15], s50 offen sc0 sc1
  s_add_u32 s50, s49, 491520
  s_cmp_eq_u32 s46, 6
  s_cselect_b32 s50, 0x7ff00000, s50
  buffer_store_dwordx4 v[76:79], v84, s[12:15], s50 offen sc0 sc1
  s_branch Lsequential_preLN__linear_kernel_hedgehog__geglu_ffn__prompt_kernel_f0_dn
Lsequential_preLN__linear_kernel_hedgehog__geglu_ffn__prompt_kernel_f0_dw:
  s_cmp_eq_u32 s44, 3
  s_mov_b32 s51, 270
  s_cselect_b32 s51, 100, s51
  s_mov_b32 s49, 20185088
  s_cselect_b32 s49, 14942208, s49
  s_mul_i32 s50, s47, 5120
  s_add_u32 s49, s49, s50
  s_lshl_b32 s50, s48, 8
  s_add_u32 s49, s49, s50
  s_lshl_b32 s50, s46, 6
  v_lshrrev_b32 v81, 2, v1
  v_add_u32 v81, s50, v81
  v_and_b32 v82, 3, v1
  v_lshlrev_b32 v82, 4, v82
  v_add_u32 v88, 0, v81
  v_mul_u32_u24 v89, 3277, v88
  v_lshrrev_b32 v89, 16, v89
  v_mul_u32_u24 v90, 20, v89
  v_sub_u32 v90, v88, v90
  v_mul_u32_u24 v91, 13108, v90
  v_lshrrev_b32 v91, 16, v91
  v_mul_u32_u24 v83, 5, v91
  v_sub_u32 v90, v90, v83
  v_mul_lo_u32 v89, v89, s51
  v_add_u32 v89, v89, v90
  v_lshlrev_b32 v89, 10, v89
  v_lshl_add_u32 v89, v91, 6, v89
  v_add_u32 v89, v89, v82
  v_mov_b32 v90, 0x7ff00000
  v_cmp_gt_u32 vcc, 160, v88
  s_nop 1
  v_cndmask_b32 v84, v90, v89, vcc
  v_add_u32 v88, 16, v81
  v_mul_u32_u24 v89, 3277, v88
  v_lshrrev_b32 v89, 16, v89
  v_mul_u32_u24 v90, 20, v89
  v_sub_u32 v90, v88, v90
  v_mul_u32_u24 v91, 13108, v90
  v_lshrrev_b32 v91, 16, v91
  v_mul_u32_u24 v83, 5, v91
  v_sub_u32 v90, v90, v83
  v_mul_lo_u32 v89, v89, s51
  v_add_u32 v89, v89, v90
  v_lshlrev_b32 v89, 10, v89
  v_lshl_add_u32 v89, v91, 6, v89
  v_add_u32 v89, v89, v82
  v_mov_b32 v90, 0x7ff00000
  v_cmp_gt_u32 vcc, 160, v88
  s_nop 1
  v_cndmask_b32 v85, v90, v89, vcc
  v_add_u32 v88, 32, v81
  v_mul_u32_u24 v89, 3277, v88
  v_lshrrev_b32 v89, 16, v89
  v_mul_u32_u24 v90, 20, v89
  v_sub_u32 v90, v88, v90
  v_mul_u32_u24 v91, 13108, v90
  v_lshrrev_b32 v91, 16, v91
  v_mul_u32_u24 v83, 5, v91
  v_sub_u32 v90, v90, v83
  v_mul_lo_u32 v89, v89, s51
  v_add_u32 v89, v89, v90
  v_lshlrev_b32 v89, 10, v89
  v_lshl_add_u32 v89, v91, 6, v89
  v_add_u32 v89, v89, v82
  v_mov_b32 v90, 0x7ff00000
  v_cmp_gt_u32 vcc, 160, v88
  s_nop 1
  v_cndmask_b32 v86, v90, v89, vcc
  v_add_u32 v88, 48, v81
  v_mul_u32_u24 v89, 3277, v88
  v_lshrrev_b32 v89, 16, v89
  v_mul_u32_u24 v90, 20, v89
  v_sub_u32 v90, v88, v90
  v_mul_u32_u24 v91, 13108, v90
  v_lshrrev_b32 v91, 16, v91
  v_mul_u32_u24 v83, 5, v91
  v_sub_u32 v90, v90, v83
  v_mul_lo_u32 v89, v89, s51
  v_add_u32 v89, v89, v90
  v_lshlrev_b32 v89, 10, v89
  v_lshl_add_u32 v89, v91, 6, v89
  v_add_u32 v89, v89, v82
  v_mov_b32 v90, 0x7ff00000
  v_cmp_gt_u32 vcc, 160, v88
  s_nop 1
  v_cndmask_b32 v87, v90, v89, vcc
  s_waitcnt lgkmcnt(0)
  ds_read_b128 v[64:67], v80 offset:0
  ds_read_b128 v[68:71], v80 offset:1024
  ds_read_b128 v[72:75], v80 offset:2048
  ds_read_b128 v[76:79], v80 offset:3072
  s_waitcnt lgkmcnt(0)
  buffer_store_dwordx4 v[64:67], v84, s[12:15], s49 offen sc0 sc1
  buffer_store_dwordx4 v[68:71], v85, s[12:15], s49 offen sc0 sc1
  buffer_store_dwordx4 v[72:75], v86, s[12:15], s49 offen sc0 sc1
  buffer_store_dwordx4 v[76:79], v87, s[12:15], s49 offen sc0 sc1
  s_branch Lsequential_preLN__linear_kernel_hedgehog__geglu_ffn__prompt_kernel_f0_dn
Lsequential_preLN__linear_kernel_hedgehog__geglu_ffn__prompt_kernel_f0_wb:
  v_mov_b32 v64, 0
  v_mov_b32 v65, 0
  v_lshlrev_b32 v66, 16, v236
  v_and_b32 v67, 0xffff0000, v236
  v_add_f32 v64, v64, v66
  v_add_f32 v65, v65, v67
  v_lshlrev_b32 v66, 16, v237
  v_and_b32 v67, 0xffff0000, v237
  v_add_f32 v64, v64, v66
  v_add_f32 v65, v65, v67
  v_lshlrev_b32 v66, 16, v238
  v_and_b32 v67, 0xffff0000, v238
  v_add_f32 v64, v64, v66
  v_add_f32 v65, v65, v67
  v_lshlrev_b32 v66, 16, v239
  v_and_b32 v67, 0xffff0000, v239
  v_add_f32 v64, v64, v66
  v_add_f32 v65, v65, v67
  v_lshlrev_b32 v66, 16, v240
  v_and_b32 v67, 0xffff0000, v240
  v_add_f32 v64, v64, v66
  v_add_f32 v65, v65, v67
  v_lshlrev_b32 v66, 16, v241
  v_and_b32 v67, 0xffff0000, v241
  v_add_f32 v64, v64, v66
  v_add_f32 v65, v65, v67
  v_lshlrev_b32 v66, 16, v242
  v_and_b32 v67, 0xffff0000, v242
  v_add_f32 v64, v64, v66
  v_add_f32 v65, v65, v67
  v_lshlrev_b32 v66, 16, v243
  v_and_b32 v67, 0xffff0000, v243
  v_add_f32 v64, v64, v66
  v_add_f32 v65, v65, v67
  v_lshlrev_b32 v66, 16, v244
  v_and_b32 v67, 0xffff0000, v244
  v_add_f32 v64, v64, v66
  v_add_f32 v65, v65, v67
  v_lshlrev_b32 v66, 16, v245
  v_and_b32 v67, 0xffff0000, v245
  v_add_f32 v64, v64, v66
  v_add_f32 v65, v65, v67
  v_lshlrev_b32 v66, 16, v246
  v_and_b32 v67, 0xffff0000, v246
  v_add_f32 v64, v64, v66
  v_add_f32 v65, v65, v67
  v_lshlrev_b32 v66, 16, v247
  v_and_b32 v67, 0xffff0000, v247
  v_add_f32 v64, v64, v66
  v_add_f32 v65, v65, v67
  v_lshlrev_b32 v66, 16, v248
  v_and_b32 v67, 0xffff0000, v248
  v_add_f32 v64, v64, v66
  v_add_f32 v65, v65, v67
  v_lshlrev_b32 v66, 16, v249
  v_and_b32 v67, 0xffff0000, v249
  v_add_f32 v64, v64, v66
  v_add_f32 v65, v65, v67
  v_lshlrev_b32 v66, 16, v250
  v_and_b32 v67, 0xffff0000, v250
  v_add_f32 v64, v64, v66
  v_add_f32 v65, v65, v67
  v_lshlrev_b32 v66, 16, v251
  v_and_b32 v67, 0xffff0000, v251
  v_add_f32 v64, v64, v66
  v_add_f32 v65, v65, v67
  v_lshlrev_b32 v66, 16, v252
  v_and_b32 v67, 0xffff0000, v252
  v_add_f32 v64, v64, v66
  v_add_f32 v65, v65, v67
  v_lshlrev_b32 v66, 16, v253
  v_and_b32 v67, 0xffff0000, v253
  v_add_f32 v64, v64, v66
  v_add_f32 v65, v65, v67
  v_lshlrev_b32 v66, 16, v254
  v_and_b32 v67, 0xffff0000, v254
  v_add_f32 v64, v64, v66
  v_add_f32 v65, v65, v67
  v_lshlrev_b32 v66, 16, v255
  v_and_b32 v67, 0xffff0000, v255
  v_add_f32 v64, v64, v66
  v_add_f32 v65, v65, v67
  v_add_f32 v64, v64, v65
  s_nop 1
  v_add_f32_dpp v65, v64, v64 row_ror:8 row_mask:0xf bank_mask:0xf
  v_mov_b32 v64, v65
  s_nop 1
  v_add_f32_dpp v65, v64, v64 row_ror:4 row_mask:0xf bank_mask:0xf
  v_mov_b32 v64, v65
  s_nop 1
  v_add_f32_dpp v65, v64, v64 row_ror:2 row_mask:0xf bank_mask:0xf
  v_mov_b32 v64, v65
  s_nop 1
  v_add_f32_dpp v65, v64, v64 row_ror:1 row_mask:0xf bank_mask:0xf
  v_mov_b32 v64, v65
  v_mul_f32 v64, 0x3acccccd, v64
  v_cvt_pk_bf16_f32 v64, v64, v64
  s_lshl_b32 s49, s45, 2
  v_add_u32 v68, s49, v3
  v_mul_u32_u24 v69, 410, v68
  v_lshrrev_b32 v69, 16, v69
  v_mul_u32_u24 v70, 160, v69
  v_sub_u32 v70, v68, v70
  v_mul_u32_u24 v71, 1639, v70
  v_lshrrev_b32 v71, 16, v71
  v_mul_u32_u24 v76, 40, v71
  v_sub_u32 v76, v70, v76
  v_mul_u32_u24 v77, 6554, v76
  v_lshrrev_b32 v77, 16, v77
  v_mul_u32_u24 v70, 10, v77
  v_sub_u32 v70, v76, v70
  v_cmp_gt_u32 vcc, 8, v70
  v_mov_b32 v76, 4
  s_nop 0
  v_cndmask_b32 v76, v76, v71, vcc
  v_lshl_add_u32 v72, v77, 1, v70
  v_subrev_u32 v72, 8, v72
  v_cndmask_b32 v72, v72, v70, vcc
  v_cndmask_b32 v71, v71, v77, vcc
  v_mul_u32_u24 v69, 5, v69
  v_add_u32 v69, v69, v76
  v_lshl_add_u32 v69, v69, 2, v71
  v_lshl_add_u32 v69, v69, 3, v72
  v_lshlrev_b32 v68, 1, v69
  v_add_u32 v68, 24633344, v68
  buffer_store_short v64, v68, s[12:15], 0 offen sc0 sc1
  buffer_store_short v64, v68, s[12:15], 0 offen sc0 sc1
  buffer_store_short v64, v68, s[12:15], 0 offen sc0 sc1
  buffer_store_short v64, v68, s[12:15], 0 offen sc0 sc1
  s_branch Lsequential_preLN__linear_kernel_hedgehog__geglu_ffn__prompt_kernel_f0_dn
Lsequential_preLN__linear_kernel_hedgehog__geglu_ffn__prompt_kernel_f0_no:
  v_mov_b32 v64, 37486336
  buffer_store_dword v64, v64, s[12:15], 0 offen
  buffer_store_dword v64, v64, s[12:15], 0 offen
  buffer_store_dword v64, v64, s[12:15], 0 offen
  buffer_store_dword v64, v64, s[12:15], 0 offen
Lsequential_preLN__linear_kernel_hedgehog__geglu_ffn__prompt_kernel_f0_dn:
Lsequential_preLN__linear_kernel_hedgehog__geglu_ffn__prompt_kernel_f0x:
  s_cmp_lt_u32 s22, 4
  s_cbranch_scc1 Lsequential_preLN__linear_kernel_hedgehog__geglu_ffn__prompt_kernel_f1x
  s_cmp_ge_u32 s17, 2168
  s_cbranch_scc1 Lsequential_preLN__linear_kernel_hedgehog__geglu_ffn__prompt_kernel_f1x
  s_mov_b32 s44, 5
  s_mov_b32 s45, 0
  s_mov_b32 s46, 0
  s_cmp_ge_u32 s17, 560
  s_cselect_b32 s49, 560, 0
  s_cselect_b32 s44, 1, 0
  s_sub_u32 s49, s17, s49
  s_mul_i32 s45, s49, 9363
  s_lshr_b32 s45, s45, 16
  s_mul_i32 s50, s45, 7
  s_sub_u32 s46, s49, s50
  s_cmp_ge_u32 s17, 1768
  s_cselect_b32 s50, 3, 2
  s_cselect_b32 s49, 648, 0
  s_add_u32 s49, s49, 1120
  s_sub_u32 s49, s17, s49
  s_mul_i32 s51, s49, 21846
  s_lshr_b32 s51, s51, 16
  s_mul_i32 s52, s51, 3
  s_sub_u32 s52, s49, s52
  s_cmp_ge_u32 s17, 1120
  s_cselect_b32 s44, s50, s44
  s_cselect_b32 s45, s51, s45
  s_cselect_b32 s46, s52, s46
  s_sub_u32 s49, s17, 2008
  s_cmp_ge_u32 s17, 2008
  s_cselect_b32 s44, 4, s44
  s_cselect_b32 s45, s49, s45
  s_cmp_ge_u32 s17, 2168
  s_cselect_b32 s44, 5, s44
  s_lshr_b32 s47, s45, 2
  s_and_b32 s48, s45, 3
  s_cmp_eq_u32 s44, 4
  s_cbranch_scc1 Lsequential_preLN__linear_kernel_hedgehog__geglu_ffn__prompt_kernel_f1_wb
  s_cmp_eq_u32 s44, 5
  s_cbranch_scc1 Lsequential_preLN__linear_kernel_hedgehog__geglu_ffn__prompt_kernel_f1_no
  s_mov_b32 s52, 0x05040100
  s_mov_b32 s53, 0x07060302
  v_perm_b32 v64, v154, v152, s52
  v_perm_b32 v65, v158, v156, s52
  v_perm_b32 v66, v162, v160, s52
  v_perm_b32 v67, v166, v164, s52
  v_perm_b32 v68, v154, v152, s53
  v_perm_b32 v69, v158, v156, s53
  v_perm_b32 v70, v162, v160, s53
  v_perm_b32 v71, v166, v164, s53
  v_perm_b32 v72, v155, v153, s52
  v_perm_b32 v73, v159, v157, s52
  v_perm_b32 v74, v163, v161, s52
  v_perm_b32 v75, v167, v165, s52
  v_perm_b32 v76, v155, v153, s53
  v_perm_b32 v77, v159, v157, s53
  v_perm_b32 v78, v163, v161, s53
  v_perm_b32 v79, v167, v165, s53
  v_lshlrev_b32 v80, 6, v1
  v_add_u32 v80, s60, v80
  ds_write_b128 v80, v[64:67] offset:0
  ds_write_b128 v80, v[68:71] offset:16
  ds_write_b128 v80, v[72:75] offset:32
  ds_write_b128 v80, v[76:79] offset:48
  v_lshlrev_b32 v80, 4, v1
  v_add_u32 v80, s60, v80
  s_cmp_ge_u32 s44, 2
  s_cbranch_scc1 Lsequential_preLN__linear_kernel_hedgehog__geglu_ffn__prompt_kernel_f1_dw
  v_mul_u32_u24 v84, 40960, v3
  v_lshl_add_u32 v84, v21, 4, v84
  s_mul_i32 s49, s46, 655360
  s_lshl_b32 s50, s47, 11
  s_add_u32 s49, s49, s50
  s_lshl_b32 s50, s44, 10
  s_add_u32 s49, s49, s50
  s_lshl_b32 s50, s48, 8
  s_add_u32 s49, s49, s50
  s_add_u32 s49, s49, 15761408
  s_waitcnt lgkmcnt(0)
  ds_read_b128 v[64:67], v80 offset:0
  ds_read_b128 v[68:71], v80 offset:1024
  ds_read_b128 v[72:75], v80 offset:2048
  ds_read_b128 v[76:79], v80 offset:3072
  s_waitcnt lgkmcnt(0)
  s_add_u32 s50, s49, 0
  buffer_store_dwordx4 v[64:67], v84, s[12:15], s50 offen sc0 sc1
  s_add_u32 s50, s49, 163840
  buffer_store_dwordx4 v[68:71], v84, s[12:15], s50 offen sc0 sc1
  s_add_u32 s50, s49, 327680
  buffer_store_dwordx4 v[72:75], v84, s[12:15], s50 offen sc0 sc1
  s_add_u32 s50, s49, 491520
  s_cmp_eq_u32 s46, 6
  s_cselect_b32 s50, 0x7ff00000, s50
  buffer_store_dwordx4 v[76:79], v84, s[12:15], s50 offen sc0 sc1
  s_branch Lsequential_preLN__linear_kernel_hedgehog__geglu_ffn__prompt_kernel_f1_dn
Lsequential_preLN__linear_kernel_hedgehog__geglu_ffn__prompt_kernel_f1_dw:
  s_cmp_eq_u32 s44, 3
  s_mov_b32 s51, 270
  s_cselect_b32 s51, 100, s51
  s_mov_b32 s49, 20185088
  s_cselect_b32 s49, 14942208, s49
  s_mul_i32 s50, s47, 5120
  s_add_u32 s49, s49, s50
  s_lshl_b32 s50, s48, 8
  s_add_u32 s49, s49, s50
  s_lshl_b32 s50, s46, 6
  v_lshrrev_b32 v81, 2, v1
  v_add_u32 v81, s50, v81
  v_and_b32 v82, 3, v1
  v_lshlrev_b32 v82, 4, v82
  v_add_u32 v88, 0, v81
  v_mul_u32_u24 v89, 3277, v88
  v_lshrrev_b32 v89, 16, v89
  v_mul_u32_u24 v90, 20, v89
  v_sub_u32 v90, v88, v90
  v_mul_u32_u24 v91, 13108, v90
  v_lshrrev_b32 v91, 16, v91
  v_mul_u32_u24 v83, 5, v91
  v_sub_u32 v90, v90, v83
  v_mul_lo_u32 v89, v89, s51
  v_add_u32 v89, v89, v90
  v_lshlrev_b32 v89, 10, v89
  v_lshl_add_u32 v89, v91, 6, v89
  v_add_u32 v89, v89, v82
  v_mov_b32 v90, 0x7ff00000
  v_cmp_gt_u32 vcc, 160, v88
  s_nop 1
  v_cndmask_b32 v84, v90, v89, vcc
  v_add_u32 v88, 16, v81
  v_mul_u32_u24 v89, 3277, v88
  v_lshrrev_b32 v89, 16, v89
  v_mul_u32_u24 v90, 20, v89
  v_sub_u32 v90, v88, v90
  v_mul_u32_u24 v91, 13108, v90
  v_lshrrev_b32 v91, 16, v91
  v_mul_u32_u24 v83, 5, v91
  v_sub_u32 v90, v90, v83
  v_mul_lo_u32 v89, v89, s51
  v_add_u32 v89, v89, v90
  v_lshlrev_b32 v89, 10, v89
  v_lshl_add_u32 v89, v91, 6, v89
  v_add_u32 v89, v89, v82
  v_mov_b32 v90, 0x7ff00000
  v_cmp_gt_u32 vcc, 160, v88
  s_nop 1
  v_cndmask_b32 v85, v90, v89, vcc
  v_add_u32 v88, 32, v81
  v_mul_u32_u24 v89, 3277, v88
  v_lshrrev_b32 v89, 16, v89
  v_mul_u32_u24 v90, 20, v89
  v_sub_u32 v90, v88, v90
  v_mul_u32_u24 v91, 13108, v90
  v_lshrrev_b32 v91, 16, v91
  v_mul_u32_u24 v83, 5, v91
  v_sub_u32 v90, v90, v83
  v_mul_lo_u32 v89, v89, s51
  v_add_u32 v89, v89, v90
  v_lshlrev_b32 v89, 10, v89
  v_lshl_add_u32 v89, v91, 6, v89
  v_add_u32 v89, v89, v82
  v_mov_b32 v90, 0x7ff00000
  v_cmp_gt_u32 vcc, 160, v88
  s_nop 1
  v_cndmask_b32 v86, v90, v89, vcc
  v_add_u32 v88, 48, v81
  v_mul_u32_u24 v89, 3277, v88
  v_lshrrev_b32 v89, 16, v89
  v_mul_u32_u24 v90, 20, v89
  v_sub_u32 v90, v88, v90
  v_mul_u32_u24 v91, 13108, v90
  v_lshrrev_b32 v91, 16, v91
  v_mul_u32_u24 v83, 5, v91
  v_sub_u32 v90, v90, v83
  v_mul_lo_u32 v89, v89, s51
  v_add_u32 v89, v89, v90
  v_lshlrev_b32 v89, 10, v89
  v_lshl_add_u32 v89, v91, 6, v89
  v_add_u32 v89, v89, v82
  v_mov_b32 v90, 0x7ff00000
  v_cmp_gt_u32 vcc, 160, v88
  s_nop 1
  v_cndmask_b32 v87, v90, v89, vcc
  s_waitcnt lgkmcnt(0)
  ds_read_b128 v[64:67], v80 offset:0
  ds_read_b128 v[68:71], v80 offset:1024
  ds_read_b128 v[72:75], v80 offset:2048
  ds_read_b128 v[76:79], v80 offset:3072
  s_waitcnt lgkmcnt(0)
  buffer_store_dwordx4 v[64:67], v84, s[12:15], s49 offen sc0 sc1
  buffer_store_dwordx4 v[68:71], v85, s[12:15], s49 offen sc0 sc1
  buffer_store_dwordx4 v[72:75], v86, s[12:15], s49 offen sc0 sc1
  buffer_store_dwordx4 v[76:79], v87, s[12:15], s49 offen sc0 sc1
  s_branch Lsequential_preLN__linear_kernel_hedgehog__geglu_ffn__prompt_kernel_f1_dn
Lsequential_preLN__linear_kernel_hedgehog__geglu_ffn__prompt_kernel_f1_wb:
  v_mov_b32 v64, 0
  v_mov_b32 v65, 0
  v_lshlrev_b32 v66, 16, v152
  v_and_b32 v67, 0xffff0000, v152
  v_add_f32 v64, v64, v66
  v_add_f32 v65, v65, v67
  v_lshlrev_b32 v66, 16, v153
  v_and_b32 v67, 0xffff0000, v153
  v_add_f32 v64, v64, v66
  v_add_f32 v65, v65, v67
  v_lshlrev_b32 v66, 16, v154
  v_and_b32 v67, 0xffff0000, v154
  v_add_f32 v64, v64, v66
  v_add_f32 v65, v65, v67
  v_lshlrev_b32 v66, 16, v155
  v_and_b32 v67, 0xffff0000, v155
  v_add_f32 v64, v64, v66
  v_add_f32 v65, v65, v67
  v_lshlrev_b32 v66, 16, v156
  v_and_b32 v67, 0xffff0000, v156
  v_add_f32 v64, v64, v66
  v_add_f32 v65, v65, v67
  v_lshlrev_b32 v66, 16, v157
  v_and_b32 v67, 0xffff0000, v157
  v_add_f32 v64, v64, v66
  v_add_f32 v65, v65, v67
  v_lshlrev_b32 v66, 16, v158
  v_and_b32 v67, 0xffff0000, v158
  v_add_f32 v64, v64, v66
  v_add_f32 v65, v65, v67
  v_lshlrev_b32 v66, 16, v159
  v_and_b32 v67, 0xffff0000, v159
  v_add_f32 v64, v64, v66
  v_add_f32 v65, v65, v67
  v_lshlrev_b32 v66, 16, v160
  v_and_b32 v67, 0xffff0000, v160
  v_add_f32 v64, v64, v66
  v_add_f32 v65, v65, v67
  v_lshlrev_b32 v66, 16, v161
  v_and_b32 v67, 0xffff0000, v161
  v_add_f32 v64, v64, v66
  v_add_f32 v65, v65, v67
  v_lshlrev_b32 v66, 16, v162
  v_and_b32 v67, 0xffff0000, v162
  v_add_f32 v64, v64, v66
  v_add_f32 v65, v65, v67
  v_lshlrev_b32 v66, 16, v163
  v_and_b32 v67, 0xffff0000, v163
  v_add_f32 v64, v64, v66
  v_add_f32 v65, v65, v67
  v_lshlrev_b32 v66, 16, v164
  v_and_b32 v67, 0xffff0000, v164
  v_add_f32 v64, v64, v66
  v_add_f32 v65, v65, v67
  v_lshlrev_b32 v66, 16, v165
  v_and_b32 v67, 0xffff0000, v165
  v_add_f32 v64, v64, v66
  v_add_f32 v65, v65, v67
  v_lshlrev_b32 v66, 16, v166
  v_and_b32 v67, 0xffff0000, v166
  v_add_f32 v64, v64, v66
  v_add_f32 v65, v65, v67
  v_lshlrev_b32 v66, 16, v167
  v_and_b32 v67, 0xffff0000, v167
  v_add_f32 v64, v64, v66
  v_add_f32 v65, v65, v67
  v_lshlrev_b32 v66, 16, v168
  v_and_b32 v67, 0xffff0000, v168
  v_add_f32 v64, v64, v66
  v_add_f32 v65, v65, v67
  v_lshlrev_b32 v66, 16, v169
  v_and_b32 v67, 0xffff0000, v169
  v_add_f32 v64, v64, v66
  v_add_f32 v65, v65, v67
  v_lshlrev_b32 v66, 16, v170
  v_and_b32 v67, 0xffff0000, v170
  v_add_f32 v64, v64, v66
  v_add_f32 v65, v65, v67
  v_lshlrev_b32 v66, 16, v171
  v_and_b32 v67, 0xffff0000, v171
  v_add_f32 v64, v64, v66
  v_add_f32 v65, v65, v67
  v_add_f32 v64, v64, v65
  s_nop 1
  v_add_f32_dpp v65, v64, v64 row_ror:8 row_mask:0xf bank_mask:0xf
  v_mov_b32 v64, v65
  s_nop 1
  v_add_f32_dpp v65, v64, v64 row_ror:4 row_mask:0xf bank_mask:0xf
  v_mov_b32 v64, v65
  s_nop 1
  v_add_f32_dpp v65, v64, v64 row_ror:2 row_mask:0xf bank_mask:0xf
  v_mov_b32 v64, v65
  s_nop 1
  v_add_f32_dpp v65, v64, v64 row_ror:1 row_mask:0xf bank_mask:0xf
  v_mov_b32 v64, v65
  v_mul_f32 v64, 0x3acccccd, v64
  v_cvt_pk_bf16_f32 v64, v64, v64
  s_lshl_b32 s49, s45, 2
  v_add_u32 v68, s49, v3
  v_mul_u32_u24 v69, 410, v68
  v_lshrrev_b32 v69, 16, v69
  v_mul_u32_u24 v70, 160, v69
  v_sub_u32 v70, v68, v70
  v_mul_u32_u24 v71, 1639, v70
  v_lshrrev_b32 v71, 16, v71
  v_mul_u32_u24 v76, 40, v71
  v_sub_u32 v76, v70, v76
  v_mul_u32_u24 v77, 6554, v76
  v_lshrrev_b32 v77, 16, v77
  v_mul_u32_u24 v70, 10, v77
  v_sub_u32 v70, v76, v70
  v_cmp_gt_u32 vcc, 8, v70
  v_mov_b32 v76, 4
  s_nop 0
  v_cndmask_b32 v76, v76, v71, vcc
  v_lshl_add_u32 v72, v77, 1, v70
  v_subrev_u32 v72, 8, v72
  v_cndmask_b32 v72, v72, v70, vcc
  v_cndmask_b32 v71, v71, v77, vcc
  v_mul_u32_u24 v69, 5, v69
  v_add_u32 v69, v69, v76
  v_lshl_add_u32 v69, v69, 2, v71
  v_lshl_add_u32 v69, v69, 3, v72
  v_lshlrev_b32 v68, 1, v69
  v_add_u32 v68, 24633344, v68
  buffer_store_short v64, v68, s[12:15], 0 offen sc0 sc1
  buffer_store_short v64, v68, s[12:15], 0 offen sc0 sc1
  buffer_store_short v64, v68, s[12:15], 0 offen sc0 sc1
  buffer_store_short v64, v68, s[12:15], 0 offen sc0 sc1
  s_branch Lsequential_preLN__linear_kernel_hedgehog__geglu_ffn__prompt_kernel_f1_dn
Lsequential_preLN__linear_kernel_hedgehog__geglu_ffn__prompt_kernel_f1_no:
  v_mov_b32 v64, 37486336
  buffer_store_dword v64, v64, s[12:15], 0 offen
  buffer_store_dword v64, v64, s[12:15], 0 offen
  buffer_store_dword v64, v64, s[12:15], 0 offen
  buffer_store_dword v64, v64, s[12:15], 0 offen
Lsequential_preLN__linear_kernel_hedgehog__geglu_ffn__prompt_kernel_f1_dn:
Lsequential_preLN__linear_kernel_hedgehog__geglu_ffn__prompt_kernel_f1x:
  s_cmp_lg_u32 s22, 0
  s_cbranch_scc1 Lsequential_preLN__linear_kernel_hedgehog__geglu_ffn__prompt_kernel_a1b
  s_lshl_b32 s33, s24, 4
  s_lshl_b32 s31, s33, 7
  s_add_u32 s31, s31, 24641536
  v_lshlrev_b32 v8, 7, v1
  s_mov_b32 s97, 0
  s_mov_b64 exec, 0xffff
  s_waitcnt vmcnt(0)
  buffer_load_dword v253, v8, s[12:15], s31 offen sc1
  s_sleep 2
  buffer_load_dword v254, v8, s[12:15], s31 offen sc1
Lsequential_preLN__linear_kernel_hedgehog__geglu_ffn__prompt_kernel_pa:
  s_waitcnt vmcnt(1)
  v_cmp_ne_u32 vcc, s96, v253
  s_cbranch_vccz Lsequential_preLN__linear_kernel_hedgehog__geglu_ffn__prompt_kernel_pa_x
  buffer_load_dword v253, v8, s[12:15], s31 offen sc1
  s_waitcnt vmcnt(1)
  v_cmp_ne_u32 vcc, s96, v254
  s_cbranch_vccz Lsequential_preLN__linear_kernel_hedgehog__geglu_ffn__prompt_kernel_pa_x
  buffer_load_dword v254, v8, s[12:15], s31 offen sc1
  s_add_u32 s97, s97, 1
  s_cmp_le_u32 s97, 0x20000
  s_cbranch_scc1 Lsequential_preLN__linear_kernel_hedgehog__geglu_ffn__prompt_kernel_pa
Lsequential_preLN__linear_kernel_hedgehog__geglu_ffn__prompt_kernel_pa_x:
  s_mov_b64 exec, -1
Lsequential_preLN__linear_kernel_hedgehog__geglu_ffn__prompt_kernel_a1b:
Lsequential_preLN__linear_kernel_hedgehog__geglu_ffn__prompt_kernel_a1:
  s_waitcnt lgkmcnt(0)
  s_barrier
  v_mov_b32 v8, 163824
  ds_read_b32 v9, v8
  s_waitcnt lgkmcnt(0)
  v_readfirstlane_b32 s96, v9
  v_min_u32 v64, 419, v0
  v_lshlrev_b32 v65, 4, v64
  s_lshl_b32 s31, s24, 4
  s_mul_i32 s31, s31, 8192
  s_add_u32 s31, s31, 22462464
  buffer_load_dwordx4 v[100:103], v65, s[12:15], s31 offen sc1
  s_add_u32 s31, s31, 8192
  buffer_load_dwordx4 v[104:107], v65, s[12:15], s31 offen sc1
  s_add_u32 s31, s31, 8192
  buffer_load_dwordx4 v[108:111], v65, s[12:15], s31 offen sc1
  s_add_u32 s31, s31, 8192
  buffer_load_dwordx4 v[112:115], v65, s[12:15], s31 offen sc1
  s_add_u32 s31, s31, 8192
  buffer_load_dwordx4 v[116:119], v65, s[12:15], s31 offen sc1
  s_add_u32 s31, s31, 8192
  buffer_load_dwordx4 v[120:123], v65, s[12:15], s31 offen sc1
  s_add_u32 s31, s31, 8192
  buffer_load_dwordx4 v[124:127], v65, s[12:15], s31 offen sc1
  s_add_u32 s31, s31, 8192
  buffer_load_dwordx4 v[128:131], v65, s[12:15], s31 offen sc1
  s_add_u32 s31, s31, 8192
  buffer_load_dwordx4 v[132:135], v65, s[12:15], s31 offen sc1
  s_add_u32 s31, s31, 8192
  buffer_load_dwordx4 v[136:139], v65, s[12:15], s31 offen sc1
  s_add_u32 s31, s31, 8192
  buffer_load_dwordx4 v[140:143], v65, s[12:15], s31 offen sc1
  s_add_u32 s31, s31, 8192
  buffer_load_dwordx4 v[144:147], v65, s[12:15], s31 offen sc1
  s_add_u32 s31, s31, 8192
  buffer_load_dwordx4 v[148:151], v65, s[12:15], s31 offen sc1
  s_add_u32 s31, s31, 8192
  buffer_load_dwordx4 v[152:155], v65, s[12:15], s31 offen sc1
  s_add_u32 s31, s31, 8192
  buffer_load_dwordx4 v[156:159], v65, s[12:15], s31 offen sc1
  s_add_u32 s31, s31, 8192
  buffer_load_dwordx4 v[160:163], v65, s[12:15], s31 offen sc1
  v_mul_u32_u24 v66, 6554, v64
  v_lshrrev_b32 v66, 16, v66
  v_mul_u32_u24 v67, 10, v66
  v_sub_u32 v67, v64, v67
  v_cmp_le_u32 vcc, 21, v66
  s_nop 1
  v_cndmask_b32 v68, 0, 1, vcc
  v_mul_u32_u24 v69, 21, v68
  v_sub_u32 v69, v66, v69
  v_cmp_le_u32 vcc, 10, v69
  s_nop 1
  v_cndmask_b32 v70, 0, 1, vcc
  v_cmp_eq_u32 s[52:53], 20, v69
  s_nop 1
  v_cndmask_b32 v70, v70, 0, s[52:53]
  v_mul_u32_u24 v71, 10, v70
  v_sub_u32 v71, v69, v71
  v_mov_b32 v72, 10
  v_cndmask_b32 v71, v71, v72, s[52:53]
  v_lshrrev_b32 v72, 2, v71
  v_mul_u32_u24 v72, 5, v72
  v_lshrrev_b32 v73, 1, v67
  v_add_u32 v72, v72, v73
  v_lshlrev_b32 v72, 10, v72
  v_lshl_add_u32 v73, v68, 1, v70
  v_lshlrev_b32 v73, 2, v73
  v_and_b32 v74, 3, v71
  v_add_u32 v73, v73, v74
  v_lshl_add_u32 v73, v68, 4, v73
  v_lshl_add_u32 v72, v73, 4, v72
  v_and_b32 v74, 1, v67
  v_lshl_add_u32 v72, v74, 3, v72
  v_add_u32 v72, 32768, v72
  s_waitcnt vmcnt(0)
  v_pk_add_f32 v[100:101], v[100:101], v[132:133]
  v_pk_add_f32 v[102:103], v[102:103], v[134:135]
  v_pk_add_f32 v[104:105], v[104:105], v[136:137]
  v_pk_add_f32 v[106:107], v[106:107], v[138:139]
  v_pk_add_f32 v[108:109], v[108:109], v[140:141]
  v_pk_add_f32 v[110:111], v[110:111], v[142:143]
  v_pk_add_f32 v[112:113], v[112:113], v[144:145]
  v_pk_add_f32 v[114:115], v[114:115], v[146:147]
  v_pk_add_f32 v[116:117], v[116:117], v[148:149]
  v_pk_add_f32 v[118:119], v[118:119], v[150:151]
  v_pk_add_f32 v[120:121], v[120:121], v[152:153]
  v_pk_add_f32 v[122:123], v[122:123], v[154:155]
  v_pk_add_f32 v[124:125], v[124:125], v[156:157]
  v_pk_add_f32 v[126:127], v[126:127], v[158:159]
  v_pk_add_f32 v[128:129], v[128:129], v[160:161]
  v_pk_add_f32 v[130:131], v[130:131], v[162:163]
  v_pk_add_f32 v[100:101], v[100:101], v[116:117]
  v_pk_add_f32 v[102:103], v[102:103], v[118:119]
  v_pk_add_f32 v[104:105], v[104:105], v[120:121]
  v_pk_add_f32 v[106:107], v[106:107], v[122:123]
  v_pk_add_f32 v[108:109], v[108:109], v[124:125]
  v_pk_add_f32 v[110:111], v[110:111], v[126:127]
  v_pk_add_f32 v[112:113], v[112:113], v[128:129]
  v_pk_add_f32 v[114:115], v[114:115], v[130:131]
  v_pk_add_f32 v[100:101], v[100:101], v[108:109]
  v_pk_add_f32 v[102:103], v[102:103], v[110:111]
  v_pk_add_f32 v[104:105], v[104:105], v[112:113]
  v_pk_add_f32 v[106:107], v[106:107], v[114:115]
  v_pk_add_f32 v[100:101], v[100:101], v[104:105]
  v_pk_add_f32 v[102:103], v[102:103], v[106:107]
  v_cvt_pk_bf16_f32 v76, v100, v101
  v_cvt_pk_bf16_f32 v77, v102, v103
  v_cmp_gt_u32 vcc, 420, v0
  s_nop 3
  s_and_saveexec_b64 s[54:55], vcc
  ds_write_b64 v72, v[76:77]
  s_and_b64 exec, exec, s[52:53]
  ds_write_b64 v72, v[76:77] offset:64
  s_mov_b64 exec, s[54:55]
  s_waitcnt lgkmcnt(0)
  s_barrier
  s_cmp_lg_u32 s22, 0
  s_cbranch_scc1 Lsequential_preLN__linear_kernel_hedgehog__geglu_ffn__prompt_kernel_a2
  s_lshl_b32 s31, s2, 7
  s_add_u32 s31, s31, 24674304
  v_mov_b32 v8, 0
  v_mov_b32 v9, s96
  s_mov_b64 exec, 1
  buffer_store_dword v9, v8, s[12:15], s31 offen sc0 sc1
  s_mov_b64 exec, -1
Lsequential_preLN__linear_kernel_hedgehog__geglu_ffn__prompt_kernel_a2:
  v_lshlrev_b32 v64, 4, v1
  ds_read_b128 v[100:103], v64 offset:32768
  ds_read_b128 v[104:107], v64 offset:33792
  ds_read_b128 v[108:111], v64 offset:34816
  ds_read_b128 v[112:115], v64 offset:35840
  ds_read_b128 v[116:119], v64 offset:36864
  ds_read_b128 v[120:123], v64 offset:37888
  ds_read_b128 v[124:127], v64 offset:38912
  ds_read_b128 v[128:131], v64 offset:39936
  ds_read_b128 v[132:135], v64 offset:40960
  ds_read_b128 v[136:139], v64 offset:41984
  ds_read_b128 v[140:143], v64 offset:43008
  ds_read_b128 v[144:147], v64 offset:44032
  ds_read_b128 v[148:151], v64 offset:45056
  ds_read_b128 v[152:155], v64 offset:46080
  ds_read_b128 v[156:159], v64 offset:47104
  s_waitcnt lgkmcnt(0)
  v_mfma_f32_16x16x32_bf16 v[68:71], v[100:103], v[44:47], 0
  v_mfma_f32_16x16x32_bf16 v[72:75], v[120:123], v[44:47], 0
  v_mfma_f32_16x16x32_bf16 v[76:79], v[140:143], v[44:47], 0
  v_mfma_f32_16x16x32_bf16 v[68:71], v[104:107], v[48:51], v[68:71]
  v_mfma_f32_16x16x32_bf16 v[72:75], v[124:127], v[48:51], v[72:75]
  v_mfma_f32_16x16x32_bf16 v[76:79], v[144:147], v[48:51], v[76:79]
  v_mfma_f32_16x16x32_bf16 v[68:71], v[108:111], v[52:55], v[68:71]
  v_mfma_f32_16x16x32_bf16 v[72:75], v[128:131], v[52:55], v[72:75]
  v_mfma_f32_16x16x32_bf16 v[76:79], v[148:151], v[52:55], v[76:79]
  v_mfma_f32_16x16x32_bf16 v[68:71], v[112:115], v[56:59], v[68:71]
  v_mfma_f32_16x16x32_bf16 v[72:75], v[132:135], v[56:59], v[72:75]
  v_mfma_f32_16x16x32_bf16 v[76:79], v[152:155], v[56:59], v[76:79]
  v_mfma_f32_16x16x32_bf16 v[68:71], v[116:119], v[60:63], v[68:71]
  v_mfma_f32_16x16x32_bf16 v[72:75], v[136:139], v[60:63], v[72:75]
  v_mfma_f32_16x16x32_bf16 v[76:79], v[156:159], v[60:63], v[76:79]
  s_nop 7
  v_add_f32 v78, 0x358637bd, v78
  v_rcp_f32 v78, v78
  s_nop 0
  v_pk_mul_f32 v[68:69], v[68:69], v[78:79] op_sel_hi:[1,0]
  v_pk_mul_f32 v[70:71], v[70:71], v[78:79] op_sel_hi:[1,0]
  v_pk_mul_f32 v[72:73], v[72:73], v[78:79] op_sel_hi:[1,0]
  v_pk_mul_f32 v[74:75], v[74:75], v[78:79] op_sel_hi:[1,0]
  v_pk_mul_f32 v[76:77], v[76:77], v[78:79] op_sel_hi:[1,0]
  v_cvt_pk_bf16_f32 v80, v68, v69
  v_cvt_pk_bf16_f32 v81, v70, v71
  v_cvt_pk_bf16_f32 v82, v72, v73
  v_cvt_pk_bf16_f32 v83, v74, v75
  v_cvt_pk_bf16_f32 v84, v76, v77
  s_lshr_b32 s31, s26, 4
  s_lshl_b32 s31, s31, 4
  s_add_u32 s31, s31, s24
  s_mul_i32 s31, s31, 1280
  s_add_u32 s31, s31, 0
  v_lshlrev_b32 v88, 4, v21
  v_lshl_add_u32 v88, v3, 2, v88
  buffer_store_dwordx4 v[80:83], v64, s[12:15], s31 offen sc0 sc1
  buffer_store_dword v84, v88, s[12:15], s31 offen offset:1024 sc0 sc1
  s_waitcnt vmcnt(0)
  s_barrier
  s_cmp_lg_u32 s22, 0
  s_cbranch_scc1 Lsequential_preLN__linear_kernel_hedgehog__geglu_ffn__prompt_kernel_a3
  s_lshl_b32 s33, s23, 4
  s_add_u32 s33, s33, s24
  s_lshl_b32 s31, s33, 7
  s_add_u32 s31, s31, 24707072
  v_mov_b32 v8, 0
  v_mov_b32 v9, s96
  s_mov_b64 exec, 1
  buffer_store_dword v9, v8, s[12:15], s31 offen sc0 sc1
  s_mov_b64 exec, -1
Lsequential_preLN__linear_kernel_hedgehog__geglu_ffn__prompt_kernel_a3:
  s_and_b32 s20, s2, 7
  s_lshr_b32 s21, s2, 3
  s_lshl_b32 s23, s20, 2
  s_lshr_b32 s24, s21, 3
  s_add_u32 s23, s23, s24
  s_and_b32 s24, s21, 7
  s_lshl_b32 s26, s23, 2
  s_add_u32 s26, s26, s25
  s_cmp_ge_u32 s22, 4
  s_cbranch_scc1 Lsequential_preLN__linear_kernel_hedgehog__geglu_ffn__prompt_kernel_H3
  v_lshlrev_b32 v4, 4, v1
  v_add_u32 v5, 61440, v4
  s_lshl_b32 s31, s26, 4
  v_add_u32 v6, s31, v21
  v_mul_u32_u24 v8, 1280, v6
  v_mul_u32_u24 v9, 40, v3
  s_mul_i32 s33, s24, 160
  v_add3_u32 v8, v8, v9, s33
  s_mov_b32 s16, s4
  s_mov_b32 s17, s5
  s_mov_b32 s18, 2621440
  s_mov_b32 s19, 0x20000
  buffer_load_dwordx4 v[216:219], v8, s[16:19], 0 offen
  buffer_load_dwordx4 v[220:223], v8, s[16:19], 0 offen offset:16
  buffer_load_dwordx2 v[224:225], v8, s[16:19], 0 offen offset:32
  s_cmp_lg_u32 s22, 0
  s_cbranch_scc1 Lsequential_preLN__linear_kernel_hedgehog__geglu_ffn__prompt_kernel_fo1
  s_lshr_b32 s33, s23, 1
  s_lshl_b32 s33, s33, 4
  s_lshl_b32 s31, s33, 7
  s_add_u32 s31, s31, 24707072
  v_lshlrev_b32 v8, 7, v1
  s_mov_b32 s97, 0
  s_mov_b64 exec, 0xffff
  s_waitcnt vmcnt(0)
  buffer_load_dword v253, v8, s[12:15], s31 offen sc1
  s_sleep 2
  buffer_load_dword v254, v8, s[12:15], s31 offen sc1
Lsequential_preLN__linear_kernel_hedgehog__geglu_ffn__prompt_kernel_po:
  s_waitcnt vmcnt(1)
  v_cmp_ne_u32 vcc, s96, v253
  s_cbranch_vccz Lsequential_preLN__linear_kernel_hedgehog__geglu_ffn__prompt_kernel_po_x
  buffer_load_dword v253, v8, s[12:15], s31 offen sc1
  s_waitcnt vmcnt(1)
  v_cmp_ne_u32 vcc, s96, v254
  s_cbranch_vccz Lsequential_preLN__linear_kernel_hedgehog__geglu_ffn__prompt_kernel_po_x
  buffer_load_dword v254, v8, s[12:15], s31 offen sc1
  s_add_u32 s97, s97, 1
  s_cmp_le_u32 s97, 0x20000
  s_cbranch_scc1 Lsequential_preLN__linear_kernel_hedgehog__geglu_ffn__prompt_kernel_po
Lsequential_preLN__linear_kernel_hedgehog__geglu_ffn__prompt_kernel_po_x:
  s_mov_b64 exec, -1
  v_mov_b32 v8, 163824
  v_mov_b32 v9, 1
  ds_write_b32 v8, v9 offset:8
  s_branch Lsequential_preLN__linear_kernel_hedgehog__geglu_ffn__prompt_kernel_fo2
Lsequential_preLN__linear_kernel_hedgehog__geglu_ffn__prompt_kernel_fo1:
  v_mov_b32 v8, 163824
  s_mov_b32 s97, 0
Lsequential_preLN__linear_kernel_hedgehog__geglu_ffn__prompt_kernel_fo3:
  ds_read_b32 v9, v8 offset:8
  s_add_u32 s97, s97, 1
  s_waitcnt lgkmcnt(0)
  v_readfirstlane_b32 s33, v9
  s_cmp_gt_u32 s97, 0x1000000
  s_cbranch_scc1 Lsequential_preLN__linear_kernel_hedgehog__geglu_ffn__prompt_kernel_fo2
  s_nop 1
  s_cmp_eq_u32 s33, 0
  s_cbranch_scc1 Lsequential_preLN__linear_kernel_hedgehog__geglu_ffn__prompt_kernel_fo3
Lsequential_preLN__linear_kernel_hedgehog__geglu_ffn__prompt_kernel_fo2:
  v_mov_b32 v7, v21
  v_mov_b32 v2, v3
  s_mul_i32 s27, s26, 20480
  s_add_u32 s27, s27, 0
  s_and_b32 s33, s21, 3
  s_add_u32 s40, s33, 0
  s_and_b32 s40, s40, 3
  s_mul_i32 s40, s40, 5120
  s_add_u32 s40, s40, s27
  s_add_u32 s41, s33, 1
  s_and_b32 s41, s41, 3
  s_mul_i32 s41, s41, 5120
  s_add_u32 s41, s41, s27
  s_add_u32 s42, s33, 2
  s_and_b32 s42, s42, 3
  s_mul_i32 s42, s42, 5120
  s_add_u32 s42, s42, s27
  s_add_u32 s43, s33, 3
  s_and_b32 s43, s43, 3
  s_mul_i32 s43, s43, 5120
  s_add_u32 s43, s43, s27
  v_mul_u32_u24 v13, 1280, v2
  v_lshl_add_u32 v13, v7, 4, v13
  buffer_load_dwordx4 v[16:19], v4, s[12:15], s40 offen offset:0 sc1
  buffer_load_dwordx4 v[20:23], v4, s[12:15], s40 offen offset:1280 sc1
  buffer_load_dwordx4 v[24:27], v4, s[12:15], s40 offen offset:2560 sc1
  buffer_load_dwordx4 v[28:31], v4, s[12:15], s40 offen offset:3840 sc1
  buffer_load_dwordx4 v[32:35], v13, s[12:15], s40 offen offset:1024 sc1
  buffer_load_dwordx4 v[36:39], v4, s[12:15], s41 offen offset:0 sc1
  buffer_load_dwordx4 v[40:43], v4, s[12:15], s41 offen offset:1280 sc1
  buffer_load_dwordx4 v[44:47], v4, s[12:15], s41 offen offset:2560 sc1
  v_lshlrev_b32 v10, 2, v6
  s_mov_b32 s34, 24559616
  s_waitcnt lgkmcnt(0)
  s_barrier
  ds_read_b128 v[96:99], v4 offset:0
  ds_read_b128 v[100:103], v4 offset:1024
  buffer_load_dwordx4 v[48:51], v4, s[12:15], s41 offen offset:3840 sc1
  ds_read_b128 v[104:107], v4 offset:2048
  ds_read_b128 v[108:111], v4 offset:3072
  ds_read_b128 v[112:115], v4 offset:4096
  ds_read_b128 v[116:119], v4 offset:5120
  ds_read_b128 v[120:123], v4 offset:6144
  buffer_load_dwordx4 v[52:55], v13, s[12:15], s41 offen offset:1024 sc1
  ds_read_b128 v[124:127], v4 offset:7168
  ds_read_b128 v[128:131], v4 offset:8192
  ds_read_b128 v[132:135], v4 offset:9216
  ds_read_b128 v[136:139], v4 offset:10240
  ds_read_b128 v[140:143], v4 offset:11264
  buffer_load_dwordx4 v[56:59], v4, s[12:15], s42 offen offset:0 sc1
  ds_read_b128 v[144:147], v4 offset:12288
  ds_read_b128 v[148:151], v4 offset:13312
  ds_read_b128 v[152:155], v4 offset:14336
  ds_read_b128 v[156:159], v4 offset:15360
  ds_read_b128 v[160:163], v4 offset:16384
  buffer_load_dwordx4 v[60:63], v4, s[12:15], s42 offen offset:1280 sc1
  ds_read_b128 v[164:167], v4 offset:17408
  ds_read_b128 v[168:171], v4 offset:18432
  ds_read_b128 v[172:175], v4 offset:19456
  ds_read_b128 v[176:179], v4 offset:20480
  ds_read_b128 v[180:183], v4 offset:21504
  ds_read_b128 v[184:187], v4 offset:22528
  ds_read_b128 v[188:191], v4 offset:23552
  s_waitcnt lgkmcnt(0)
  s_barrier
  s_waitcnt vmcnt(8)
  v_mfma_f32_16x16x32_bf16 v[192:195], v[96:99], v[16:19], 0
  ds_read_b128 v[96:99], v4 offset:24576
  v_mfma_f32_16x16x32_bf16 v[196:199], v[100:103], v[16:19], 0
  ds_read_b128 v[100:103], v4 offset:25600
  buffer_load_dwordx4 v[64:67], v4, s[12:15], s42 offen offset:2560 sc1
  v_mfma_f32_16x16x32_bf16 v[200:203], v[104:107], v[16:19], 0
  ds_read_b128 v[104:107], v4 offset:26624
  v_mfma_f32_16x16x32_bf16 v[204:207], v[108:111], v[16:19], 0
  ds_read_b128 v[108:111], v4 offset:27648
  v_mfma_f32_16x16x32_bf16 v[208:211], v[112:115], v[16:19], 0
  ds_read_b128 v[112:115], v4 offset:28672
  v_mfma_f32_16x16x32_bf16 v[212:215], v[116:119], v[16:19], 0
  ds_read_b128 v[116:119], v4 offset:29696
  v_mfma_f32_16x16x32_bf16 v[192:195], v[120:123], v[20:23], v[192:195]
  ds_read_b128 v[120:123], v4 offset:30720
  buffer_load_dwordx4 v[68:71], v4, s[12:15], s42 offen offset:3840 sc1
  v_mfma_f32_16x16x32_bf16 v[196:199], v[124:127], v[20:23], v[196:199]
  ds_read_b128 v[124:127], v4 offset:31744
  v_mfma_f32_16x16x32_bf16 v[200:203], v[128:131], v[20:23], v[200:203]
  ds_read_b128 v[128:131], v4 offset:32768
  v_mfma_f32_16x16x32_bf16 v[204:207], v[132:135], v[20:23], v[204:207]
  ds_read_b128 v[132:135], v4 offset:33792
  v_mfma_f32_16x16x32_bf16 v[208:211], v[136:139], v[20:23], v[208:211]
  ds_read_b128 v[136:139], v4 offset:34816
  v_mfma_f32_16x16x32_bf16 v[212:215], v[140:143], v[20:23], v[212:215]
  ds_read_b128 v[140:143], v4 offset:35840
  buffer_load_dwordx4 v[72:75], v13, s[12:15], s42 offen offset:1024 sc1
  v_mfma_f32_16x16x32_bf16 v[192:195], v[144:147], v[24:27], v[192:195]
  ds_read_b128 v[144:147], v4 offset:36864
  v_mfma_f32_16x16x32_bf16 v[196:199], v[148:151], v[24:27], v[196:199]
  ds_read_b128 v[148:151], v4 offset:37888
  v_mfma_f32_16x16x32_bf16 v[200:203], v[152:155], v[24:27], v[200:203]
  ds_read_b128 v[152:155], v4 offset:38912
  v_mfma_f32_16x16x32_bf16 v[204:207], v[156:159], v[24:27], v[204:207]
  ds_read_b128 v[156:159], v4 offset:39936
  v_mfma_f32_16x16x32_bf16 v[208:211], v[160:163], v[24:27], v[208:211]
  ds_read_b128 v[160:163], v4 offset:40960
  buffer_load_dwordx4 v[76:79], v4, s[12:15], s43 offen offset:0 sc1
  v_mfma_f32_16x16x32_bf16 v[212:215], v[164:167], v[24:27], v[212:215]
  ds_read_b128 v[164:167], v4 offset:41984
  v_mfma_f32_16x16x32_bf16 v[192:195], v[168:171], v[28:31], v[192:195]
  ds_read_b128 v[168:171], v4 offset:43008
  v_mfma_f32_16x16x32_bf16 v[196:199], v[172:175], v[28:31], v[196:199]
  ds_read_b128 v[172:175], v4 offset:44032
  v_mfma_f32_16x16x32_bf16 v[200:203], v[176:179], v[28:31], v[200:203]
  ds_read_b128 v[176:179], v4 offset:45056
  v_mfma_f32_16x16x32_bf16 v[204:207], v[180:183], v[28:31], v[204:207]
  ds_read_b128 v[180:183], v4 offset:46080
  v_mfma_f32_16x16x32_bf16 v[208:211], v[184:187], v[28:31], v[208:211]
  ds_read_b128 v[184:187], v4 offset:47104
  v_mfma_f32_16x16x32_bf16 v[212:215], v[188:191], v[28:31], v[212:215]
  ds_read_b128 v[188:191], v4 offset:48128
  s_waitcnt lgkmcnt(0)
  s_barrier
  s_waitcnt vmcnt(8)
  v_mfma_f32_16x16x32_bf16 v[192:195], v[96:99], v[32:35], v[192:195]
  ds_read_b128 v[96:99], v4 offset:49152
  v_mfma_f32_16x16x32_bf16 v[196:199], v[100:103], v[32:35], v[196:199]
  ds_read_b128 v[100:103], v4 offset:50176
  buffer_load_dwordx4 v[80:83], v4, s[12:15], s43 offen offset:1280 sc1
  v_mfma_f32_16x16x32_bf16 v[200:203], v[104:107], v[32:35], v[200:203]
  ds_read_b128 v[104:107], v4 offset:51200
  v_mfma_f32_16x16x32_bf16 v[204:207], v[108:111], v[32:35], v[204:207]
  ds_read_b128 v[108:111], v4 offset:52224
  v_mfma_f32_16x16x32_bf16 v[208:211], v[112:115], v[32:35], v[208:211]
  ds_read_b128 v[112:115], v4 offset:53248
  v_mfma_f32_16x16x32_bf16 v[212:215], v[116:119], v[32:35], v[212:215]
  ds_read_b128 v[116:119], v4 offset:54272
  v_mfma_f32_16x16x32_bf16 v[192:195], v[120:123], v[36:39], v[192:195]
  ds_read_b128 v[120:123], v4 offset:55296
  buffer_load_dwordx4 v[84:87], v4, s[12:15], s43 offen offset:2560 sc1
  v_mfma_f32_16x16x32_bf16 v[196:199], v[124:127], v[36:39], v[196:199]
  ds_read_b128 v[124:127], v4 offset:56320
  v_mfma_f32_16x16x32_bf16 v[200:203], v[128:131], v[36:39], v[200:203]
  ds_read_b128 v[128:131], v4 offset:57344
  v_mfma_f32_16x16x32_bf16 v[204:207], v[132:135], v[36:39], v[204:207]
  ds_read_b128 v[132:135], v4 offset:58368
  v_mfma_f32_16x16x32_bf16 v[208:211], v[136:139], v[36:39], v[208:211]
  ds_read_b128 v[136:139], v4 offset:59392
  v_mfma_f32_16x16x32_bf16 v[212:215], v[140:143], v[36:39], v[212:215]
  ds_read_b128 v[140:143], v4 offset:60416
  buffer_load_dwordx4 v[88:91], v4, s[12:15], s43 offen offset:3840 sc1
  v_mfma_f32_16x16x32_bf16 v[192:195], v[144:147], v[40:43], v[192:195]
  ds_read_b128 v[144:147], v5 offset:0
  v_mfma_f32_16x16x32_bf16 v[196:199], v[148:151], v[40:43], v[196:199]
  ds_read_b128 v[148:151], v5 offset:1024
  v_mfma_f32_16x16x32_bf16 v[200:203], v[152:155], v[40:43], v[200:203]
  ds_read_b128 v[152:155], v5 offset:2048
  v_mfma_f32_16x16x32_bf16 v[204:207], v[156:159], v[40:43], v[204:207]
  ds_read_b128 v[156:159], v5 offset:3072
  v_mfma_f32_16x16x32_bf16 v[208:211], v[160:163], v[40:43], v[208:211]
  ds_read_b128 v[160:163], v5 offset:4096
  buffer_load_dwordx4 v[92:95], v13, s[12:15], s43 offen offset:1024 sc1
  v_mfma_f32_16x16x32_bf16 v[212:215], v[164:167], v[40:43], v[212:215]
  ds_read_b128 v[164:167], v5 offset:5120
  v_mfma_f32_16x16x32_bf16 v[192:195], v[168:171], v[44:47], v[192:195]
  ds_read_b128 v[168:171], v5 offset:6144
  v_mfma_f32_16x16x32_bf16 v[196:199], v[172:175], v[44:47], v[196:199]
  ds_read_b128 v[172:175], v5 offset:7168
  v_mfma_f32_16x16x32_bf16 v[200:203], v[176:179], v[44:47], v[200:203]
  ds_read_b128 v[176:179], v5 offset:8192
  v_mfma_f32_16x16x32_bf16 v[204:207], v[180:183], v[44:47], v[204:207]
  ds_read_b128 v[180:183], v5 offset:9216
  v_mfma_f32_16x16x32_bf16 v[208:211], v[184:187], v[44:47], v[208:211]
  ds_read_b128 v[184:187], v5 offset:10240
  v_mfma_f32_16x16x32_bf16 v[212:215], v[188:191], v[44:47], v[212:215]
  ds_read_b128 v[188:191], v5 offset:11264
  s_waitcnt lgkmcnt(0)
  s_barrier
  s_waitcnt vmcnt(8)
  v_mfma_f32_16x16x32_bf16 v[192:195], v[96:99], v[48:51], v[192:195]
  ds_read_b128 v[96:99], v5 offset:12288
  v_mfma_f32_16x16x32_bf16 v[196:199], v[100:103], v[48:51], v[196:199]
  ds_read_b128 v[100:103], v5 offset:13312
  buffer_load_dword v226, v10, s[12:15], s34 offen sc1
  v_mfma_f32_16x16x32_bf16 v[200:203], v[104:107], v[48:51], v[200:203]
  ds_read_b128 v[104:107], v5 offset:14336
  v_mfma_f32_16x16x32_bf16 v[204:207], v[108:111], v[48:51], v[204:207]
  ds_read_b128 v[108:111], v5 offset:15360
  v_mfma_f32_16x16x32_bf16 v[208:211], v[112:115], v[48:51], v[208:211]
  ds_read_b128 v[112:115], v5 offset:16384
  v_mfma_f32_16x16x32_bf16 v[212:215], v[116:119], v[48:51], v[212:215]
  ds_read_b128 v[116:119], v5 offset:17408
  v_mfma_f32_16x16x32_bf16 v[192:195], v[120:123], v[52:55], v[192:195]
  ds_read_b128 v[120:123], v5 offset:18432
  v_mfma_f32_16x16x32_bf16 v[196:199], v[124:127], v[52:55], v[196:199]
  ds_read_b128 v[124:127], v5 offset:19456
  v_mfma_f32_16x16x32_bf16 v[200:203], v[128:131], v[52:55], v[200:203]
  ds_read_b128 v[128:131], v5 offset:20480
  v_mfma_f32_16x16x32_bf16 v[204:207], v[132:135], v[52:55], v[204:207]
  ds_read_b128 v[132:135], v5 offset:21504
  v_mfma_f32_16x16x32_bf16 v[208:211], v[136:139], v[52:55], v[208:211]
  ds_read_b128 v[136:139], v5 offset:22528
  v_mfma_f32_16x16x32_bf16 v[212:215], v[140:143], v[52:55], v[212:215]
  ds_read_b128 v[140:143], v5 offset:23552
  v_mfma_f32_16x16x32_bf16 v[192:195], v[144:147], v[56:59], v[192:195]
  ds_read_b128 v[144:147], v5 offset:24576
  v_mfma_f32_16x16x32_bf16 v[196:199], v[148:151], v[56:59], v[196:199]
  ds_read_b128 v[148:151], v5 offset:25600
  v_mfma_f32_16x16x32_bf16 v[200:203], v[152:155], v[56:59], v[200:203]
  ds_read_b128 v[152:155], v5 offset:26624
  v_mfma_f32_16x16x32_bf16 v[204:207], v[156:159], v[56:59], v[204:207]
  ds_read_b128 v[156:159], v5 offset:27648
  v_mfma_f32_16x16x32_bf16 v[208:211], v[160:163], v[56:59], v[208:211]
  ds_read_b128 v[160:163], v5 offset:28672
  v_mfma_f32_16x16x32_bf16 v[212:215], v[164:167], v[56:59], v[212:215]
  ds_read_b128 v[164:167], v5 offset:29696
  v_mfma_f32_16x16x32_bf16 v[192:195], v[168:171], v[60:63], v[192:195]
  ds_read_b128 v[168:171], v5 offset:30720
  v_mfma_f32_16x16x32_bf16 v[196:199], v[172:175], v[60:63], v[196:199]
  ds_read_b128 v[172:175], v5 offset:31744
  v_mfma_f32_16x16x32_bf16 v[200:203], v[176:179], v[60:63], v[200:203]
  ds_read_b128 v[176:179], v5 offset:32768
  v_mfma_f32_16x16x32_bf16 v[204:207], v[180:183], v[60:63], v[204:207]
  ds_read_b128 v[180:183], v5 offset:33792
  v_mfma_f32_16x16x32_bf16 v[208:211], v[184:187], v[60:63], v[208:211]
  ds_read_b128 v[184:187], v5 offset:34816
  v_mfma_f32_16x16x32_bf16 v[212:215], v[188:191], v[60:63], v[212:215]
  ds_read_b128 v[188:191], v5 offset:35840
  s_waitcnt lgkmcnt(0)
  s_barrier
  s_waitcnt vmcnt(5)
  v_mfma_f32_16x16x32_bf16 v[192:195], v[96:99], v[64:67], v[192:195]
  ds_read_b128 v[96:99], v5 offset:36864
  v_mfma_f32_16x16x32_bf16 v[196:199], v[100:103], v[64:67], v[196:199]
  ds_read_b128 v[100:103], v5 offset:37888
  v_mfma_f32_16x16x32_bf16 v[200:203], v[104:107], v[64:67], v[200:203]
  ds_read_b128 v[104:107], v5 offset:38912
  v_mfma_f32_16x16x32_bf16 v[204:207], v[108:111], v[64:67], v[204:207]
  ds_read_b128 v[108:111], v5 offset:39936
  v_mfma_f32_16x16x32_bf16 v[208:211], v[112:115], v[64:67], v[208:211]
  ds_read_b128 v[112:115], v5 offset:40960
  v_mfma_f32_16x16x32_bf16 v[212:215], v[116:119], v[64:67], v[212:215]
  ds_read_b128 v[116:119], v5 offset:41984
  v_mfma_f32_16x16x32_bf16 v[192:195], v[120:123], v[68:71], v[192:195]
  ds_read_b128 v[120:123], v5 offset:43008
  v_mfma_f32_16x16x32_bf16 v[196:199], v[124:127], v[68:71], v[196:199]
  ds_read_b128 v[124:127], v5 offset:44032
  v_mfma_f32_16x16x32_bf16 v[200:203], v[128:131], v[68:71], v[200:203]
  ds_read_b128 v[128:131], v5 offset:45056
  v_mfma_f32_16x16x32_bf16 v[204:207], v[132:135], v[68:71], v[204:207]
  ds_read_b128 v[132:135], v5 offset:46080
  v_mfma_f32_16x16x32_bf16 v[208:211], v[136:139], v[68:71], v[208:211]
  ds_read_b128 v[136:139], v5 offset:47104
  v_mfma_f32_16x16x32_bf16 v[212:215], v[140:143], v[68:71], v[212:215]
  ds_read_b128 v[140:143], v5 offset:48128
  v_mfma_f32_16x16x32_bf16 v[192:195], v[144:147], v[72:75], v[192:195]
  ds_read_b128 v[144:147], v5 offset:49152
  v_mfma_f32_16x16x32_bf16 v[196:199], v[148:151], v[72:75], v[196:199]
  ds_read_b128 v[148:151], v5 offset:50176
  v_mfma_f32_16x16x32_bf16 v[200:203], v[152:155], v[72:75], v[200:203]
  ds_read_b128 v[152:155], v5 offset:51200
  v_mfma_f32_16x16x32_bf16 v[204:207], v[156:159], v[72:75], v[204:207]
  ds_read_b128 v[156:159], v5 offset:52224
  v_mfma_f32_16x16x32_bf16 v[208:211], v[160:163], v[72:75], v[208:211]
  ds_read_b128 v[160:163], v5 offset:53248
  v_mfma_f32_16x16x32_bf16 v[212:215], v[164:167], v[72:75], v[212:215]
  ds_read_b128 v[164:167], v5 offset:54272
  v_mfma_f32_16x16x32_bf16 v[192:195], v[168:171], v[76:79], v[192:195]
  ds_read_b128 v[168:171], v5 offset:55296
  v_mfma_f32_16x16x32_bf16 v[196:199], v[172:175], v[76:79], v[196:199]
  ds_read_b128 v[172:175], v5 offset:56320
  v_mfma_f32_16x16x32_bf16 v[200:203], v[176:179], v[76:79], v[200:203]
  ds_read_b128 v[176:179], v5 offset:57344
  v_mfma_f32_16x16x32_bf16 v[204:207], v[180:183], v[76:79], v[204:207]
  ds_read_b128 v[180:183], v5 offset:58368
  v_mfma_f32_16x16x32_bf16 v[208:211], v[184:187], v[76:79], v[208:211]
  ds_read_b128 v[184:187], v5 offset:59392
  v_mfma_f32_16x16x32_bf16 v[212:215], v[188:191], v[76:79], v[212:215]
  ds_read_b128 v[188:191], v5 offset:60416
  s_waitcnt lgkmcnt(0)
  s_barrier
  s_waitcnt vmcnt(1)
  v_mfma_f32_16x16x32_bf16 v[192:195], v[96:99], v[80:83], v[192:195]
  v_mfma_f32_16x16x32_bf16 v[196:199], v[100:103], v[80:83], v[196:199]
  v_mfma_f32_16x16x32_bf16 v[200:203], v[104:107], v[80:83], v[200:203]
  v_mfma_f32_16x16x32_bf16 v[204:207], v[108:111], v[80:83], v[204:207]
  v_mfma_f32_16x16x32_bf16 v[208:211], v[112:115], v[80:83], v[208:211]
  v_mfma_f32_16x16x32_bf16 v[212:215], v[116:119], v[80:83], v[212:215]
  v_mfma_f32_16x16x32_bf16 v[192:195], v[120:123], v[84:87], v[192:195]
  v_mfma_f32_16x16x32_bf16 v[196:199], v[124:127], v[84:87], v[196:199]
  v_mfma_f32_16x16x32_bf16 v[200:203], v[128:131], v[84:87], v[200:203]
  v_mfma_f32_16x16x32_bf16 v[204:207], v[132:135], v[84:87], v[204:207]
  v_mfma_f32_16x16x32_bf16 v[208:211], v[136:139], v[84:87], v[208:211]
  v_mfma_f32_16x16x32_bf16 v[212:215], v[140:143], v[84:87], v[212:215]
  v_mfma_f32_16x16x32_bf16 v[192:195], v[144:147], v[88:91], v[192:195]
  v_mfma_f32_16x16x32_bf16 v[196:199], v[148:151], v[88:91], v[196:199]
  v_mfma_f32_16x16x32_bf16 v[200:203], v[152:155], v[88:91], v[200:203]
  v_mfma_f32_16x16x32_bf16 v[204:207], v[156:159], v[88:91], v[204:207]
  v_mfma_f32_16x16x32_bf16 v[208:211], v[160:163], v[88:91], v[208:211]
  v_mfma_f32_16x16x32_bf16 v[212:215], v[164:167], v[88:91], v[212:215]
  v_mfma_f32_16x16x32_bf16 v[192:195], v[168:171], v[92:95], v[192:195]
  v_mfma_f32_16x16x32_bf16 v[196:199], v[172:175], v[92:95], v[196:199]
  v_mfma_f32_16x16x32_bf16 v[200:203], v[176:179], v[92:95], v[200:203]
  v_mfma_f32_16x16x32_bf16 v[204:207], v[180:183], v[92:95], v[204:207]
  v_mfma_f32_16x16x32_bf16 v[208:211], v[184:187], v[92:95], v[208:211]
  v_mfma_f32_16x16x32_bf16 v[212:215], v[188:191], v[92:95], v[212:215]
  s_waitcnt vmcnt(0)
  s_nop 1
  v_cvt_pk_bf16_f32 v16, v192, v193
  v_cvt_pk_bf16_f32 v17, v194, v195
  v_cvt_pk_bf16_f32 v18, v196, v197
  v_cvt_pk_bf16_f32 v19, v198, v199
  v_cvt_pk_bf16_f32 v20, v200, v201
  v_cvt_pk_bf16_f32 v21, v202, v203
  v_cvt_pk_bf16_f32 v22, v204, v205
  v_cvt_pk_bf16_f32 v23, v206, v207
  v_cvt_pk_bf16_f32 v24, v208, v209
  v_cvt_pk_bf16_f32 v25, v210, v211
  v_lshlrev_b32 v32, 16, v16
  v_and_b32 v33, 0xffff0000, v16
  v_lshlrev_b32 v56, 16, v216
  v_and_b32 v57, 0xffff0000, v216
  v_lshlrev_b32 v34, 16, v17
  v_and_b32 v35, 0xffff0000, v17
  v_lshlrev_b32 v58, 16, v217
  v_and_b32 v59, 0xffff0000, v217
  v_lshlrev_b32 v36, 16, v18
  v_and_b32 v37, 0xffff0000, v18
  v_lshlrev_b32 v60, 16, v218
  v_and_b32 v61, 0xffff0000, v218
  v_lshlrev_b32 v38, 16, v19
  v_and_b32 v39, 0xffff0000, v19
  v_lshlrev_b32 v62, 16, v219
  v_and_b32 v63, 0xffff0000, v219
  v_lshlrev_b32 v40, 16, v20
  v_and_b32 v41, 0xffff0000, v20
  v_lshlrev_b32 v64, 16, v220
  v_and_b32 v65, 0xffff0000, v220
  v_lshlrev_b32 v42, 16, v21
  v_and_b32 v43, 0xffff0000, v21
  v_lshlrev_b32 v66, 16, v221
  v_and_b32 v67, 0xffff0000, v221
  v_lshlrev_b32 v44, 16, v22
  v_and_b32 v45, 0xffff0000, v22
  v_lshlrev_b32 v68, 16, v222
  v_and_b32 v69, 0xffff0000, v222
  v_lshlrev_b32 v46, 16, v23
  v_and_b32 v47, 0xffff0000, v23
  v_lshlrev_b32 v70, 16, v223
  v_and_b32 v71, 0xffff0000, v223
  v_lshlrev_b32 v48, 16, v24
  v_and_b32 v49, 0xffff0000, v24
  v_lshlrev_b32 v72, 16, v224
  v_and_b32 v73, 0xffff0000, v224
  v_lshlrev_b32 v50, 16, v25
  v_and_b32 v51, 0xffff0000, v25
  v_lshlrev_b32 v74, 16, v225
  v_and_b32 v75, 0xffff0000, v225
  v_pk_add_f32 v[32:33], v[32:33], v[56:57]
  v_pk_add_f32 v[34:35], v[34:35], v[58:59]
  v_pk_add_f32 v[36:37], v[36:37], v[60:61]
  v_pk_add_f32 v[38:39], v[38:39], v[62:63]
  v_pk_add_f32 v[40:41], v[40:41], v[64:65]
  v_pk_add_f32 v[42:43], v[42:43], v[66:67]
  v_pk_add_f32 v[44:45], v[44:45], v[68:69]
  v_pk_add_f32 v[46:47], v[46:47], v[70:71]
  v_pk_add_f32 v[48:49], v[48:49], v[72:73]
  v_pk_add_f32 v[50:51], v[50:51], v[74:75]
  v_cvt_pk_bf16_f32 v80, v32, v33
  v_cvt_pk_bf16_f32 v81, v34, v35
  v_cvt_pk_bf16_f32 v82, v36, v37
  v_cvt_pk_bf16_f32 v83, v38, v39
  v_cvt_pk_bf16_f32 v84, v40, v41
  v_cvt_pk_bf16_f32 v85, v42, v43
  v_cvt_pk_bf16_f32 v86, v44, v45
  v_cvt_pk_bf16_f32 v87, v46, v47
  v_cvt_pk_bf16_f32 v88, v48, v49
  v_cvt_pk_bf16_f32 v89, v50, v51
  v_add_f32 v226, v226, v212
  v_cvt_pk_bf16_f32 v228, v226, v226
  v_lshlrev_b32 v227, 16, v228
  v_lshlrev_b32 v32, 16, v80
  v_and_b32 v33, 0xffff0000, v80
  v_lshlrev_b32 v34, 16, v81
  v_and_b32 v35, 0xffff0000, v81
  v_lshlrev_b32 v36, 16, v82
  v_and_b32 v37, 0xffff0000, v82
  v_lshlrev_b32 v38, 16, v83
  v_and_b32 v39, 0xffff0000, v83
  v_lshlrev_b32 v40, 16, v84
  v_and_b32 v41, 0xffff0000, v84
  v_lshlrev_b32 v42, 16, v85
  v_and_b32 v43, 0xffff0000, v85
  v_lshlrev_b32 v44, 16, v86
  v_and_b32 v45, 0xffff0000, v86
  v_lshlrev_b32 v46, 16, v87
  v_and_b32 v47, 0xffff0000, v87
  v_lshlrev_b32 v48, 16, v88
  v_and_b32 v49, 0xffff0000, v88
  v_lshlrev_b32 v50, 16, v89
  v_and_b32 v51, 0xffff0000, v89
  v_pk_add_f32 v[56:57], v[32:33], v[226:227] op_sel:[0,1] op_sel_hi:[1,1] neg_lo:[0,1] neg_hi:[0,1]
  v_pk_add_f32 v[58:59], v[34:35], v[226:227] op_sel:[0,1] op_sel_hi:[1,1] neg_lo:[0,1] neg_hi:[0,1]
  v_pk_add_f32 v[60:61], v[36:37], v[226:227] op_sel:[0,1] op_sel_hi:[1,1] neg_lo:[0,1] neg_hi:[0,1]
  v_pk_add_f32 v[62:63], v[38:39], v[226:227] op_sel:[0,1] op_sel_hi:[1,1] neg_lo:[0,1] neg_hi:[0,1]
  v_pk_add_f32 v[64:65], v[40:41], v[226:227] op_sel:[0,1] op_sel_hi:[1,1] neg_lo:[0,1] neg_hi:[0,1]
  v_pk_add_f32 v[66:67], v[42:43], v[226:227] op_sel:[0,1] op_sel_hi:[1,1] neg_lo:[0,1] neg_hi:[0,1]
  v_pk_add_f32 v[68:69], v[44:45], v[226:227] op_sel:[0,1] op_sel_hi:[1,1] neg_lo:[0,1] neg_hi:[0,1]
  v_pk_add_f32 v[70:71], v[46:47], v[226:227] op_sel:[0,1] op_sel_hi:[1,1] neg_lo:[0,1] neg_hi:[0,1]
  v_pk_add_f32 v[72:73], v[48:49], v[226:227] op_sel:[0,1] op_sel_hi:[1,1] neg_lo:[0,1] neg_hi:[0,1]
  v_pk_add_f32 v[74:75], v[50:51], v[226:227] op_sel:[0,1] op_sel_hi:[1,1] neg_lo:[0,1] neg_hi:[0,1]
  v_cvt_pk_bf16_f32 v92, v56, v57
  v_cvt_pk_bf16_f32 v93, v58, v59
  v_cvt_pk_bf16_f32 v94, v60, v61
  v_cvt_pk_bf16_f32 v95, v62, v63
  v_cvt_pk_bf16_f32 v96, v64, v65
  v_cvt_pk_bf16_f32 v97, v66, v67
  v_cvt_pk_bf16_f32 v98, v68, v69
  v_cvt_pk_bf16_f32 v99, v70, v71
  v_cvt_pk_bf16_f32 v100, v72, v73
  v_cvt_pk_bf16_f32 v101, v74, v75
  s_lshr_b32 s36, s24, 1
  s_mul_i32 s36, s36, 5120
  s_mul_i32 s37, s26, 20480
  s_add_u32 s36, s36, s37
  s_add_u32 s36, s36, 2621440
  v_lshlrev_b32 v11, 3, v1
  s_bitcmp1_b32 s24, 0
  s_cbranch_scc1 Lsequential_preLN__linear_kernel_hedgehog__geglu_ffn__prompt_kernel_odd
  buffer_store_dwordx4 v[92:95], v4, s[12:15], s36 offen sc0 sc1
  buffer_store_dwordx4 v[96:99], v4, s[12:15], s36 offen offset:1024 sc0 sc1
  buffer_store_dwordx2 v[100:101], v11, s[12:15], s36 offen offset:2048 sc0 sc1
  s_branch Lsequential_preLN__linear_kernel_hedgehog__geglu_ffn__prompt_kernel_st
Lsequential_preLN__linear_kernel_hedgehog__geglu_ffn__prompt_kernel_odd:
  buffer_store_dwordx2 v[92:93], v11, s[12:15], s36 offen offset:2560 sc0 sc1
  buffer_store_dwordx4 v[94:97], v4, s[12:15], s36 offen offset:3072 sc0 sc1
  s_add_u32 s36, s36, 4096
  buffer_store_dwordx4 v[98:101], v4, s[12:15], s36 offen sc0 sc1
Lsequential_preLN__linear_kernel_hedgehog__geglu_ffn__prompt_kernel_st:
  v_pk_add_f32 v[32:33], v[32:33], v[226:227] op_sel:[0,0] op_sel_hi:[1,0] neg_lo:[0,1] neg_hi:[0,1]
  v_pk_add_f32 v[34:35], v[34:35], v[226:227] op_sel:[0,0] op_sel_hi:[1,0] neg_lo:[0,1] neg_hi:[0,1]
  v_pk_add_f32 v[36:37], v[36:37], v[226:227] op_sel:[0,0] op_sel_hi:[1,0] neg_lo:[0,1] neg_hi:[0,1]
  v_pk_add_f32 v[38:39], v[38:39], v[226:227] op_sel:[0,0] op_sel_hi:[1,0] neg_lo:[0,1] neg_hi:[0,1]
  v_pk_add_f32 v[40:41], v[40:41], v[226:227] op_sel:[0,0] op_sel_hi:[1,0] neg_lo:[0,1] neg_hi:[0,1]
  v_pk_add_f32 v[42:43], v[42:43], v[226:227] op_sel:[0,0] op_sel_hi:[1,0] neg_lo:[0,1] neg_hi:[0,1]
  v_pk_add_f32 v[44:45], v[44:45], v[226:227] op_sel:[0,0] op_sel_hi:[1,0] neg_lo:[0,1] neg_hi:[0,1]
  v_pk_add_f32 v[46:47], v[46:47], v[226:227] op_sel:[0,0] op_sel_hi:[1,0] neg_lo:[0,1] neg_hi:[0,1]
  v_pk_add_f32 v[48:49], v[48:49], v[226:227] op_sel:[0,0] op_sel_hi:[1,0] neg_lo:[0,1] neg_hi:[0,1]
  v_pk_add_f32 v[50:51], v[50:51], v[226:227] op_sel:[0,0] op_sel_hi:[1,0] neg_lo:[0,1] neg_hi:[0,1]
  v_pk_mul_f32 v[228:229], v[32:33], v[32:33]
  v_pk_fma_f32 v[228:229], v[34:35], v[34:35], v[228:229]
  v_pk_fma_f32 v[228:229], v[36:37], v[36:37], v[228:229]
  v_pk_fma_f32 v[228:229], v[38:39], v[38:39], v[228:229]
  v_pk_fma_f32 v[228:229], v[40:41], v[40:41], v[228:229]
  v_pk_fma_f32 v[228:229], v[42:43], v[42:43], v[228:229]
  v_pk_fma_f32 v[228:229], v[44:45], v[44:45], v[228:229]
  v_pk_fma_f32 v[228:229], v[46:47], v[46:47], v[228:229]
  v_pk_fma_f32 v[228:229], v[48:49], v[48:49], v[228:229]
  v_pk_fma_f32 v[228:229], v[50:51], v[50:51], v[228:229]
  v_add_f32 v228, v228, v229
  v_mov_b32 v229, v228
  s_nop 1
  v_permlane16_swap_b32 v229, v228
  v_add_f32 v228, v228, v229
  v_mov_b32 v229, v228
  s_nop 1
  v_permlane32_swap_b32 v229, v228
  v_add_f32 v228, v228, v229
  v_lshlrev_b32 v10, 2, v6
  s_lshl_b32 s37, s24, 13
  s_add_u32 s37, s37, 24567808
  buffer_store_dword v228, v10, s[12:15], s37 offen sc0 sc1
  s_mul_i32 s35, s25, 3072
  s_add_u32 s35, s35, 143360
  v_add_u32 v10, s35, v4
  ds_write_b128 v10, v[80:83]
  ds_write_b128 v10, v[84:87] offset:1024
  ds_write_b128 v10, v[88:91] offset:2048
  v_mov_b32 v21, v7
  v_mov_b32 v3, v2
  s_waitcnt vmcnt(0)
  s_barrier
  s_cmp_lg_u32 s22, 0
  s_cbranch_scc1 Lsequential_preLN__linear_kernel_hedgehog__geglu_ffn__prompt_kernel_a5
  s_lshl_b32 s33, s23, 3
  s_add_u32 s33, s33, s24
  s_lshl_b32 s31, s33, 7
  s_add_u32 s31, s31, 24739840
  v_mov_b32 v8, 0
  v_mov_b32 v9, s96
  s_mov_b64 exec, 1
  buffer_store_dword v9, v8, s[12:15], s31 offen sc0 sc1
  s_mov_b64 exec, -1
Lsequential_preLN__linear_kernel_hedgehog__geglu_ffn__prompt_kernel_a5:
  s_and_b32 s20, s2, 7
  s_lshr_b32 s21, s2, 3
  s_lshr_b32 s23, s20, 2
  s_lshl_b32 s23, s23, 3
  s_lshr_b32 s24, s21, 2
  s_add_u32 s23, s23, s24
  s_and_b32 s24, s20, 3
  s_lshl_b32 s24, s24, 2
  s_and_b32 s27, s21, 3
  s_add_u32 s24, s24, s27
  s_mov_b32 s18, s24
  s_mul_i32 s24, s24, 7
  s_min_u32 s24, s24, 101
  s_lshl_b32 s26, s23, 7
  s_lshl_b32 s27, s25, 5
  s_add_u32 s26, s26, s27
  s_cmp_lg_u32 s22, 0
  s_cbranch_scc1 Lsequential_preLN__linear_kernel_hedgehog__geglu_ffn__prompt_kernel_a6
  s_lshl_b32 s33, s23, 4
  s_lshl_b32 s31, s33, 7
  s_add_u32 s31, s31, 24739840
  v_lshlrev_b32 v8, 7, v1
  s_mov_b32 s97, 0
  s_mov_b64 exec, 0xffff
  s_waitcnt vmcnt(0)
  buffer_load_dword v253, v8, s[12:15], s31 offen sc1
  s_sleep 2
  buffer_load_dword v254, v8, s[12:15], s31 offen sc1
Lsequential_preLN__linear_kernel_hedgehog__geglu_ffn__prompt_kernel_ph:
  s_waitcnt vmcnt(1)
  v_cmp_ne_u32 vcc, s96, v253
  s_cbranch_vccz Lsequential_preLN__linear_kernel_hedgehog__geglu_ffn__prompt_kernel_ph_x
  buffer_load_dword v253, v8, s[12:15], s31 offen sc1
  s_waitcnt vmcnt(1)
  v_cmp_ne_u32 vcc, s96, v254
  s_cbranch_vccz Lsequential_preLN__linear_kernel_hedgehog__geglu_ffn__prompt_kernel_ph_x
  buffer_load_dword v254, v8, s[12:15], s31 offen sc1
  s_add_u32 s97, s97, 1
  s_cmp_le_u32 s97, 0x20000
  s_cbranch_scc1 Lsequential_preLN__linear_kernel_hedgehog__geglu_ffn__prompt_kernel_ph
Lsequential_preLN__linear_kernel_hedgehog__geglu_ffn__prompt_kernel_ph_x:
  s_mov_b64 exec, -1
Lsequential_preLN__linear_kernel_hedgehog__geglu_ffn__prompt_kernel_a6:
  s_barrier
  s_mov_b32 s53, 0x7ff00000
  v_lshlrev_b32 v4, 4, v1
  v_add_u32 v5, 40960, v4
  v_add_u32 v6, 81920, v4
  v_lshlrev_b32 v7, 3, v1
  s_lshr_b32 s38, s26, 4
  s_mul_i32 s38, s38, 20480
  s_add_u32 s38, s38, 2621440
  s_and_b32 s43, s21, 3
  s_add_u32 s44, s43, 0
  s_and_b32 s44, s44, 3
  s_mul_i32 s44, s44, 5120
  s_add_u32 s44, s44, s38
  s_add_u32 s45, s44, 20480
  s_add_u32 s46, s44, 4096
  s_add_u32 s47, s44, 24576
  buffer_load_dwordx4 v[16:19], v4, s[12:15], s44 offen offset:0 sc1
  buffer_load_dwordx4 v[96:99], v4, s[12:15], s45 offen offset:0 sc1
  buffer_load_dwordx4 v[20:23], v4, s[12:15], s44 offen offset:1024 sc1
  buffer_load_dwordx4 v[100:103], v4, s[12:15], s45 offen offset:1024 sc1
  buffer_load_dwordx2 v[24:25], v7, s[12:15], s44 offen offset:2048 sc1
  buffer_load_dwordx2 v[26:27], v7, s[12:15], s44 offen offset:2560 sc1
  buffer_load_dwordx2 v[104:105], v7, s[12:15], s45 offen offset:2048 sc1
  buffer_load_dwordx2 v[106:107], v7, s[12:15], s45 offen offset:2560 sc1
  buffer_load_dwordx4 v[28:31], v4, s[12:15], s44 offen offset:3072 sc1
  buffer_load_dwordx4 v[108:111], v4, s[12:15], s45 offen offset:3072 sc1
  buffer_load_dwordx4 v[32:35], v4, s[12:15], s46 offen offset:0 sc1
  buffer_load_dwordx4 v[112:115], v4, s[12:15], s47 offen offset:0 sc1
  s_add_u32 s44, s43, 1
  s_and_b32 s44, s44, 3
  s_mul_i32 s44, s44, 5120
  s_add_u32 s44, s44, s38
  s_add_u32 s45, s44, 20480
  s_add_u32 s46, s44, 4096
  s_add_u32 s47, s44, 24576
  buffer_load_dwordx4 v[36:39], v4, s[12:15], s44 offen offset:0 sc1
  buffer_load_dwordx4 v[116:119], v4, s[12:15], s45 offen offset:0 sc1
  s_lshr_b32 s35, s26, 4
  s_mul_i32 s35, s35, 55296
  s_add_u32 s35, s35, 7864320
  s_barrier
  s_lshl_b32 s30, s25, 11
  s_add_u32 s30, s30, 155648
  v_add_u32 v14, s30, v4
  ds_read_b128 v[176:179], v4 offset:0
  ds_read_b128 v[180:183], v4 offset:1024
  ds_read_b128 v[184:187], v5 offset:0
  ds_read_b128 v[188:191], v5 offset:1024
  s_waitcnt vmcnt(12)
  s_waitcnt lgkmcnt(0)
  v_mfma_f32_16x16x32_bf16 v[216:219], v[176:179], v[16:19], 0
  ds_read_b128 v[192:195], v4 offset:2048
  v_mfma_f32_16x16x32_bf16 v[224:227], v[176:179], v[96:99], 0
  ds_read_b128 v[196:199], v4 offset:3072
  v_mfma_f32_16x16x32_bf16 v[220:223], v[180:183], v[16:19], 0
  ds_read_b128 v[200:203], v5 offset:2048
  v_mfma_f32_16x16x32_bf16 v[228:231], v[180:183], v[96:99], 0
  ds_read_b128 v[204:207], v5 offset:3072
  v_mfma_f32_16x16x32_bf16 v[232:235], v[184:187], v[16:19], 0
  buffer_load_dwordx4 v[40:43], v4, s[12:15], s44 offen offset:1024 sc1
  buffer_load_dwordx4 v[120:123], v4, s[12:15], s45 offen offset:1024 sc1
  v_mfma_f32_16x16x32_bf16 v[240:243], v[184:187], v[96:99], 0
  v_mfma_f32_16x16x32_bf16 v[236:239], v[188:191], v[16:19], 0
  v_mfma_f32_16x16x32_bf16 v[244:247], v[188:191], v[96:99], 0
  s_waitcnt vmcnt(12)
  s_waitcnt lgkmcnt(0)
  v_mfma_f32_16x16x32_bf16 v[216:219], v[192:195], v[20:23], v[216:219]
  ds_read_b128 v[176:179], v4 offset:4096
  v_mfma_f32_16x16x32_bf16 v[224:227], v[192:195], v[100:103], v[224:227]
  ds_read_b128 v[180:183], v4 offset:5120
  v_mfma_f32_16x16x32_bf16 v[220:223], v[196:199], v[20:23], v[220:223]
  ds_read_b128 v[184:187], v5 offset:4096
  v_mfma_f32_16x16x32_bf16 v[228:231], v[196:199], v[100:103], v[228:231]
  ds_read_b128 v[188:191], v5 offset:5120
  v_mfma_f32_16x16x32_bf16 v[232:235], v[200:203], v[20:23], v[232:235]
  buffer_load_dwordx2 v[44:45], v7, s[12:15], s44 offen offset:2048 sc1
  buffer_load_dwordx2 v[46:47], v7, s[12:15], s44 offen offset:2560 sc1
  buffer_load_dwordx2 v[124:125], v7, s[12:15], s45 offen offset:2048 sc1
  buffer_load_dwordx2 v[126:127], v7, s[12:15], s45 offen offset:2560 sc1
  v_mfma_f32_16x16x32_bf16 v[240:243], v[200:203], v[100:103], v[240:243]
  v_mfma_f32_16x16x32_bf16 v[236:239], v[204:207], v[20:23], v[236:239]
  v_mfma_f32_16x16x32_bf16 v[244:247], v[204:207], v[100:103], v[244:247]
  s_waitcnt vmcnt(12)
  s_waitcnt lgkmcnt(0)
  v_mfma_f32_16x16x32_bf16 v[216:219], v[176:179], v[24:27], v[216:219]
  ds_read_b128 v[192:195], v4 offset:6144
  v_mfma_f32_16x16x32_bf16 v[224:227], v[176:179], v[104:107], v[224:227]
  ds_read_b128 v[196:199], v4 offset:7168
  v_mfma_f32_16x16x32_bf16 v[220:223], v[180:183], v[24:27], v[220:223]
  ds_read_b128 v[200:203], v5 offset:6144
  v_mfma_f32_16x16x32_bf16 v[228:231], v[180:183], v[104:107], v[228:231]
  ds_read_b128 v[204:207], v5 offset:7168
  v_mfma_f32_16x16x32_bf16 v[232:235], v[184:187], v[24:27], v[232:235]
  buffer_load_dwordx4 v[48:51], v4, s[12:15], s44 offen offset:3072 sc1
  buffer_load_dwordx4 v[128:131], v4, s[12:15], s45 offen offset:3072 sc1
  v_mfma_f32_16x16x32_bf16 v[240:243], v[184:187], v[104:107], v[240:243]
  v_mfma_f32_16x16x32_bf16 v[236:239], v[188:191], v[24:27], v[236:239]
  v_mfma_f32_16x16x32_bf16 v[244:247], v[188:191], v[104:107], v[244:247]
  s_waitcnt vmcnt(12)
  s_waitcnt lgkmcnt(0)
  v_mfma_f32_16x16x32_bf16 v[216:219], v[192:195], v[28:31], v[216:219]
  ds_read_b128 v[176:179], v4 offset:8192
  v_mfma_f32_16x16x32_bf16 v[224:227], v[192:195], v[108:111], v[224:227]
  ds_read_b128 v[180:183], v4 offset:9216
  v_mfma_f32_16x16x32_bf16 v[220:223], v[196:199], v[28:31], v[220:223]
  ds_read_b128 v[184:187], v5 offset:8192
  v_mfma_f32_16x16x32_bf16 v[228:231], v[196:199], v[108:111], v[228:231]
  ds_read_b128 v[188:191], v5 offset:9216
  v_mfma_f32_16x16x32_bf16 v[232:235], v[200:203], v[28:31], v[232:235]
  buffer_load_dwordx4 v[52:55], v4, s[12:15], s46 offen offset:0 sc1
  buffer_load_dwordx4 v[132:135], v4, s[12:15], s47 offen offset:0 sc1
  v_mfma_f32_16x16x32_bf16 v[240:243], v[200:203], v[108:111], v[240:243]
  v_mfma_f32_16x16x32_bf16 v[236:239], v[204:207], v[28:31], v[236:239]
  v_mfma_f32_16x16x32_bf16 v[244:247], v[204:207], v[108:111], v[244:247]
  s_waitcnt vmcnt(12)
  s_waitcnt lgkmcnt(0)
  v_mfma_f32_16x16x32_bf16 v[216:219], v[176:179], v[32:35], v[216:219]
  ds_read_b128 v[192:195], v4 offset:10240
  v_mfma_f32_16x16x32_bf16 v[224:227], v[176:179], v[112:115], v[224:227]
  ds_read_b128 v[196:199], v4 offset:11264
  v_mfma_f32_16x16x32_bf16 v[220:223], v[180:183], v[32:35], v[220:223]
  ds_read_b128 v[200:203], v5 offset:10240
  v_mfma_f32_16x16x32_bf16 v[228:231], v[180:183], v[112:115], v[228:231]
  ds_read_b128 v[204:207], v5 offset:11264
  v_mfma_f32_16x16x32_bf16 v[232:235], v[184:187], v[32:35], v[232:235]
  s_add_u32 s44, s43, 2
  s_and_b32 s44, s44, 3
  s_mul_i32 s44, s44, 5120
  s_add_u32 s44, s44, s38
  s_add_u32 s45, s44, 20480
  s_add_u32 s46, s44, 4096
  s_add_u32 s47, s44, 24576
  buffer_load_dwordx4 v[56:59], v4, s[12:15], s44 offen offset:0 sc1
  buffer_load_dwordx4 v[136:139], v4, s[12:15], s45 offen offset:0 sc1
  v_mfma_f32_16x16x32_bf16 v[240:243], v[184:187], v[112:115], v[240:243]
  v_mfma_f32_16x16x32_bf16 v[236:239], v[188:191], v[32:35], v[236:239]
  v_mfma_f32_16x16x32_bf16 v[244:247], v[188:191], v[112:115], v[244:247]
  s_waitcnt vmcnt(12)
  s_waitcnt lgkmcnt(0)
  v_mfma_f32_16x16x32_bf16 v[216:219], v[192:195], v[36:39], v[216:219]
  ds_read_b128 v[176:179], v4 offset:12288
  v_mfma_f32_16x16x32_bf16 v[224:227], v[192:195], v[116:119], v[224:227]
  ds_read_b128 v[180:183], v4 offset:13312
  v_mfma_f32_16x16x32_bf16 v[220:223], v[196:199], v[36:39], v[220:223]
  ds_read_b128 v[184:187], v5 offset:12288
  v_mfma_f32_16x16x32_bf16 v[228:231], v[196:199], v[116:119], v[228:231]
  ds_read_b128 v[188:191], v5 offset:13312
  v_mfma_f32_16x16x32_bf16 v[232:235], v[200:203], v[36:39], v[232:235]
  buffer_load_dwordx4 v[60:63], v4, s[12:15], s44 offen offset:1024 sc1
  buffer_load_dwordx4 v[140:143], v4, s[12:15], s45 offen offset:1024 sc1
  v_mfma_f32_16x16x32_bf16 v[240:243], v[200:203], v[116:119], v[240:243]
  v_mfma_f32_16x16x32_bf16 v[236:239], v[204:207], v[36:39], v[236:239]
  v_mfma_f32_16x16x32_bf16 v[244:247], v[204:207], v[116:119], v[244:247]
  s_waitcnt vmcnt(12)
  s_waitcnt lgkmcnt(0)
  v_mfma_f32_16x16x32_bf16 v[216:219], v[176:179], v[40:43], v[216:219]
  ds_read_b128 v[192:195], v4 offset:14336
  v_mfma_f32_16x16x32_bf16 v[224:227], v[176:179], v[120:123], v[224:227]
  ds_read_b128 v[196:199], v4 offset:15360
  v_mfma_f32_16x16x32_bf16 v[220:223], v[180:183], v[40:43], v[220:223]
  ds_read_b128 v[200:203], v5 offset:14336
  v_mfma_f32_16x16x32_bf16 v[228:231], v[180:183], v[120:123], v[228:231]
  ds_read_b128 v[204:207], v5 offset:15360
  v_mfma_f32_16x16x32_bf16 v[232:235], v[184:187], v[40:43], v[232:235]
  buffer_load_dwordx2 v[64:65], v7, s[12:15], s44 offen offset:2048 sc1
  buffer_load_dwordx2 v[66:67], v7, s[12:15], s44 offen offset:2560 sc1
  buffer_load_dwordx2 v[144:145], v7, s[12:15], s45 offen offset:2048 sc1
  buffer_load_dwordx2 v[146:147], v7, s[12:15], s45 offen offset:2560 sc1
  v_mfma_f32_16x16x32_bf16 v[240:243], v[184:187], v[120:123], v[240:243]
  v_mfma_f32_16x16x32_bf16 v[236:239], v[188:191], v[40:43], v[236:239]
  v_mfma_f32_16x16x32_bf16 v[244:247], v[188:191], v[120:123], v[244:247]
  s_waitcnt vmcnt(12)
  s_waitcnt lgkmcnt(0)
  v_mfma_f32_16x16x32_bf16 v[216:219], v[192:195], v[44:47], v[216:219]
  ds_read_b128 v[176:179], v4 offset:16384
  v_mfma_f32_16x16x32_bf16 v[224:227], v[192:195], v[124:127], v[224:227]
  ds_read_b128 v[180:183], v4 offset:17408
  v_mfma_f32_16x16x32_bf16 v[220:223], v[196:199], v[44:47], v[220:223]
  ds_read_b128 v[184:187], v5 offset:16384
  v_mfma_f32_16x16x32_bf16 v[228:231], v[196:199], v[124:127], v[228:231]
  ds_read_b128 v[188:191], v5 offset:17408
  v_mfma_f32_16x16x32_bf16 v[232:235], v[200:203], v[44:47], v[232:235]
  buffer_load_dwordx4 v[68:71], v4, s[12:15], s44 offen offset:3072 sc1
  buffer_load_dwordx4 v[148:151], v4, s[12:15], s45 offen offset:3072 sc1
  v_mfma_f32_16x16x32_bf16 v[240:243], v[200:203], v[124:127], v[240:243]
  v_mfma_f32_16x16x32_bf16 v[236:239], v[204:207], v[44:47], v[236:239]
  v_mfma_f32_16x16x32_bf16 v[244:247], v[204:207], v[124:127], v[244:247]
  s_waitcnt vmcnt(12)
  s_waitcnt lgkmcnt(0)
  v_mfma_f32_16x16x32_bf16 v[216:219], v[176:179], v[48:51], v[216:219]
  ds_read_b128 v[192:195], v4 offset:18432
  v_mfma_f32_16x16x32_bf16 v[224:227], v[176:179], v[128:131], v[224:227]
  ds_read_b128 v[196:199], v4 offset:19456
  v_mfma_f32_16x16x32_bf16 v[220:223], v[180:183], v[48:51], v[220:223]
  ds_read_b128 v[200:203], v5 offset:18432
  v_mfma_f32_16x16x32_bf16 v[228:231], v[180:183], v[128:131], v[228:231]
  ds_read_b128 v[204:207], v5 offset:19456
  v_mfma_f32_16x16x32_bf16 v[232:235], v[184:187], v[48:51], v[232:235]
  buffer_load_dwordx4 v[72:75], v4, s[12:15], s46 offen offset:0 sc1
  buffer_load_dwordx4 v[152:155], v4, s[12:15], s47 offen offset:0 sc1
  v_mfma_f32_16x16x32_bf16 v[240:243], v[184:187], v[128:131], v[240:243]
  v_mfma_f32_16x16x32_bf16 v[236:239], v[188:191], v[48:51], v[236:239]
  v_mfma_f32_16x16x32_bf16 v[244:247], v[188:191], v[128:131], v[244:247]
  s_waitcnt vmcnt(12)
  s_waitcnt lgkmcnt(0)
  v_mfma_f32_16x16x32_bf16 v[216:219], v[192:195], v[52:55], v[216:219]
  ds_read_b128 v[176:179], v4 offset:20480
  v_mfma_f32_16x16x32_bf16 v[224:227], v[192:195], v[132:135], v[224:227]
  ds_read_b128 v[180:183], v4 offset:21504
  v_mfma_f32_16x16x32_bf16 v[220:223], v[196:199], v[52:55], v[220:223]
  ds_read_b128 v[184:187], v5 offset:20480
  v_mfma_f32_16x16x32_bf16 v[228:231], v[196:199], v[132:135], v[228:231]
  ds_read_b128 v[188:191], v5 offset:21504
  v_mfma_f32_16x16x32_bf16 v[232:235], v[200:203], v[52:55], v[232:235]
  s_add_u32 s44, s43, 3
  s_and_b32 s44, s44, 3
  s_mul_i32 s44, s44, 5120
  s_add_u32 s44, s44, s38
  s_add_u32 s45, s44, 20480
  s_add_u32 s46, s44, 4096
  s_add_u32 s47, s44, 24576
  buffer_load_dwordx4 v[76:79], v4, s[12:15], s44 offen offset:0 sc1
  buffer_load_dwordx4 v[156:159], v4, s[12:15], s45 offen offset:0 sc1
  v_mfma_f32_16x16x32_bf16 v[240:243], v[200:203], v[132:135], v[240:243]
  v_mfma_f32_16x16x32_bf16 v[236:239], v[204:207], v[52:55], v[236:239]
  v_mfma_f32_16x16x32_bf16 v[244:247], v[204:207], v[132:135], v[244:247]
  s_waitcnt vmcnt(12)
  s_waitcnt lgkmcnt(0)
  v_mfma_f32_16x16x32_bf16 v[216:219], v[176:179], v[56:59], v[216:219]
  ds_read_b128 v[192:195], v4 offset:22528
  v_mfma_f32_16x16x32_bf16 v[224:227], v[176:179], v[136:139], v[224:227]
  ds_read_b128 v[196:199], v4 offset:23552
  v_mfma_f32_16x16x32_bf16 v[220:223], v[180:183], v[56:59], v[220:223]
  ds_read_b128 v[200:203], v5 offset:22528
  v_mfma_f32_16x16x32_bf16 v[228:231], v[180:183], v[136:139], v[228:231]
  ds_read_b128 v[204:207], v5 offset:23552
  v_mfma_f32_16x16x32_bf16 v[232:235], v[184:187], v[56:59], v[232:235]
  buffer_load_dwordx4 v[80:83], v4, s[12:15], s44 offen offset:1024 sc1
  buffer_load_dwordx4 v[160:163], v4, s[12:15], s45 offen offset:1024 sc1
  v_mfma_f32_16x16x32_bf16 v[240:243], v[184:187], v[136:139], v[240:243]
  v_mfma_f32_16x16x32_bf16 v[236:239], v[188:191], v[56:59], v[236:239]
  v_mfma_f32_16x16x32_bf16 v[244:247], v[188:191], v[136:139], v[244:247]
  s_waitcnt vmcnt(12)
  s_waitcnt lgkmcnt(0)
  v_mfma_f32_16x16x32_bf16 v[216:219], v[192:195], v[60:63], v[216:219]
  ds_read_b128 v[176:179], v4 offset:24576
  v_mfma_f32_16x16x32_bf16 v[224:227], v[192:195], v[140:143], v[224:227]
  ds_read_b128 v[180:183], v4 offset:25600
  v_mfma_f32_16x16x32_bf16 v[220:223], v[196:199], v[60:63], v[220:223]
  ds_read_b128 v[184:187], v5 offset:24576
  v_mfma_f32_16x16x32_bf16 v[228:231], v[196:199], v[140:143], v[228:231]
  ds_read_b128 v[188:191], v5 offset:25600
  v_mfma_f32_16x16x32_bf16 v[232:235], v[200:203], v[60:63], v[232:235]
  buffer_load_dwordx2 v[84:85], v7, s[12:15], s44 offen offset:2048 sc1
  buffer_load_dwordx2 v[86:87], v7, s[12:15], s44 offen offset:2560 sc1
  buffer_load_dwordx2 v[164:165], v7, s[12:15], s45 offen offset:2048 sc1
  buffer_load_dwordx2 v[166:167], v7, s[12:15], s45 offen offset:2560 sc1
  v_mfma_f32_16x16x32_bf16 v[240:243], v[200:203], v[140:143], v[240:243]
  v_mfma_f32_16x16x32_bf16 v[236:239], v[204:207], v[60:63], v[236:239]
  v_mfma_f32_16x16x32_bf16 v[244:247], v[204:207], v[140:143], v[244:247]
  s_waitcnt vmcnt(12)
  s_waitcnt lgkmcnt(0)
  v_mfma_f32_16x16x32_bf16 v[216:219], v[176:179], v[64:67], v[216:219]
  ds_read_b128 v[192:195], v4 offset:26624
  v_mfma_f32_16x16x32_bf16 v[224:227], v[176:179], v[144:147], v[224:227]
  ds_read_b128 v[196:199], v4 offset:27648
  v_mfma_f32_16x16x32_bf16 v[220:223], v[180:183], v[64:67], v[220:223]
  ds_read_b128 v[200:203], v5 offset:26624
  v_mfma_f32_16x16x32_bf16 v[228:231], v[180:183], v[144:147], v[228:231]
  ds_read_b128 v[204:207], v5 offset:27648
  v_mfma_f32_16x16x32_bf16 v[232:235], v[184:187], v[64:67], v[232:235]
  buffer_load_dwordx4 v[88:91], v4, s[12:15], s44 offen offset:3072 sc1
  buffer_load_dwordx4 v[168:171], v4, s[12:15], s45 offen offset:3072 sc1
  v_mfma_f32_16x16x32_bf16 v[240:243], v[184:187], v[144:147], v[240:243]
  v_mfma_f32_16x16x32_bf16 v[236:239], v[188:191], v[64:67], v[236:239]
  v_mfma_f32_16x16x32_bf16 v[244:247], v[188:191], v[144:147], v[244:247]
  s_waitcnt vmcnt(12)
  s_waitcnt lgkmcnt(0)
  v_mfma_f32_16x16x32_bf16 v[216:219], v[192:195], v[68:71], v[216:219]
  ds_read_b128 v[176:179], v4 offset:28672
  v_mfma_f32_16x16x32_bf16 v[224:227], v[192:195], v[148:151], v[224:227]
  ds_read_b128 v[180:183], v4 offset:29696
  v_mfma_f32_16x16x32_bf16 v[220:223], v[196:199], v[68:71], v[220:223]
  ds_read_b128 v[184:187], v5 offset:28672
  v_mfma_f32_16x16x32_bf16 v[228:231], v[196:199], v[148:151], v[228:231]
  ds_read_b128 v[188:191], v5 offset:29696
  v_mfma_f32_16x16x32_bf16 v[232:235], v[200:203], v[68:71], v[232:235]
  buffer_load_dwordx4 v[92:95], v4, s[12:15], s46 offen offset:0 sc1
  buffer_load_dwordx4 v[172:175], v4, s[12:15], s47 offen offset:0 sc1
  v_mfma_f32_16x16x32_bf16 v[240:243], v[200:203], v[148:151], v[240:243]
  v_mfma_f32_16x16x32_bf16 v[236:239], v[204:207], v[68:71], v[236:239]
  v_mfma_f32_16x16x32_bf16 v[244:247], v[204:207], v[148:151], v[244:247]
  s_waitcnt vmcnt(12)
  s_waitcnt lgkmcnt(0)
  v_mfma_f32_16x16x32_bf16 v[216:219], v[176:179], v[72:75], v[216:219]
  ds_read_b128 v[192:195], v4 offset:30720
  v_mfma_f32_16x16x32_bf16 v[224:227], v[176:179], v[152:155], v[224:227]
  ds_read_b128 v[196:199], v4 offset:31744
  v_mfma_f32_16x16x32_bf16 v[220:223], v[180:183], v[72:75], v[220:223]
  ds_read_b128 v[200:203], v5 offset:30720
  v_mfma_f32_16x16x32_bf16 v[228:231], v[180:183], v[152:155], v[228:231]
  ds_read_b128 v[204:207], v5 offset:31744
  v_mfma_f32_16x16x32_bf16 v[232:235], v[184:187], v[72:75], v[232:235]
  v_mfma_f32_16x16x32_bf16 v[240:243], v[184:187], v[152:155], v[240:243]
  v_mfma_f32_16x16x32_bf16 v[236:239], v[188:191], v[72:75], v[236:239]
  v_mfma_f32_16x16x32_bf16 v[244:247], v[188:191], v[152:155], v[244:247]
  s_waitcnt vmcnt(10)
  s_waitcnt lgkmcnt(0)
  v_mfma_f32_16x16x32_bf16 v[216:219], v[192:195], v[76:79], v[216:219]
  ds_read_b128 v[176:179], v4 offset:32768
  v_mfma_f32_16x16x32_bf16 v[224:227], v[192:195], v[156:159], v[224:227]
  ds_read_b128 v[180:183], v4 offset:33792
  v_mfma_f32_16x16x32_bf16 v[220:223], v[196:199], v[76:79], v[220:223]
  ds_read_b128 v[184:187], v5 offset:32768
  v_mfma_f32_16x16x32_bf16 v[228:231], v[196:199], v[156:159], v[228:231]
  ds_read_b128 v[188:191], v5 offset:33792
  v_mfma_f32_16x16x32_bf16 v[232:235], v[200:203], v[76:79], v[232:235]
  v_mfma_f32_16x16x32_bf16 v[240:243], v[200:203], v[156:159], v[240:243]
  v_mfma_f32_16x16x32_bf16 v[236:239], v[204:207], v[76:79], v[236:239]
  v_mfma_f32_16x16x32_bf16 v[244:247], v[204:207], v[156:159], v[244:247]
  s_waitcnt vmcnt(8)
  s_waitcnt lgkmcnt(0)
  v_mfma_f32_16x16x32_bf16 v[216:219], v[176:179], v[80:83], v[216:219]
  ds_read_b128 v[192:195], v4 offset:34816
  v_mfma_f32_16x16x32_bf16 v[224:227], v[176:179], v[160:163], v[224:227]
  ds_read_b128 v[196:199], v4 offset:35840
  v_mfma_f32_16x16x32_bf16 v[220:223], v[180:183], v[80:83], v[220:223]
  ds_read_b128 v[200:203], v5 offset:34816
  v_mfma_f32_16x16x32_bf16 v[228:231], v[180:183], v[160:163], v[228:231]
  ds_read_b128 v[204:207], v5 offset:35840
  v_mfma_f32_16x16x32_bf16 v[232:235], v[184:187], v[80:83], v[232:235]
  v_mfma_f32_16x16x32_bf16 v[240:243], v[184:187], v[160:163], v[240:243]
  v_mfma_f32_16x16x32_bf16 v[236:239], v[188:191], v[80:83], v[236:239]
  v_mfma_f32_16x16x32_bf16 v[244:247], v[188:191], v[160:163], v[244:247]
  s_waitcnt vmcnt(4)
  s_waitcnt lgkmcnt(0)
  v_mfma_f32_16x16x32_bf16 v[216:219], v[192:195], v[84:87], v[216:219]
  ds_read_b128 v[176:179], v4 offset:36864
  v_mfma_f32_16x16x32_bf16 v[224:227], v[192:195], v[164:167], v[224:227]
  ds_read_b128 v[180:183], v4 offset:37888
  v_mfma_f32_16x16x32_bf16 v[220:223], v[196:199], v[84:87], v[220:223]
  ds_read_b128 v[184:187], v5 offset:36864
  v_mfma_f32_16x16x32_bf16 v[228:231], v[196:199], v[164:167], v[228:231]
  ds_read_b128 v[188:191], v5 offset:37888
  v_mfma_f32_16x16x32_bf16 v[232:235], v[200:203], v[84:87], v[232:235]
  v_mfma_f32_16x16x32_bf16 v[240:243], v[200:203], v[164:167], v[240:243]
  v_mfma_f32_16x16x32_bf16 v[236:239], v[204:207], v[84:87], v[236:239]
  v_mfma_f32_16x16x32_bf16 v[244:247], v[204:207], v[164:167], v[244:247]
  s_waitcnt vmcnt(2)
  s_waitcnt lgkmcnt(0)
  v_mfma_f32_16x16x32_bf16 v[216:219], v[176:179], v[88:91], v[216:219]
  ds_read_b128 v[192:195], v4 offset:38912
  v_mfma_f32_16x16x32_bf16 v[224:227], v[176:179], v[168:171], v[224:227]
  ds_read_b128 v[196:199], v4 offset:39936
  v_mfma_f32_16x16x32_bf16 v[220:223], v[180:183], v[88:91], v[220:223]
  ds_read_b128 v[200:203], v5 offset:38912
  v_mfma_f32_16x16x32_bf16 v[228:231], v[180:183], v[168:171], v[228:231]
  ds_read_b128 v[204:207], v5 offset:39936
  v_mfma_f32_16x16x32_bf16 v[232:235], v[184:187], v[88:91], v[232:235]
  v_mfma_f32_16x16x32_bf16 v[240:243], v[184:187], v[168:171], v[240:243]
  v_mfma_f32_16x16x32_bf16 v[236:239], v[188:191], v[88:91], v[236:239]
  v_mfma_f32_16x16x32_bf16 v[244:247], v[188:191], v[168:171], v[244:247]
  s_waitcnt vmcnt(0)
  s_waitcnt lgkmcnt(0)
  s_barrier
  ds_read_b128 v[8:11], v14
  ds_read_b64 v[12:13], v14 offset:1024
  v_mfma_f32_16x16x32_bf16 v[216:219], v[192:195], v[92:95], v[216:219]
  ds_read_b128 v[176:179], v6 offset:0
  v_mfma_f32_16x16x32_bf16 v[224:227], v[192:195], v[172:175], v[224:227]
  ds_read_b128 v[180:183], v6 offset:1024
  v_mfma_f32_16x16x32_bf16 v[220:223], v[196:199], v[92:95], v[220:223]
  ds_read_b128 v[184:187], v6 offset:2048
  v_mfma_f32_16x16x32_bf16 v[228:231], v[196:199], v[172:175], v[228:231]
  ds_read_b128 v[188:191], v6 offset:3072
  v_mfma_f32_16x16x32_bf16 v[232:235], v[200:203], v[92:95], v[232:235]
  v_mfma_f32_16x16x32_bf16 v[240:243], v[200:203], v[172:175], v[240:243]
  v_mfma_f32_16x16x32_bf16 v[236:239], v[204:207], v[92:95], v[236:239]
  v_mfma_f32_16x16x32_bf16 v[244:247], v[204:207], v[172:175], v[244:247]
  ds_read_b128 v[192:195], v6 offset:4096
  ds_read_b128 v[196:199], v6 offset:5120
  s_waitcnt lgkmcnt(6)
  s_add_u32 s37, s24, 0
  s_lshr_b32 s36, s37, 1
  s_lshl_b32 s36, s36, 10
  s_add_u32 s36, s36, s35
  s_bitcmp1_b32 s37, 0
  s_cselect_b64 s[50:51], -1, 0
  s_cselect_b64 s[48:49], 0, -1
  s_cselect_b32 s52, s36, s53
  s_add_u32 s54, s52, 55296
  s_add_u32 s55, s52, 8
  s_add_u32 s56, s54, 8
  v_pk_mul_f32 v[220:221], v[216:217], v[220:221]
  v_pk_mul_f32 v[248:249], v[216:217], v[216:217]
  v_fma_f32 v248, v248, v9, v8
  v_fma_f32 v249, v249, v9, v8
  v_pk_mul_f32 v[216:217], v[248:249], v[216:217]
  v_exp_f32 v216, v216
  v_exp_f32 v217, v217
  v_fma_f32 v216, v216, v10, v10
  v_fma_f32 v217, v217, v10, v10
  v_rcp_f32 v216, v216
  v_rcp_f32 v217, v217
  s_nop 0
  v_pk_mul_f32 v[220:221], v[220:221], v[216:217]
  v_pk_mul_f32 v[222:223], v[218:219], v[222:223]
  v_pk_mul_f32 v[250:251], v[218:219], v[218:219]
  v_fma_f32 v250, v250, v9, v8
  v_fma_f32 v251, v251, v9, v8
  v_pk_mul_f32 v[218:219], v[250:251], v[218:219]
  v_exp_f32 v218, v218
  v_exp_f32 v219, v219
  v_fma_f32 v218, v218, v10, v10
  v_fma_f32 v219, v219, v10, v10
  v_rcp_f32 v218, v218
  v_rcp_f32 v219, v219
  s_nop 0
  v_pk_mul_f32 v[222:223], v[222:223], v[218:219]
  v_cvt_pk_bf16_f32 v2, v220, v221
  v_cvt_pk_bf16_f32 v3, v222, v223
  s_bitcmp1_b32 s37, 0
  s_cbranch_scc0 Lp4sh_17888_0_0
  buffer_store_dwordx2 v[2:3], v4, s[12:15], s55 offen sc0 sc1
Lp4sh_17888_0_0:
  v_cndmask_b32 v208, v208, v2, s[48:49]
  v_cndmask_b32 v209, v209, v3, s[48:49]
  v_pk_mul_f32 v[228:229], v[224:225], v[228:229]
  v_pk_mul_f32 v[252:253], v[224:225], v[224:225]
  v_fma_f32 v252, v252, v12, v11
  v_fma_f32 v253, v253, v12, v11
  v_pk_mul_f32 v[224:225], v[252:253], v[224:225]
  v_exp_f32 v224, v224
  v_exp_f32 v225, v225
  v_fma_f32 v224, v224, v13, v13
  v_fma_f32 v225, v225, v13, v13
  v_rcp_f32 v224, v224
  v_rcp_f32 v225, v225
  s_nop 0
  v_pk_mul_f32 v[228:229], v[228:229], v[224:225]
  v_pk_mul_f32 v[230:231], v[226:227], v[230:231]
  v_pk_mul_f32 v[254:255], v[226:227], v[226:227]
  v_fma_f32 v254, v254, v12, v11
  v_fma_f32 v255, v255, v12, v11
  v_pk_mul_f32 v[226:227], v[254:255], v[226:227]
  v_exp_f32 v226, v226
  v_exp_f32 v227, v227
  v_fma_f32 v226, v226, v13, v13
  v_fma_f32 v227, v227, v13, v13
  v_rcp_f32 v226, v226
  v_rcp_f32 v227, v227
  s_nop 0
  v_pk_mul_f32 v[230:231], v[230:231], v[226:227]
  v_cvt_pk_bf16_f32 v14, v228, v229
  v_cvt_pk_bf16_f32 v15, v230, v231
  s_bitcmp1_b32 s37, 0
  s_cbranch_scc0 Lp4sh_17888_0_1
  buffer_store_dwordx2 v[14:15], v4, s[12:15], s56 offen sc0 sc1
Lp4sh_17888_0_1:
  v_cndmask_b32 v212, v212, v14, s[48:49]
  v_cndmask_b32 v213, v213, v15, s[48:49]
  s_waitcnt lgkmcnt(4)
  v_mfma_f32_16x16x32_bf16 v[216:219], v[176:179], v[16:19], 0
  ds_read_b128 v[200:203], v6 offset:6144
  v_mfma_f32_16x16x32_bf16 v[224:227], v[176:179], v[96:99], 0
  ds_read_b128 v[204:207], v6 offset:7168
  v_mfma_f32_16x16x32_bf16 v[220:223], v[180:183], v[16:19], 0
  s_waitcnt lgkmcnt(4)
  v_mfma_f32_16x16x32_bf16 v[228:231], v[180:183], v[96:99], 0
  v_mfma_f32_16x16x32_bf16 v[216:219], v[184:187], v[20:23], v[216:219]
  ds_read_b128 v[176:179], v6 offset:8192
  s_add_u32 s37, s24, 1
  v_mfma_f32_16x16x32_bf16 v[224:227], v[184:187], v[100:103], v[224:227]
  ds_read_b128 v[180:183], v6 offset:9216
  s_lshr_b32 s36, s37, 1
  v_mfma_f32_16x16x32_bf16 v[220:223], v[188:191], v[20:23], v[220:223]
  s_waitcnt lgkmcnt(4)
  s_lshl_b32 s36, s36, 10
  v_mfma_f32_16x16x32_bf16 v[228:231], v[188:191], v[100:103], v[228:231]
  s_add_u32 s36, s36, s35
  s_bitcmp1_b32 s37, 0
  s_cselect_b64 s[50:51], -1, 0
  s_cselect_b64 s[48:49], 0, -1
  s_cselect_b32 s52, s36, s53
  s_add_u32 s54, s52, 55296
  v_mfma_f32_16x16x32_bf16 v[216:219], v[192:195], v[24:27], v[216:219]
  ds_read_b128 v[184:187], v6 offset:10240
  v_pk_mul_f32 v[236:237], v[232:233], v[236:237]
  v_mfma_f32_16x16x32_bf16 v[224:227], v[192:195], v[104:107], v[224:227]
  ds_read_b128 v[188:191], v6 offset:11264
  v_pk_mul_f32 v[248:249], v[232:233], v[232:233]
  v_mfma_f32_16x16x32_bf16 v[220:223], v[196:199], v[24:27], v[220:223]
  s_waitcnt lgkmcnt(4)
  v_fma_f32 v248, v248, v9, v8
  v_mfma_f32_16x16x32_bf16 v[228:231], v[196:199], v[104:107], v[228:231]
  v_fma_f32 v249, v249, v9, v8
  v_pk_mul_f32 v[232:233], v[248:249], v[232:233]
  v_mfma_f32_16x16x32_bf16 v[216:219], v[200:203], v[28:31], v[216:219]
  ds_read_b128 v[192:195], v6 offset:12288
  v_pk_mul_f32 v[238:239], v[234:235], v[238:239]
  v_mfma_f32_16x16x32_bf16 v[224:227], v[200:203], v[108:111], v[224:227]
  ds_read_b128 v[196:199], v6 offset:13312
  v_pk_mul_f32 v[250:251], v[234:235], v[234:235]
  v_mfma_f32_16x16x32_bf16 v[220:223], v[204:207], v[28:31], v[220:223]
  s_waitcnt lgkmcnt(4)
  v_fma_f32 v250, v250, v9, v8
  v_mfma_f32_16x16x32_bf16 v[228:231], v[204:207], v[108:111], v[228:231]
  v_exp_f32 v232, v232
  v_mfma_f32_16x16x32_bf16 v[216:219], v[176:179], v[32:35], v[216:219]
  ds_read_b128 v[200:203], v6 offset:14336
  v_fma_f32 v232, v232, v10, v10
  v_mfma_f32_16x16x32_bf16 v[224:227], v[176:179], v[112:115], v[224:227]
  ds_read_b128 v[204:207], v6 offset:15360
  v_fma_f32 v251, v251, v9, v8
  v_mfma_f32_16x16x32_bf16 v[220:223], v[180:183], v[32:35], v[220:223]
  s_waitcnt lgkmcnt(4)
  v_pk_mul_f32 v[234:235], v[250:251], v[234:235]
  v_mfma_f32_16x16x32_bf16 v[228:231], v[180:183], v[112:115], v[228:231]
  v_exp_f32 v233, v233
  v_mfma_f32_16x16x32_bf16 v[216:219], v[184:187], v[36:39], v[216:219]
  ds_read_b128 v[176:179], v6 offset:16384
  v_fma_f32 v233, v233, v10, v10
  v_mfma_f32_16x16x32_bf16 v[224:227], v[184:187], v[116:119], v[224:227]
  ds_read_b128 v[180:183], v6 offset:17408
  v_pk_mul_f32 v[244:245], v[240:241], v[244:245]
  v_mfma_f32_16x16x32_bf16 v[220:223], v[188:191], v[36:39], v[220:223]
  s_waitcnt lgkmcnt(4)
  v_pk_mul_f32 v[252:253], v[240:241], v[240:241]
  v_mfma_f32_16x16x32_bf16 v[228:231], v[188:191], v[116:119], v[228:231]
  v_rcp_f32 v232, v232
  v_mfma_f32_16x16x32_bf16 v[216:219], v[192:195], v[40:43], v[216:219]
  ds_read_b128 v[184:187], v6 offset:18432
  v_fma_f32 v252, v252, v12, v11
  v_mfma_f32_16x16x32_bf16 v[224:227], v[192:195], v[120:123], v[224:227]
  ds_read_b128 v[188:191], v6 offset:19456
  v_fma_f32 v253, v253, v12, v11
  v_mfma_f32_16x16x32_bf16 v[220:223], v[196:199], v[40:43], v[220:223]
  s_waitcnt lgkmcnt(4)
  v_pk_mul_f32 v[240:241], v[252:253], v[240:241]
  v_mfma_f32_16x16x32_bf16 v[228:231], v[196:199], v[120:123], v[228:231]
  v_rcp_f32 v233, v233
  v_mfma_f32_16x16x32_bf16 v[216:219], v[200:203], v[44:47], v[216:219]
  ds_read_b128 v[192:195], v6 offset:20480
  v_pk_mul_f32 v[236:237], v[236:237], v[232:233]
  v_mfma_f32_16x16x32_bf16 v[224:227], v[200:203], v[124:127], v[224:227]
  ds_read_b128 v[196:199], v6 offset:21504
  v_cvt_pk_bf16_f32 v2, v236, v237
  v_mfma_f32_16x16x32_bf16 v[220:223], v[204:207], v[44:47], v[220:223]
  s_waitcnt lgkmcnt(4)
  v_mov_b32 v210, v2
  v_mfma_f32_16x16x32_bf16 v[228:231], v[204:207], v[124:127], v[228:231]
  v_exp_f32 v234, v234
  v_mfma_f32_16x16x32_bf16 v[216:219], v[176:179], v[48:51], v[216:219]
  ds_read_b128 v[200:203], v6 offset:22528
  v_fma_f32 v234, v234, v10, v10
  v_mfma_f32_16x16x32_bf16 v[224:227], v[176:179], v[128:131], v[224:227]
  ds_read_b128 v[204:207], v6 offset:23552
  v_pk_mul_f32 v[246:247], v[242:243], v[246:247]
  v_mfma_f32_16x16x32_bf16 v[220:223], v[180:183], v[48:51], v[220:223]
  s_waitcnt lgkmcnt(4)
  v_pk_mul_f32 v[254:255], v[242:243], v[242:243]
  v_mfma_f32_16x16x32_bf16 v[228:231], v[180:183], v[128:131], v[228:231]
  v_exp_f32 v235, v235
  v_mfma_f32_16x16x32_bf16 v[216:219], v[184:187], v[52:55], v[216:219]
  ds_read_b128 v[176:179], v6 offset:24576
  v_fma_f32 v235, v235, v10, v10
  v_mfma_f32_16x16x32_bf16 v[224:227], v[184:187], v[132:135], v[224:227]
  ds_read_b128 v[180:183], v6 offset:25600
  v_fma_f32 v254, v254, v12, v11
  v_mfma_f32_16x16x32_bf16 v[220:223], v[188:191], v[52:55], v[220:223]
  s_waitcnt lgkmcnt(4)
  v_fma_f32 v255, v255, v12, v11
  v_mfma_f32_16x16x32_bf16 v[228:231], v[188:191], v[132:135], v[228:231]
  v_rcp_f32 v234, v234
  v_mfma_f32_16x16x32_bf16 v[216:219], v[192:195], v[56:59], v[216:219]
  ds_read_b128 v[184:187], v6 offset:26624
  v_pk_mul_f32 v[242:243], v[254:255], v[242:243]
  v_mfma_f32_16x16x32_bf16 v[224:227], v[192:195], v[136:139], v[224:227]
  ds_read_b128 v[188:191], v6 offset:27648
  v_mfma_f32_16x16x32_bf16 v[220:223], v[196:199], v[56:59], v[220:223]
  s_waitcnt lgkmcnt(4)
  v_mfma_f32_16x16x32_bf16 v[228:231], v[196:199], v[136:139], v[228:231]
  v_rcp_f32 v235, v235
  v_mfma_f32_16x16x32_bf16 v[216:219], v[200:203], v[60:63], v[216:219]
  ds_read_b128 v[192:195], v6 offset:28672
  v_pk_mul_f32 v[238:239], v[238:239], v[234:235]
  v_mfma_f32_16x16x32_bf16 v[224:227], v[200:203], v[140:143], v[224:227]
  ds_read_b128 v[196:199], v6 offset:29696
  v_cvt_pk_bf16_f32 v3, v238, v239
  v_mfma_f32_16x16x32_bf16 v[220:223], v[204:207], v[60:63], v[220:223]
  s_waitcnt lgkmcnt(4)
  v_mov_b32 v211, v3
  v_mfma_f32_16x16x32_bf16 v[228:231], v[204:207], v[140:143], v[228:231]
  v_exp_f32 v240, v240
  v_mfma_f32_16x16x32_bf16 v[216:219], v[176:179], v[64:67], v[216:219]
  ds_read_b128 v[200:203], v6 offset:30720
  s_bitcmp1_b32 s37, 0
  s_cbranch_scc0 Lp4st_17888_1_0
  buffer_store_dwordx4 v[208:211], v4, s[12:15], s52 offen sc0 sc1
Lp4st_17888_1_0:
  v_mfma_f32_16x16x32_bf16 v[224:227], v[176:179], v[144:147], v[224:227]
  ds_read_b128 v[204:207], v6 offset:31744
  v_cndmask_b32 v208, v208, v2, s[48:49]
  v_mfma_f32_16x16x32_bf16 v[220:223], v[180:183], v[64:67], v[220:223]
  s_waitcnt lgkmcnt(4)
  v_cndmask_b32 v209, v209, v3, s[48:49]
  v_mfma_f32_16x16x32_bf16 v[228:231], v[180:183], v[144:147], v[228:231]
  v_exp_f32 v241, v241
  v_mfma_f32_16x16x32_bf16 v[216:219], v[184:187], v[68:71], v[216:219]
  ds_read_b128 v[176:179], v6 offset:32768
  v_fma_f32 v240, v240, v13, v13
  v_mfma_f32_16x16x32_bf16 v[224:227], v[184:187], v[148:151], v[224:227]
  ds_read_b128 v[180:183], v6 offset:33792
  v_fma_f32 v241, v241, v13, v13
  v_mfma_f32_16x16x32_bf16 v[220:223], v[188:191], v[68:71], v[220:223]
  s_waitcnt lgkmcnt(4)
  v_mfma_f32_16x16x32_bf16 v[228:231], v[188:191], v[148:151], v[228:231]
  v_rcp_f32 v240, v240
  v_mfma_f32_16x16x32_bf16 v[216:219], v[192:195], v[72:75], v[216:219]
  ds_read_b128 v[184:187], v6 offset:34816
  v_mfma_f32_16x16x32_bf16 v[224:227], v[192:195], v[152:155], v[224:227]
  ds_read_b128 v[188:191], v6 offset:35840
  v_mfma_f32_16x16x32_bf16 v[220:223], v[196:199], v[72:75], v[220:223]
  s_waitcnt lgkmcnt(4)
  v_mfma_f32_16x16x32_bf16 v[228:231], v[196:199], v[152:155], v[228:231]
  v_rcp_f32 v241, v241
  v_mfma_f32_16x16x32_bf16 v[216:219], v[200:203], v[76:79], v[216:219]
  ds_read_b128 v[192:195], v6 offset:36864
  v_pk_mul_f32 v[244:245], v[244:245], v[240:241]
  v_mfma_f32_16x16x32_bf16 v[224:227], v[200:203], v[156:159], v[224:227]
  ds_read_b128 v[196:199], v6 offset:37888
  v_cvt_pk_bf16_f32 v14, v244, v245
  v_mfma_f32_16x16x32_bf16 v[220:223], v[204:207], v[76:79], v[220:223]
  s_waitcnt lgkmcnt(4)
  v_mov_b32 v214, v14
  v_mfma_f32_16x16x32_bf16 v[228:231], v[204:207], v[156:159], v[228:231]
  v_exp_f32 v242, v242
  v_mfma_f32_16x16x32_bf16 v[216:219], v[176:179], v[80:83], v[216:219]
  ds_read_b128 v[200:203], v6 offset:38912
  v_fma_f32 v242, v242, v13, v13
  v_mfma_f32_16x16x32_bf16 v[224:227], v[176:179], v[160:163], v[224:227]
  ds_read_b128 v[204:207], v6 offset:39936
  v_mfma_f32_16x16x32_bf16 v[220:223], v[180:183], v[80:83], v[220:223]
  s_waitcnt lgkmcnt(4)
  v_mfma_f32_16x16x32_bf16 v[228:231], v[180:183], v[160:163], v[228:231]
  v_exp_f32 v243, v243
  s_waitcnt lgkmcnt(0)
  s_barrier
  v_mfma_f32_16x16x32_bf16 v[216:219], v[184:187], v[84:87], v[216:219]
  ds_read_b128 v[176:179], v4 offset:0
  v_fma_f32 v243, v243, v13, v13
  v_mfma_f32_16x16x32_bf16 v[224:227], v[184:187], v[164:167], v[224:227]
  ds_read_b128 v[180:183], v4 offset:1024
  v_mfma_f32_16x16x32_bf16 v[220:223], v[188:191], v[84:87], v[220:223]
  v_rcp_f32 v242, v242
  v_mfma_f32_16x16x32_bf16 v[228:231], v[188:191], v[164:167], v[228:231]
  v_rcp_f32 v243, v243
  v_mfma_f32_16x16x32_bf16 v[216:219], v[192:195], v[88:91], v[216:219]
  ds_read_b128 v[184:187], v4 offset:2048
  v_pk_mul_f32 v[246:247], v[246:247], v[242:243]
  v_mfma_f32_16x16x32_bf16 v[224:227], v[192:195], v[168:171], v[224:227]
  ds_read_b128 v[188:191], v4 offset:3072
  v_cvt_pk_bf16_f32 v15, v246, v247
  v_mfma_f32_16x16x32_bf16 v[220:223], v[196:199], v[88:91], v[220:223]
  v_mov_b32 v215, v15
  s_bitcmp1_b32 s37, 0
  s_cbranch_scc0 Lp4st_17888_1_1
  buffer_store_dwordx4 v[212:215], v4, s[12:15], s54 offen sc0 sc1
Lp4st_17888_1_1:
  v_mfma_f32_16x16x32_bf16 v[228:231], v[196:199], v[168:171], v[228:231]
  s_nop 0
  v_cndmask_b32 v212, v212, v14, s[48:49]
  v_cndmask_b32 v213, v213, v15, s[48:49]
  v_mfma_f32_16x16x32_bf16 v[216:219], v[200:203], v[92:95], v[216:219]
  ds_read_b128 v[192:195], v4 offset:4096
  v_mfma_f32_16x16x32_bf16 v[224:227], v[200:203], v[172:175], v[224:227]
  ds_read_b128 v[196:199], v4 offset:5120
  v_mfma_f32_16x16x32_bf16 v[220:223], v[204:207], v[92:95], v[220:223]
  s_waitcnt lgkmcnt(4)
  v_mfma_f32_16x16x32_bf16 v[228:231], v[204:207], v[172:175], v[228:231]
  v_mfma_f32_16x16x32_bf16 v[232:235], v[176:179], v[16:19], 0
  ds_read_b128 v[200:203], v4 offset:6144
  v_mfma_f32_16x16x32_bf16 v[240:243], v[176:179], v[96:99], 0
  ds_read_b128 v[204:207], v4 offset:7168
  v_mfma_f32_16x16x32_bf16 v[236:239], v[180:183], v[16:19], 0
  s_waitcnt lgkmcnt(4)
  v_mfma_f32_16x16x32_bf16 v[244:247], v[180:183], v[96:99], 0
  v_mfma_f32_16x16x32_bf16 v[232:235], v[184:187], v[20:23], v[232:235]
  ds_read_b128 v[176:179], v4 offset:8192
  s_add_u32 s37, s24, 2
  v_mfma_f32_16x16x32_bf16 v[240:243], v[184:187], v[100:103], v[240:243]
  ds_read_b128 v[180:183], v4 offset:9216
  s_lshr_b32 s36, s37, 1
  v_mfma_f32_16x16x32_bf16 v[236:239], v[188:191], v[20:23], v[236:239]
  s_waitcnt lgkmcnt(4)
  s_lshl_b32 s36, s36, 10
  v_mfma_f32_16x16x32_bf16 v[244:247], v[188:191], v[100:103], v[244:247]
  s_add_u32 s36, s36, s35
  s_bitcmp1_b32 s37, 0
  s_cselect_b64 s[50:51], -1, 0
  s_cselect_b64 s[48:49], 0, -1
  s_cselect_b32 s52, s36, s53
  s_add_u32 s54, s52, 55296
  v_mfma_f32_16x16x32_bf16 v[232:235], v[192:195], v[24:27], v[232:235]
  ds_read_b128 v[184:187], v4 offset:10240
  v_pk_mul_f32 v[220:221], v[216:217], v[220:221]
  v_mfma_f32_16x16x32_bf16 v[240:243], v[192:195], v[104:107], v[240:243]
  ds_read_b128 v[188:191], v4 offset:11264
  v_pk_mul_f32 v[248:249], v[216:217], v[216:217]
  v_mfma_f32_16x16x32_bf16 v[236:239], v[196:199], v[24:27], v[236:239]
  s_waitcnt lgkmcnt(4)
  v_fma_f32 v248, v248, v9, v8
  v_mfma_f32_16x16x32_bf16 v[244:247], v[196:199], v[104:107], v[244:247]
  v_fma_f32 v249, v249, v9, v8
  v_pk_mul_f32 v[216:217], v[248:249], v[216:217]
  v_mfma_f32_16x16x32_bf16 v[232:235], v[200:203], v[28:31], v[232:235]
  ds_read_b128 v[192:195], v4 offset:12288
  v_pk_mul_f32 v[222:223], v[218:219], v[222:223]
  v_mfma_f32_16x16x32_bf16 v[240:243], v[200:203], v[108:111], v[240:243]
  ds_read_b128 v[196:199], v4 offset:13312
  v_pk_mul_f32 v[250:251], v[218:219], v[218:219]
  v_mfma_f32_16x16x32_bf16 v[236:239], v[204:207], v[28:31], v[236:239]
  s_waitcnt lgkmcnt(4)
  v_fma_f32 v250, v250, v9, v8
  v_mfma_f32_16x16x32_bf16 v[244:247], v[204:207], v[108:111], v[244:247]
  v_exp_f32 v216, v216
  v_mfma_f32_16x16x32_bf16 v[232:235], v[176:179], v[32:35], v[232:235]
  ds_read_b128 v[200:203], v4 offset:14336
  v_fma_f32 v216, v216, v10, v10
  v_mfma_f32_16x16x32_bf16 v[240:243], v[176:179], v[112:115], v[240:243]
  ds_read_b128 v[204:207], v4 offset:15360
  v_fma_f32 v251, v251, v9, v8
  v_mfma_f32_16x16x32_bf16 v[236:239], v[180:183], v[32:35], v[236:239]
  s_waitcnt lgkmcnt(4)
  v_pk_mul_f32 v[218:219], v[250:251], v[218:219]
  v_mfma_f32_16x16x32_bf16 v[244:247], v[180:183], v[112:115], v[244:247]
  v_exp_f32 v217, v217
  v_mfma_f32_16x16x32_bf16 v[232:235], v[184:187], v[36:39], v[232:235]
  ds_read_b128 v[176:179], v4 offset:16384
  v_fma_f32 v217, v217, v10, v10
  v_mfma_f32_16x16x32_bf16 v[240:243], v[184:187], v[116:119], v[240:243]
  ds_read_b128 v[180:183], v4 offset:17408
  v_pk_mul_f32 v[228:229], v[224:225], v[228:229]
  v_mfma_f32_16x16x32_bf16 v[236:239], v[188:191], v[36:39], v[236:239]
  s_waitcnt lgkmcnt(4)
  v_pk_mul_f32 v[252:253], v[224:225], v[224:225]
  v_mfma_f32_16x16x32_bf16 v[244:247], v[188:191], v[116:119], v[244:247]
  v_rcp_f32 v216, v216
  v_mfma_f32_16x16x32_bf16 v[232:235], v[192:195], v[40:43], v[232:235]
  ds_read_b128 v[184:187], v4 offset:18432
  v_fma_f32 v252, v252, v12, v11
  v_mfma_f32_16x16x32_bf16 v[240:243], v[192:195], v[120:123], v[240:243]
  ds_read_b128 v[188:191], v4 offset:19456
  v_fma_f32 v253, v253, v12, v11
  v_mfma_f32_16x16x32_bf16 v[236:239], v[196:199], v[40:43], v[236:239]
  s_waitcnt lgkmcnt(4)
  v_pk_mul_f32 v[224:225], v[252:253], v[224:225]
  v_mfma_f32_16x16x32_bf16 v[244:247], v[196:199], v[120:123], v[244:247]
  v_rcp_f32 v217, v217
  v_mfma_f32_16x16x32_bf16 v[232:235], v[200:203], v[44:47], v[232:235]
  ds_read_b128 v[192:195], v4 offset:20480
  v_pk_mul_f32 v[220:221], v[220:221], v[216:217]
  v_mfma_f32_16x16x32_bf16 v[240:243], v[200:203], v[124:127], v[240:243]
  ds_read_b128 v[196:199], v4 offset:21504
  v_cvt_pk_bf16_f32 v2, v220, v221
  v_mfma_f32_16x16x32_bf16 v[236:239], v[204:207], v[44:47], v[236:239]
  s_waitcnt lgkmcnt(4)
  v_mov_b32 v210, v2
  v_mfma_f32_16x16x32_bf16 v[244:247], v[204:207], v[124:127], v[244:247]
  v_exp_f32 v218, v218
  v_mfma_f32_16x16x32_bf16 v[232:235], v[176:179], v[48:51], v[232:235]
  ds_read_b128 v[200:203], v4 offset:22528
  v_fma_f32 v218, v218, v10, v10
  v_mfma_f32_16x16x32_bf16 v[240:243], v[176:179], v[128:131], v[240:243]
  ds_read_b128 v[204:207], v4 offset:23552
  v_pk_mul_f32 v[230:231], v[226:227], v[230:231]
  v_mfma_f32_16x16x32_bf16 v[236:239], v[180:183], v[48:51], v[236:239]
  s_waitcnt lgkmcnt(4)
  v_pk_mul_f32 v[254:255], v[226:227], v[226:227]
  v_mfma_f32_16x16x32_bf16 v[244:247], v[180:183], v[128:131], v[244:247]
  v_exp_f32 v219, v219
  v_mfma_f32_16x16x32_bf16 v[232:235], v[184:187], v[52:55], v[232:235]
  ds_read_b128 v[176:179], v4 offset:24576
  v_fma_f32 v219, v219, v10, v10
  v_mfma_f32_16x16x32_bf16 v[240:243], v[184:187], v[132:135], v[240:243]
  ds_read_b128 v[180:183], v4 offset:25600
  v_fma_f32 v254, v254, v12, v11
  v_mfma_f32_16x16x32_bf16 v[236:239], v[188:191], v[52:55], v[236:239]
  s_waitcnt lgkmcnt(4)
  v_fma_f32 v255, v255, v12, v11
  v_mfma_f32_16x16x32_bf16 v[244:247], v[188:191], v[132:135], v[244:247]
  v_rcp_f32 v218, v218
  v_mfma_f32_16x16x32_bf16 v[232:235], v[192:195], v[56:59], v[232:235]
  ds_read_b128 v[184:187], v4 offset:26624
  v_pk_mul_f32 v[226:227], v[254:255], v[226:227]
  v_mfma_f32_16x16x32_bf16 v[240:243], v[192:195], v[136:139], v[240:243]
  ds_read_b128 v[188:191], v4 offset:27648
  v_mfma_f32_16x16x32_bf16 v[236:239], v[196:199], v[56:59], v[236:239]
  s_waitcnt lgkmcnt(4)
  v_mfma_f32_16x16x32_bf16 v[244:247], v[196:199], v[136:139], v[244:247]
  v_rcp_f32 v219, v219
  v_mfma_f32_16x16x32_bf16 v[232:235], v[200:203], v[60:63], v[232:235]
  ds_read_b128 v[192:195], v4 offset:28672
  v_pk_mul_f32 v[222:223], v[222:223], v[218:219]
  v_mfma_f32_16x16x32_bf16 v[240:243], v[200:203], v[140:143], v[240:243]
  ds_read_b128 v[196:199], v4 offset:29696
  v_cvt_pk_bf16_f32 v3, v222, v223
  v_mfma_f32_16x16x32_bf16 v[236:239], v[204:207], v[60:63], v[236:239]
  s_waitcnt lgkmcnt(4)
  v_mov_b32 v211, v3
  v_mfma_f32_16x16x32_bf16 v[244:247], v[204:207], v[140:143], v[244:247]
  v_exp_f32 v224, v224
  v_mfma_f32_16x16x32_bf16 v[232:235], v[176:179], v[64:67], v[232:235]
  ds_read_b128 v[200:203], v4 offset:30720
  s_bitcmp1_b32 s37, 0
  s_cbranch_scc0 Lp4st_17888_2_0
  buffer_store_dwordx4 v[208:211], v4, s[12:15], s52 offen sc0 sc1
Lp4st_17888_2_0:
  v_mfma_f32_16x16x32_bf16 v[240:243], v[176:179], v[144:147], v[240:243]
  ds_read_b128 v[204:207], v4 offset:31744
  v_cndmask_b32 v208, v208, v2, s[48:49]
  v_mfma_f32_16x16x32_bf16 v[236:239], v[180:183], v[64:67], v[236:239]
  s_waitcnt lgkmcnt(4)
  v_cndmask_b32 v209, v209, v3, s[48:49]
  v_mfma_f32_16x16x32_bf16 v[244:247], v[180:183], v[144:147], v[244:247]
  v_exp_f32 v225, v225
  v_mfma_f32_16x16x32_bf16 v[232:235], v[184:187], v[68:71], v[232:235]
  ds_read_b128 v[176:179], v4 offset:32768
  v_fma_f32 v224, v224, v13, v13
  v_mfma_f32_16x16x32_bf16 v[240:243], v[184:187], v[148:151], v[240:243]
  ds_read_b128 v[180:183], v4 offset:33792
  v_fma_f32 v225, v225, v13, v13
  v_mfma_f32_16x16x32_bf16 v[236:239], v[188:191], v[68:71], v[236:239]
  s_waitcnt lgkmcnt(4)
  v_mfma_f32_16x16x32_bf16 v[244:247], v[188:191], v[148:151], v[244:247]
  v_rcp_f32 v224, v224
  v_mfma_f32_16x16x32_bf16 v[232:235], v[192:195], v[72:75], v[232:235]
  ds_read_b128 v[184:187], v4 offset:34816
  v_mfma_f32_16x16x32_bf16 v[240:243], v[192:195], v[152:155], v[240:243]
  ds_read_b128 v[188:191], v4 offset:35840
  v_mfma_f32_16x16x32_bf16 v[236:239], v[196:199], v[72:75], v[236:239]
  s_waitcnt lgkmcnt(4)
  v_mfma_f32_16x16x32_bf16 v[244:247], v[196:199], v[152:155], v[244:247]
  v_rcp_f32 v225, v225
  v_mfma_f32_16x16x32_bf16 v[232:235], v[200:203], v[76:79], v[232:235]
  ds_read_b128 v[192:195], v4 offset:36864
  v_pk_mul_f32 v[228:229], v[228:229], v[224:225]
  v_mfma_f32_16x16x32_bf16 v[240:243], v[200:203], v[156:159], v[240:243]
  ds_read_b128 v[196:199], v4 offset:37888
  v_cvt_pk_bf16_f32 v14, v228, v229
  v_mfma_f32_16x16x32_bf16 v[236:239], v[204:207], v[76:79], v[236:239]
  s_waitcnt lgkmcnt(4)
  v_mov_b32 v214, v14
  v_mfma_f32_16x16x32_bf16 v[244:247], v[204:207], v[156:159], v[244:247]
  v_exp_f32 v226, v226
  v_mfma_f32_16x16x32_bf16 v[232:235], v[176:179], v[80:83], v[232:235]
  ds_read_b128 v[200:203], v4 offset:38912
  v_fma_f32 v226, v226, v13, v13
  v_mfma_f32_16x16x32_bf16 v[240:243], v[176:179], v[160:163], v[240:243]
  ds_read_b128 v[204:207], v4 offset:39936
  v_mfma_f32_16x16x32_bf16 v[236:239], v[180:183], v[80:83], v[236:239]
  s_waitcnt lgkmcnt(4)
  v_mfma_f32_16x16x32_bf16 v[244:247], v[180:183], v[160:163], v[244:247]
  v_exp_f32 v227, v227
  s_waitcnt lgkmcnt(0)
  s_barrier
  v_mfma_f32_16x16x32_bf16 v[232:235], v[184:187], v[84:87], v[232:235]
  ds_read_b128 v[176:179], v5 offset:0
  v_fma_f32 v227, v227, v13, v13
  v_mfma_f32_16x16x32_bf16 v[240:243], v[184:187], v[164:167], v[240:243]
  ds_read_b128 v[180:183], v5 offset:1024
  v_mfma_f32_16x16x32_bf16 v[236:239], v[188:191], v[84:87], v[236:239]
  v_rcp_f32 v226, v226
  v_mfma_f32_16x16x32_bf16 v[244:247], v[188:191], v[164:167], v[244:247]
  v_rcp_f32 v227, v227
  v_mfma_f32_16x16x32_bf16 v[232:235], v[192:195], v[88:91], v[232:235]
  ds_read_b128 v[184:187], v5 offset:2048
  v_pk_mul_f32 v[230:231], v[230:231], v[226:227]
  v_mfma_f32_16x16x32_bf16 v[240:243], v[192:195], v[168:171], v[240:243]
  ds_read_b128 v[188:191], v5 offset:3072
  v_cvt_pk_bf16_f32 v15, v230, v231
  v_mfma_f32_16x16x32_bf16 v[236:239], v[196:199], v[88:91], v[236:239]
  v_mov_b32 v215, v15
  s_bitcmp1_b32 s37, 0
  s_cbranch_scc0 Lp4st_17888_2_1
  buffer_store_dwordx4 v[212:215], v4, s[12:15], s54 offen sc0 sc1
Lp4st_17888_2_1:
  v_mfma_f32_16x16x32_bf16 v[244:247], v[196:199], v[168:171], v[244:247]
  s_nop 0
  v_cndmask_b32 v212, v212, v14, s[48:49]
  v_cndmask_b32 v213, v213, v15, s[48:49]
  v_mfma_f32_16x16x32_bf16 v[232:235], v[200:203], v[92:95], v[232:235]
  ds_read_b128 v[192:195], v5 offset:4096
  v_mfma_f32_16x16x32_bf16 v[240:243], v[200:203], v[172:175], v[240:243]
  ds_read_b128 v[196:199], v5 offset:5120
  v_mfma_f32_16x16x32_bf16 v[236:239], v[204:207], v[92:95], v[236:239]
  s_waitcnt lgkmcnt(4)
  v_mfma_f32_16x16x32_bf16 v[244:247], v[204:207], v[172:175], v[244:247]
  v_mfma_f32_16x16x32_bf16 v[216:219], v[176:179], v[16:19], 0
  ds_read_b128 v[200:203], v5 offset:6144
  v_mfma_f32_16x16x32_bf16 v[224:227], v[176:179], v[96:99], 0
  ds_read_b128 v[204:207], v5 offset:7168
  v_mfma_f32_16x16x32_bf16 v[220:223], v[180:183], v[16:19], 0
  s_waitcnt lgkmcnt(4)
  v_mfma_f32_16x16x32_bf16 v[228:231], v[180:183], v[96:99], 0
  v_mfma_f32_16x16x32_bf16 v[216:219], v[184:187], v[20:23], v[216:219]
  ds_read_b128 v[176:179], v5 offset:8192
  s_add_u32 s37, s24, 3
  v_mfma_f32_16x16x32_bf16 v[224:227], v[184:187], v[100:103], v[224:227]
  ds_read_b128 v[180:183], v5 offset:9216
  s_lshr_b32 s36, s37, 1
  v_mfma_f32_16x16x32_bf16 v[220:223], v[188:191], v[20:23], v[220:223]
  s_waitcnt lgkmcnt(4)
  s_lshl_b32 s36, s36, 10
  v_mfma_f32_16x16x32_bf16 v[228:231], v[188:191], v[100:103], v[228:231]
  s_add_u32 s36, s36, s35
  s_bitcmp1_b32 s37, 0
  s_cselect_b64 s[50:51], -1, 0
  s_cselect_b64 s[48:49], 0, -1
  s_cselect_b32 s52, s36, s53
  s_add_u32 s54, s52, 55296
  v_mfma_f32_16x16x32_bf16 v[216:219], v[192:195], v[24:27], v[216:219]
  ds_read_b128 v[184:187], v5 offset:10240
  v_pk_mul_f32 v[236:237], v[232:233], v[236:237]
  v_mfma_f32_16x16x32_bf16 v[224:227], v[192:195], v[104:107], v[224:227]
  ds_read_b128 v[188:191], v5 offset:11264
  v_pk_mul_f32 v[248:249], v[232:233], v[232:233]
  v_mfma_f32_16x16x32_bf16 v[220:223], v[196:199], v[24:27], v[220:223]
  s_waitcnt lgkmcnt(4)
  v_fma_f32 v248, v248, v9, v8
  v_mfma_f32_16x16x32_bf16 v[228:231], v[196:199], v[104:107], v[228:231]
  v_fma_f32 v249, v249, v9, v8
  v_pk_mul_f32 v[232:233], v[248:249], v[232:233]
  v_mfma_f32_16x16x32_bf16 v[216:219], v[200:203], v[28:31], v[216:219]
  ds_read_b128 v[192:195], v5 offset:12288
  v_pk_mul_f32 v[238:239], v[234:235], v[238:239]
  v_mfma_f32_16x16x32_bf16 v[224:227], v[200:203], v[108:111], v[224:227]
  ds_read_b128 v[196:199], v5 offset:13312
  v_pk_mul_f32 v[250:251], v[234:235], v[234:235]
  v_mfma_f32_16x16x32_bf16 v[220:223], v[204:207], v[28:31], v[220:223]
  s_waitcnt lgkmcnt(4)
  v_fma_f32 v250, v250, v9, v8
  v_mfma_f32_16x16x32_bf16 v[228:231], v[204:207], v[108:111], v[228:231]
  v_exp_f32 v232, v232
  v_mfma_f32_16x16x32_bf16 v[216:219], v[176:179], v[32:35], v[216:219]
  ds_read_b128 v[200:203], v5 offset:14336
  v_fma_f32 v232, v232, v10, v10
  v_mfma_f32_16x16x32_bf16 v[224:227], v[176:179], v[112:115], v[224:227]
  ds_read_b128 v[204:207], v5 offset:15360
  v_fma_f32 v251, v251, v9, v8
  v_mfma_f32_16x16x32_bf16 v[220:223], v[180:183], v[32:35], v[220:223]
  s_waitcnt lgkmcnt(4)
  v_pk_mul_f32 v[234:235], v[250:251], v[234:235]
  v_mfma_f32_16x16x32_bf16 v[228:231], v[180:183], v[112:115], v[228:231]
  v_exp_f32 v233, v233
  v_mfma_f32_16x16x32_bf16 v[216:219], v[184:187], v[36:39], v[216:219]
  ds_read_b128 v[176:179], v5 offset:16384
  v_fma_f32 v233, v233, v10, v10
  v_mfma_f32_16x16x32_bf16 v[224:227], v[184:187], v[116:119], v[224:227]
  ds_read_b128 v[180:183], v5 offset:17408
  v_pk_mul_f32 v[244:245], v[240:241], v[244:245]
  v_mfma_f32_16x16x32_bf16 v[220:223], v[188:191], v[36:39], v[220:223]
  s_waitcnt lgkmcnt(4)
  v_pk_mul_f32 v[252:253], v[240:241], v[240:241]
  v_mfma_f32_16x16x32_bf16 v[228:231], v[188:191], v[116:119], v[228:231]
  v_rcp_f32 v232, v232
  v_mfma_f32_16x16x32_bf16 v[216:219], v[192:195], v[40:43], v[216:219]
  ds_read_b128 v[184:187], v5 offset:18432
  v_fma_f32 v252, v252, v12, v11
  v_mfma_f32_16x16x32_bf16 v[224:227], v[192:195], v[120:123], v[224:227]
  ds_read_b128 v[188:191], v5 offset:19456
  v_fma_f32 v253, v253, v12, v11
  v_mfma_f32_16x16x32_bf16 v[220:223], v[196:199], v[40:43], v[220:223]
  s_waitcnt lgkmcnt(4)
  v_pk_mul_f32 v[240:241], v[252:253], v[240:241]
  v_mfma_f32_16x16x32_bf16 v[228:231], v[196:199], v[120:123], v[228:231]
  v_rcp_f32 v233, v233
  v_mfma_f32_16x16x32_bf16 v[216:219], v[200:203], v[44:47], v[216:219]
  ds_read_b128 v[192:195], v5 offset:20480
  v_pk_mul_f32 v[236:237], v[236:237], v[232:233]
  v_mfma_f32_16x16x32_bf16 v[224:227], v[200:203], v[124:127], v[224:227]
  ds_read_b128 v[196:199], v5 offset:21504
  v_cvt_pk_bf16_f32 v2, v236, v237
  v_mfma_f32_16x16x32_bf16 v[220:223], v[204:207], v[44:47], v[220:223]
  s_waitcnt lgkmcnt(4)
  v_mov_b32 v210, v2
  v_mfma_f32_16x16x32_bf16 v[228:231], v[204:207], v[124:127], v[228:231]
  v_exp_f32 v234, v234
  v_mfma_f32_16x16x32_bf16 v[216:219], v[176:179], v[48:51], v[216:219]
  ds_read_b128 v[200:203], v5 offset:22528
  v_fma_f32 v234, v234, v10, v10
  v_mfma_f32_16x16x32_bf16 v[224:227], v[176:179], v[128:131], v[224:227]
  ds_read_b128 v[204:207], v5 offset:23552
  v_pk_mul_f32 v[246:247], v[242:243], v[246:247]
  v_mfma_f32_16x16x32_bf16 v[220:223], v[180:183], v[48:51], v[220:223]
  s_waitcnt lgkmcnt(4)
  v_pk_mul_f32 v[254:255], v[242:243], v[242:243]
  v_mfma_f32_16x16x32_bf16 v[228:231], v[180:183], v[128:131], v[228:231]
  v_exp_f32 v235, v235
  v_mfma_f32_16x16x32_bf16 v[216:219], v[184:187], v[52:55], v[216:219]
  ds_read_b128 v[176:179], v5 offset:24576
  v_fma_f32 v235, v235, v10, v10
  v_mfma_f32_16x16x32_bf16 v[224:227], v[184:187], v[132:135], v[224:227]
  ds_read_b128 v[180:183], v5 offset:25600
  v_fma_f32 v254, v254, v12, v11
  v_mfma_f32_16x16x32_bf16 v[220:223], v[188:191], v[52:55], v[220:223]
  s_waitcnt lgkmcnt(4)
  v_fma_f32 v255, v255, v12, v11
  v_mfma_f32_16x16x32_bf16 v[228:231], v[188:191], v[132:135], v[228:231]
  v_rcp_f32 v234, v234
  v_mfma_f32_16x16x32_bf16 v[216:219], v[192:195], v[56:59], v[216:219]
  ds_read_b128 v[184:187], v5 offset:26624
  v_pk_mul_f32 v[242:243], v[254:255], v[242:243]
  v_mfma_f32_16x16x32_bf16 v[224:227], v[192:195], v[136:139], v[224:227]
  ds_read_b128 v[188:191], v5 offset:27648
  v_mfma_f32_16x16x32_bf16 v[220:223], v[196:199], v[56:59], v[220:223]
  s_waitcnt lgkmcnt(4)
  v_mfma_f32_16x16x32_bf16 v[228:231], v[196:199], v[136:139], v[228:231]
  v_rcp_f32 v235, v235
  v_mfma_f32_16x16x32_bf16 v[216:219], v[200:203], v[60:63], v[216:219]
  ds_read_b128 v[192:195], v5 offset:28672
  v_pk_mul_f32 v[238:239], v[238:239], v[234:235]
  v_mfma_f32_16x16x32_bf16 v[224:227], v[200:203], v[140:143], v[224:227]
  ds_read_b128 v[196:199], v5 offset:29696
  v_cvt_pk_bf16_f32 v3, v238, v239
  v_mfma_f32_16x16x32_bf16 v[220:223], v[204:207], v[60:63], v[220:223]
  s_waitcnt lgkmcnt(4)
  v_mov_b32 v211, v3
  v_mfma_f32_16x16x32_bf16 v[228:231], v[204:207], v[140:143], v[228:231]
  v_exp_f32 v240, v240
  v_mfma_f32_16x16x32_bf16 v[216:219], v[176:179], v[64:67], v[216:219]
  ds_read_b128 v[200:203], v5 offset:30720
  s_bitcmp1_b32 s37, 0
  s_cbranch_scc0 Lp4st_17888_3_0
  buffer_store_dwordx4 v[208:211], v4, s[12:15], s52 offen sc0 sc1
Lp4st_17888_3_0:
  v_mfma_f32_16x16x32_bf16 v[224:227], v[176:179], v[144:147], v[224:227]
  ds_read_b128 v[204:207], v5 offset:31744
  v_cndmask_b32 v208, v208, v2, s[48:49]
  v_mfma_f32_16x16x32_bf16 v[220:223], v[180:183], v[64:67], v[220:223]
  s_waitcnt lgkmcnt(4)
  v_cndmask_b32 v209, v209, v3, s[48:49]
  v_mfma_f32_16x16x32_bf16 v[228:231], v[180:183], v[144:147], v[228:231]
  v_exp_f32 v241, v241
  v_mfma_f32_16x16x32_bf16 v[216:219], v[184:187], v[68:71], v[216:219]
  ds_read_b128 v[176:179], v5 offset:32768
  v_fma_f32 v240, v240, v13, v13
  v_mfma_f32_16x16x32_bf16 v[224:227], v[184:187], v[148:151], v[224:227]
  ds_read_b128 v[180:183], v5 offset:33792
  v_fma_f32 v241, v241, v13, v13
  v_mfma_f32_16x16x32_bf16 v[220:223], v[188:191], v[68:71], v[220:223]
  s_waitcnt lgkmcnt(4)
  v_mfma_f32_16x16x32_bf16 v[228:231], v[188:191], v[148:151], v[228:231]
  v_rcp_f32 v240, v240
  v_mfma_f32_16x16x32_bf16 v[216:219], v[192:195], v[72:75], v[216:219]
  ds_read_b128 v[184:187], v5 offset:34816
  v_mfma_f32_16x16x32_bf16 v[224:227], v[192:195], v[152:155], v[224:227]
  ds_read_b128 v[188:191], v5 offset:35840
  v_mfma_f32_16x16x32_bf16 v[220:223], v[196:199], v[72:75], v[220:223]
  s_waitcnt lgkmcnt(4)
  v_mfma_f32_16x16x32_bf16 v[228:231], v[196:199], v[152:155], v[228:231]
  v_rcp_f32 v241, v241
  v_mfma_f32_16x16x32_bf16 v[216:219], v[200:203], v[76:79], v[216:219]
  ds_read_b128 v[192:195], v5 offset:36864
  v_pk_mul_f32 v[244:245], v[244:245], v[240:241]
  v_mfma_f32_16x16x32_bf16 v[224:227], v[200:203], v[156:159], v[224:227]
  ds_read_b128 v[196:199], v5 offset:37888
  v_cvt_pk_bf16_f32 v14, v244, v245
  v_mfma_f32_16x16x32_bf16 v[220:223], v[204:207], v[76:79], v[220:223]
  s_waitcnt lgkmcnt(4)
  v_mov_b32 v214, v14
  v_mfma_f32_16x16x32_bf16 v[228:231], v[204:207], v[156:159], v[228:231]
  v_exp_f32 v242, v242
  v_mfma_f32_16x16x32_bf16 v[216:219], v[176:179], v[80:83], v[216:219]
  ds_read_b128 v[200:203], v5 offset:38912
  v_fma_f32 v242, v242, v13, v13
  v_mfma_f32_16x16x32_bf16 v[224:227], v[176:179], v[160:163], v[224:227]
  ds_read_b128 v[204:207], v5 offset:39936
  v_mfma_f32_16x16x32_bf16 v[220:223], v[180:183], v[80:83], v[220:223]
  s_waitcnt lgkmcnt(4)
  v_mfma_f32_16x16x32_bf16 v[228:231], v[180:183], v[160:163], v[228:231]
  v_exp_f32 v243, v243
  s_waitcnt lgkmcnt(0)
  s_barrier
  v_mfma_f32_16x16x32_bf16 v[216:219], v[184:187], v[84:87], v[216:219]
  ds_read_b128 v[176:179], v6 offset:0
  v_fma_f32 v243, v243, v13, v13
  v_mfma_f32_16x16x32_bf16 v[224:227], v[184:187], v[164:167], v[224:227]
  ds_read_b128 v[180:183], v6 offset:1024
  v_mfma_f32_16x16x32_bf16 v[220:223], v[188:191], v[84:87], v[220:223]
  v_rcp_f32 v242, v242
  v_mfma_f32_16x16x32_bf16 v[228:231], v[188:191], v[164:167], v[228:231]
  v_rcp_f32 v243, v243
  v_mfma_f32_16x16x32_bf16 v[216:219], v[192:195], v[88:91], v[216:219]
  ds_read_b128 v[184:187], v6 offset:2048
  v_pk_mul_f32 v[246:247], v[246:247], v[242:243]
  v_mfma_f32_16x16x32_bf16 v[224:227], v[192:195], v[168:171], v[224:227]
  ds_read_b128 v[188:191], v6 offset:3072
  v_cvt_pk_bf16_f32 v15, v246, v247
  v_mfma_f32_16x16x32_bf16 v[220:223], v[196:199], v[88:91], v[220:223]
  v_mov_b32 v215, v15
  s_bitcmp1_b32 s37, 0
  s_cbranch_scc0 Lp4st_17888_3_1
  buffer_store_dwordx4 v[212:215], v4, s[12:15], s54 offen sc0 sc1
Lp4st_17888_3_1:
  v_mfma_f32_16x16x32_bf16 v[228:231], v[196:199], v[168:171], v[228:231]
  s_nop 0
  v_cndmask_b32 v212, v212, v14, s[48:49]
  v_cndmask_b32 v213, v213, v15, s[48:49]
  v_mfma_f32_16x16x32_bf16 v[216:219], v[200:203], v[92:95], v[216:219]
  ds_read_b128 v[192:195], v6 offset:4096
  v_mfma_f32_16x16x32_bf16 v[224:227], v[200:203], v[172:175], v[224:227]
  ds_read_b128 v[196:199], v6 offset:5120
  v_mfma_f32_16x16x32_bf16 v[220:223], v[204:207], v[92:95], v[220:223]
  s_waitcnt lgkmcnt(4)
  v_mfma_f32_16x16x32_bf16 v[228:231], v[204:207], v[172:175], v[228:231]
  v_mfma_f32_16x16x32_bf16 v[232:235], v[176:179], v[16:19], 0
  ds_read_b128 v[200:203], v6 offset:6144
  v_mfma_f32_16x16x32_bf16 v[240:243], v[176:179], v[96:99], 0
  ds_read_b128 v[204:207], v6 offset:7168
  v_mfma_f32_16x16x32_bf16 v[236:239], v[180:183], v[16:19], 0
  s_waitcnt lgkmcnt(4)
  v_mfma_f32_16x16x32_bf16 v[244:247], v[180:183], v[96:99], 0
  v_mfma_f32_16x16x32_bf16 v[232:235], v[184:187], v[20:23], v[232:235]
  ds_read_b128 v[176:179], v6 offset:8192
  s_add_u32 s37, s24, 4
  v_mfma_f32_16x16x32_bf16 v[240:243], v[184:187], v[100:103], v[240:243]
  ds_read_b128 v[180:183], v6 offset:9216
  s_lshr_b32 s36, s37, 1
  v_mfma_f32_16x16x32_bf16 v[236:239], v[188:191], v[20:23], v[236:239]
  s_waitcnt lgkmcnt(4)
  s_lshl_b32 s36, s36, 10
  v_mfma_f32_16x16x32_bf16 v[244:247], v[188:191], v[100:103], v[244:247]
  s_add_u32 s36, s36, s35
  s_bitcmp1_b32 s37, 0
  s_cselect_b64 s[50:51], -1, 0
  s_cselect_b64 s[48:49], 0, -1
  s_cselect_b32 s52, s36, s53
  s_add_u32 s54, s52, 55296
  v_mfma_f32_16x16x32_bf16 v[232:235], v[192:195], v[24:27], v[232:235]
  ds_read_b128 v[184:187], v6 offset:10240
  v_pk_mul_f32 v[220:221], v[216:217], v[220:221]
  v_mfma_f32_16x16x32_bf16 v[240:243], v[192:195], v[104:107], v[240:243]
  ds_read_b128 v[188:191], v6 offset:11264
  v_pk_mul_f32 v[248:249], v[216:217], v[216:217]
  v_mfma_f32_16x16x32_bf16 v[236:239], v[196:199], v[24:27], v[236:239]
  s_waitcnt lgkmcnt(4)
  v_fma_f32 v248, v248, v9, v8
  v_mfma_f32_16x16x32_bf16 v[244:247], v[196:199], v[104:107], v[244:247]
  v_fma_f32 v249, v249, v9, v8
  v_pk_mul_f32 v[216:217], v[248:249], v[216:217]
  v_mfma_f32_16x16x32_bf16 v[232:235], v[200:203], v[28:31], v[232:235]
  ds_read_b128 v[192:195], v6 offset:12288
  v_pk_mul_f32 v[222:223], v[218:219], v[222:223]
  v_mfma_f32_16x16x32_bf16 v[240:243], v[200:203], v[108:111], v[240:243]
  ds_read_b128 v[196:199], v6 offset:13312
  v_pk_mul_f32 v[250:251], v[218:219], v[218:219]
  v_mfma_f32_16x16x32_bf16 v[236:239], v[204:207], v[28:31], v[236:239]
  s_waitcnt lgkmcnt(4)
  v_fma_f32 v250, v250, v9, v8
  v_mfma_f32_16x16x32_bf16 v[244:247], v[204:207], v[108:111], v[244:247]
  v_exp_f32 v216, v216
  v_mfma_f32_16x16x32_bf16 v[232:235], v[176:179], v[32:35], v[232:235]
  ds_read_b128 v[200:203], v6 offset:14336
  v_fma_f32 v216, v216, v10, v10
  v_mfma_f32_16x16x32_bf16 v[240:243], v[176:179], v[112:115], v[240:243]
  ds_read_b128 v[204:207], v6 offset:15360
  v_fma_f32 v251, v251, v9, v8
  v_mfma_f32_16x16x32_bf16 v[236:239], v[180:183], v[32:35], v[236:239]
  s_waitcnt lgkmcnt(4)
  v_pk_mul_f32 v[218:219], v[250:251], v[218:219]
  v_mfma_f32_16x16x32_bf16 v[244:247], v[180:183], v[112:115], v[244:247]
  v_exp_f32 v217, v217
  v_mfma_f32_16x16x32_bf16 v[232:235], v[184:187], v[36:39], v[232:235]
  ds_read_b128 v[176:179], v6 offset:16384
  v_fma_f32 v217, v217, v10, v10
  v_mfma_f32_16x16x32_bf16 v[240:243], v[184:187], v[116:119], v[240:243]
  ds_read_b128 v[180:183], v6 offset:17408
  v_pk_mul_f32 v[228:229], v[224:225], v[228:229]
  v_mfma_f32_16x16x32_bf16 v[236:239], v[188:191], v[36:39], v[236:239]
  s_waitcnt lgkmcnt(4)
  v_pk_mul_f32 v[252:253], v[224:225], v[224:225]
  v_mfma_f32_16x16x32_bf16 v[244:247], v[188:191], v[116:119], v[244:247]
  v_rcp_f32 v216, v216
  v_mfma_f32_16x16x32_bf16 v[232:235], v[192:195], v[40:43], v[232:235]
  ds_read_b128 v[184:187], v6 offset:18432
  v_fma_f32 v252, v252, v12, v11
  v_mfma_f32_16x16x32_bf16 v[240:243], v[192:195], v[120:123], v[240:243]
  ds_read_b128 v[188:191], v6 offset:19456
  v_fma_f32 v253, v253, v12, v11
  v_mfma_f32_16x16x32_bf16 v[236:239], v[196:199], v[40:43], v[236:239]
  s_waitcnt lgkmcnt(4)
  v_pk_mul_f32 v[224:225], v[252:253], v[224:225]
  v_mfma_f32_16x16x32_bf16 v[244:247], v[196:199], v[120:123], v[244:247]
  v_rcp_f32 v217, v217
  v_mfma_f32_16x16x32_bf16 v[232:235], v[200:203], v[44:47], v[232:235]
  ds_read_b128 v[192:195], v6 offset:20480
  v_pk_mul_f32 v[220:221], v[220:221], v[216:217]
  v_mfma_f32_16x16x32_bf16 v[240:243], v[200:203], v[124:127], v[240:243]
  ds_read_b128 v[196:199], v6 offset:21504
  v_cvt_pk_bf16_f32 v2, v220, v221
  v_mfma_f32_16x16x32_bf16 v[236:239], v[204:207], v[44:47], v[236:239]
  s_waitcnt lgkmcnt(4)
  v_mov_b32 v210, v2
  v_mfma_f32_16x16x32_bf16 v[244:247], v[204:207], v[124:127], v[244:247]
  v_exp_f32 v218, v218
  v_mfma_f32_16x16x32_bf16 v[232:235], v[176:179], v[48:51], v[232:235]
  ds_read_b128 v[200:203], v6 offset:22528
  v_fma_f32 v218, v218, v10, v10
  v_mfma_f32_16x16x32_bf16 v[240:243], v[176:179], v[128:131], v[240:243]
  ds_read_b128 v[204:207], v6 offset:23552
  v_pk_mul_f32 v[230:231], v[226:227], v[230:231]
  v_mfma_f32_16x16x32_bf16 v[236:239], v[180:183], v[48:51], v[236:239]
  s_waitcnt lgkmcnt(4)
  v_pk_mul_f32 v[254:255], v[226:227], v[226:227]
  v_mfma_f32_16x16x32_bf16 v[244:247], v[180:183], v[128:131], v[244:247]
  v_exp_f32 v219, v219
  v_mfma_f32_16x16x32_bf16 v[232:235], v[184:187], v[52:55], v[232:235]
  ds_read_b128 v[176:179], v6 offset:24576
  v_fma_f32 v219, v219, v10, v10
  v_mfma_f32_16x16x32_bf16 v[240:243], v[184:187], v[132:135], v[240:243]
  ds_read_b128 v[180:183], v6 offset:25600
  v_fma_f32 v254, v254, v12, v11
  v_mfma_f32_16x16x32_bf16 v[236:239], v[188:191], v[52:55], v[236:239]
  s_waitcnt lgkmcnt(4)
  v_fma_f32 v255, v255, v12, v11
  v_mfma_f32_16x16x32_bf16 v[244:247], v[188:191], v[132:135], v[244:247]
  v_rcp_f32 v218, v218
  v_mfma_f32_16x16x32_bf16 v[232:235], v[192:195], v[56:59], v[232:235]
  ds_read_b128 v[184:187], v6 offset:26624
  v_pk_mul_f32 v[226:227], v[254:255], v[226:227]
  v_mfma_f32_16x16x32_bf16 v[240:243], v[192:195], v[136:139], v[240:243]
  ds_read_b128 v[188:191], v6 offset:27648
  v_mfma_f32_16x16x32_bf16 v[236:239], v[196:199], v[56:59], v[236:239]
  s_waitcnt lgkmcnt(4)
  v_mfma_f32_16x16x32_bf16 v[244:247], v[196:199], v[136:139], v[244:247]
  v_rcp_f32 v219, v219
  v_mfma_f32_16x16x32_bf16 v[232:235], v[200:203], v[60:63], v[232:235]
  ds_read_b128 v[192:195], v6 offset:28672
  v_pk_mul_f32 v[222:223], v[222:223], v[218:219]
  v_mfma_f32_16x16x32_bf16 v[240:243], v[200:203], v[140:143], v[240:243]
  ds_read_b128 v[196:199], v6 offset:29696
  v_cvt_pk_bf16_f32 v3, v222, v223
  v_mfma_f32_16x16x32_bf16 v[236:239], v[204:207], v[60:63], v[236:239]
  s_waitcnt lgkmcnt(4)
  v_mov_b32 v211, v3
  v_mfma_f32_16x16x32_bf16 v[244:247], v[204:207], v[140:143], v[244:247]
  v_exp_f32 v224, v224
  v_mfma_f32_16x16x32_bf16 v[232:235], v[176:179], v[64:67], v[232:235]
  ds_read_b128 v[200:203], v6 offset:30720
  s_bitcmp1_b32 s37, 0
  s_cbranch_scc0 Lp4st_17888_4_0
  buffer_store_dwordx4 v[208:211], v4, s[12:15], s52 offen sc0 sc1
Lp4st_17888_4_0:
  v_mfma_f32_16x16x32_bf16 v[240:243], v[176:179], v[144:147], v[240:243]
  ds_read_b128 v[204:207], v6 offset:31744
  v_cndmask_b32 v208, v208, v2, s[48:49]
  v_mfma_f32_16x16x32_bf16 v[236:239], v[180:183], v[64:67], v[236:239]
  s_waitcnt lgkmcnt(4)
  v_cndmask_b32 v209, v209, v3, s[48:49]
  v_mfma_f32_16x16x32_bf16 v[244:247], v[180:183], v[144:147], v[244:247]
  v_exp_f32 v225, v225
  v_mfma_f32_16x16x32_bf16 v[232:235], v[184:187], v[68:71], v[232:235]
  ds_read_b128 v[176:179], v6 offset:32768
  v_fma_f32 v224, v224, v13, v13
  v_mfma_f32_16x16x32_bf16 v[240:243], v[184:187], v[148:151], v[240:243]
  ds_read_b128 v[180:183], v6 offset:33792
  v_fma_f32 v225, v225, v13, v13
  v_mfma_f32_16x16x32_bf16 v[236:239], v[188:191], v[68:71], v[236:239]
  s_waitcnt lgkmcnt(4)
  v_mfma_f32_16x16x32_bf16 v[244:247], v[188:191], v[148:151], v[244:247]
  v_rcp_f32 v224, v224
  v_mfma_f32_16x16x32_bf16 v[232:235], v[192:195], v[72:75], v[232:235]
  ds_read_b128 v[184:187], v6 offset:34816
  v_mfma_f32_16x16x32_bf16 v[240:243], v[192:195], v[152:155], v[240:243]
  ds_read_b128 v[188:191], v6 offset:35840
  v_mfma_f32_16x16x32_bf16 v[236:239], v[196:199], v[72:75], v[236:239]
  s_waitcnt lgkmcnt(4)
  v_mfma_f32_16x16x32_bf16 v[244:247], v[196:199], v[152:155], v[244:247]
  v_rcp_f32 v225, v225
  v_mfma_f32_16x16x32_bf16 v[232:235], v[200:203], v[76:79], v[232:235]
  ds_read_b128 v[192:195], v6 offset:36864
  v_pk_mul_f32 v[228:229], v[228:229], v[224:225]
  v_mfma_f32_16x16x32_bf16 v[240:243], v[200:203], v[156:159], v[240:243]
  ds_read_b128 v[196:199], v6 offset:37888
  v_cvt_pk_bf16_f32 v14, v228, v229
  v_mfma_f32_16x16x32_bf16 v[236:239], v[204:207], v[76:79], v[236:239]
  s_waitcnt lgkmcnt(4)
  v_mov_b32 v214, v14
  v_mfma_f32_16x16x32_bf16 v[244:247], v[204:207], v[156:159], v[244:247]
  v_exp_f32 v226, v226
  v_mfma_f32_16x16x32_bf16 v[232:235], v[176:179], v[80:83], v[232:235]
  ds_read_b128 v[200:203], v6 offset:38912
  v_fma_f32 v226, v226, v13, v13
  v_mfma_f32_16x16x32_bf16 v[240:243], v[176:179], v[160:163], v[240:243]
  ds_read_b128 v[204:207], v6 offset:39936
  v_mfma_f32_16x16x32_bf16 v[236:239], v[180:183], v[80:83], v[236:239]
  s_waitcnt lgkmcnt(4)
  v_mfma_f32_16x16x32_bf16 v[244:247], v[180:183], v[160:163], v[244:247]
  v_exp_f32 v227, v227
  s_waitcnt lgkmcnt(0)
  s_barrier
  v_mfma_f32_16x16x32_bf16 v[232:235], v[184:187], v[84:87], v[232:235]
  ds_read_b128 v[176:179], v4 offset:0
  v_fma_f32 v227, v227, v13, v13
  v_mfma_f32_16x16x32_bf16 v[240:243], v[184:187], v[164:167], v[240:243]
  ds_read_b128 v[180:183], v4 offset:1024
  v_mfma_f32_16x16x32_bf16 v[236:239], v[188:191], v[84:87], v[236:239]
  v_rcp_f32 v226, v226
  v_mfma_f32_16x16x32_bf16 v[244:247], v[188:191], v[164:167], v[244:247]
  v_rcp_f32 v227, v227
  v_mfma_f32_16x16x32_bf16 v[232:235], v[192:195], v[88:91], v[232:235]
  ds_read_b128 v[184:187], v4 offset:2048
  v_pk_mul_f32 v[230:231], v[230:231], v[226:227]
  v_mfma_f32_16x16x32_bf16 v[240:243], v[192:195], v[168:171], v[240:243]
  ds_read_b128 v[188:191], v4 offset:3072
  v_cvt_pk_bf16_f32 v15, v230, v231
  v_mfma_f32_16x16x32_bf16 v[236:239], v[196:199], v[88:91], v[236:239]
  v_mov_b32 v215, v15
  s_bitcmp1_b32 s37, 0
  s_cbranch_scc0 Lp4st_17888_4_1
  buffer_store_dwordx4 v[212:215], v4, s[12:15], s54 offen sc0 sc1
Lp4st_17888_4_1:
  v_mfma_f32_16x16x32_bf16 v[244:247], v[196:199], v[168:171], v[244:247]
  s_nop 0
  v_cndmask_b32 v212, v212, v14, s[48:49]
  v_cndmask_b32 v213, v213, v15, s[48:49]
  v_mfma_f32_16x16x32_bf16 v[232:235], v[200:203], v[92:95], v[232:235]
  ds_read_b128 v[192:195], v4 offset:4096
  v_mfma_f32_16x16x32_bf16 v[240:243], v[200:203], v[172:175], v[240:243]
  ds_read_b128 v[196:199], v4 offset:5120
  v_mfma_f32_16x16x32_bf16 v[236:239], v[204:207], v[92:95], v[236:239]
  s_waitcnt lgkmcnt(4)
  v_mfma_f32_16x16x32_bf16 v[244:247], v[204:207], v[172:175], v[244:247]
  v_mfma_f32_16x16x32_bf16 v[216:219], v[176:179], v[16:19], 0
  ds_read_b128 v[200:203], v4 offset:6144
  v_mfma_f32_16x16x32_bf16 v[224:227], v[176:179], v[96:99], 0
  ds_read_b128 v[204:207], v4 offset:7168
  v_mfma_f32_16x16x32_bf16 v[220:223], v[180:183], v[16:19], 0
  s_waitcnt lgkmcnt(4)
  v_mfma_f32_16x16x32_bf16 v[228:231], v[180:183], v[96:99], 0
  v_mfma_f32_16x16x32_bf16 v[216:219], v[184:187], v[20:23], v[216:219]
  ds_read_b128 v[176:179], v4 offset:8192
  s_add_u32 s37, s24, 5
  v_mfma_f32_16x16x32_bf16 v[224:227], v[184:187], v[100:103], v[224:227]
  ds_read_b128 v[180:183], v4 offset:9216
  s_lshr_b32 s36, s37, 1
  v_mfma_f32_16x16x32_bf16 v[220:223], v[188:191], v[20:23], v[220:223]
  s_waitcnt lgkmcnt(4)
  s_lshl_b32 s36, s36, 10
  v_mfma_f32_16x16x32_bf16 v[228:231], v[188:191], v[100:103], v[228:231]
  s_add_u32 s36, s36, s35
  s_bitcmp1_b32 s37, 0
  s_cselect_b64 s[50:51], -1, 0
  s_cselect_b64 s[48:49], 0, -1
  s_cselect_b32 s52, s36, s53
  s_add_u32 s54, s52, 55296
  v_mfma_f32_16x16x32_bf16 v[216:219], v[192:195], v[24:27], v[216:219]
  ds_read_b128 v[184:187], v4 offset:10240
  v_pk_mul_f32 v[236:237], v[232:233], v[236:237]
  v_mfma_f32_16x16x32_bf16 v[224:227], v[192:195], v[104:107], v[224:227]
  ds_read_b128 v[188:191], v4 offset:11264
  v_pk_mul_f32 v[248:249], v[232:233], v[232:233]
  v_mfma_f32_16x16x32_bf16 v[220:223], v[196:199], v[24:27], v[220:223]
  s_waitcnt lgkmcnt(4)
  v_fma_f32 v248, v248, v9, v8
  v_mfma_f32_16x16x32_bf16 v[228:231], v[196:199], v[104:107], v[228:231]
  v_fma_f32 v249, v249, v9, v8
  v_pk_mul_f32 v[232:233], v[248:249], v[232:233]
  v_mfma_f32_16x16x32_bf16 v[216:219], v[200:203], v[28:31], v[216:219]
  ds_read_b128 v[192:195], v4 offset:12288
  v_pk_mul_f32 v[238:239], v[234:235], v[238:239]
  v_mfma_f32_16x16x32_bf16 v[224:227], v[200:203], v[108:111], v[224:227]
  ds_read_b128 v[196:199], v4 offset:13312
  v_pk_mul_f32 v[250:251], v[234:235], v[234:235]
  v_mfma_f32_16x16x32_bf16 v[220:223], v[204:207], v[28:31], v[220:223]
  s_waitcnt lgkmcnt(4)
  v_fma_f32 v250, v250, v9, v8
  v_mfma_f32_16x16x32_bf16 v[228:231], v[204:207], v[108:111], v[228:231]
  v_exp_f32 v232, v232
  v_mfma_f32_16x16x32_bf16 v[216:219], v[176:179], v[32:35], v[216:219]
  ds_read_b128 v[200:203], v4 offset:14336
  v_fma_f32 v232, v232, v10, v10
  v_mfma_f32_16x16x32_bf16 v[224:227], v[176:179], v[112:115], v[224:227]
  ds_read_b128 v[204:207], v4 offset:15360
  v_fma_f32 v251, v251, v9, v8
  v_mfma_f32_16x16x32_bf16 v[220:223], v[180:183], v[32:35], v[220:223]
  s_waitcnt lgkmcnt(4)
  v_pk_mul_f32 v[234:235], v[250:251], v[234:235]
  v_mfma_f32_16x16x32_bf16 v[228:231], v[180:183], v[112:115], v[228:231]
  v_exp_f32 v233, v233
  v_mfma_f32_16x16x32_bf16 v[216:219], v[184:187], v[36:39], v[216:219]
  ds_read_b128 v[176:179], v4 offset:16384
  v_fma_f32 v233, v233, v10, v10
  v_mfma_f32_16x16x32_bf16 v[224:227], v[184:187], v[116:119], v[224:227]
  ds_read_b128 v[180:183], v4 offset:17408
  v_pk_mul_f32 v[244:245], v[240:241], v[244:245]
  v_mfma_f32_16x16x32_bf16 v[220:223], v[188:191], v[36:39], v[220:223]
  s_waitcnt lgkmcnt(4)
  v_pk_mul_f32 v[252:253], v[240:241], v[240:241]
  v_mfma_f32_16x16x32_bf16 v[228:231], v[188:191], v[116:119], v[228:231]
  v_rcp_f32 v232, v232
  v_mfma_f32_16x16x32_bf16 v[216:219], v[192:195], v[40:43], v[216:219]
  ds_read_b128 v[184:187], v4 offset:18432
  v_fma_f32 v252, v252, v12, v11
  v_mfma_f32_16x16x32_bf16 v[224:227], v[192:195], v[120:123], v[224:227]
  ds_read_b128 v[188:191], v4 offset:19456
  v_fma_f32 v253, v253, v12, v11
  v_mfma_f32_16x16x32_bf16 v[220:223], v[196:199], v[40:43], v[220:223]
  s_waitcnt lgkmcnt(4)
  v_pk_mul_f32 v[240:241], v[252:253], v[240:241]
  v_mfma_f32_16x16x32_bf16 v[228:231], v[196:199], v[120:123], v[228:231]
  v_rcp_f32 v233, v233
  v_mfma_f32_16x16x32_bf16 v[216:219], v[200:203], v[44:47], v[216:219]
  ds_read_b128 v[192:195], v4 offset:20480
  v_pk_mul_f32 v[236:237], v[236:237], v[232:233]
  v_mfma_f32_16x16x32_bf16 v[224:227], v[200:203], v[124:127], v[224:227]
  ds_read_b128 v[196:199], v4 offset:21504
  v_cvt_pk_bf16_f32 v2, v236, v237
  v_mfma_f32_16x16x32_bf16 v[220:223], v[204:207], v[44:47], v[220:223]
  s_waitcnt lgkmcnt(4)
  v_mov_b32 v210, v2
  v_mfma_f32_16x16x32_bf16 v[228:231], v[204:207], v[124:127], v[228:231]
  v_exp_f32 v234, v234
  v_mfma_f32_16x16x32_bf16 v[216:219], v[176:179], v[48:51], v[216:219]
  ds_read_b128 v[200:203], v4 offset:22528
  v_fma_f32 v234, v234, v10, v10
  v_mfma_f32_16x16x32_bf16 v[224:227], v[176:179], v[128:131], v[224:227]
  ds_read_b128 v[204:207], v4 offset:23552
  v_pk_mul_f32 v[246:247], v[242:243], v[246:247]
  v_mfma_f32_16x16x32_bf16 v[220:223], v[180:183], v[48:51], v[220:223]
  s_waitcnt lgkmcnt(4)
  v_pk_mul_f32 v[254:255], v[242:243], v[242:243]
  v_mfma_f32_16x16x32_bf16 v[228:231], v[180:183], v[128:131], v[228:231]
  v_exp_f32 v235, v235
  v_mfma_f32_16x16x32_bf16 v[216:219], v[184:187], v[52:55], v[216:219]
  ds_read_b128 v[176:179], v4 offset:24576
  v_fma_f32 v235, v235, v10, v10
  v_mfma_f32_16x16x32_bf16 v[224:227], v[184:187], v[132:135], v[224:227]
  ds_read_b128 v[180:183], v4 offset:25600
  v_fma_f32 v254, v254, v12, v11
  v_mfma_f32_16x16x32_bf16 v[220:223], v[188:191], v[52:55], v[220:223]
  s_waitcnt lgkmcnt(4)
  v_fma_f32 v255, v255, v12, v11
  v_mfma_f32_16x16x32_bf16 v[228:231], v[188:191], v[132:135], v[228:231]
  v_rcp_f32 v234, v234
  v_mfma_f32_16x16x32_bf16 v[216:219], v[192:195], v[56:59], v[216:219]
  ds_read_b128 v[184:187], v4 offset:26624
  v_pk_mul_f32 v[242:243], v[254:255], v[242:243]
  v_mfma_f32_16x16x32_bf16 v[224:227], v[192:195], v[136:139], v[224:227]
  ds_read_b128 v[188:191], v4 offset:27648
  v_mfma_f32_16x16x32_bf16 v[220:223], v[196:199], v[56:59], v[220:223]
  s_waitcnt lgkmcnt(4)
  v_mfma_f32_16x16x32_bf16 v[228:231], v[196:199], v[136:139], v[228:231]
  v_rcp_f32 v235, v235
  v_mfma_f32_16x16x32_bf16 v[216:219], v[200:203], v[60:63], v[216:219]
  ds_read_b128 v[192:195], v4 offset:28672
  v_pk_mul_f32 v[238:239], v[238:239], v[234:235]
  v_mfma_f32_16x16x32_bf16 v[224:227], v[200:203], v[140:143], v[224:227]
  ds_read_b128 v[196:199], v4 offset:29696
  v_cvt_pk_bf16_f32 v3, v238, v239
  v_mfma_f32_16x16x32_bf16 v[220:223], v[204:207], v[60:63], v[220:223]
  s_waitcnt lgkmcnt(4)
  v_mov_b32 v211, v3
  v_mfma_f32_16x16x32_bf16 v[228:231], v[204:207], v[140:143], v[228:231]
  v_exp_f32 v240, v240
  v_mfma_f32_16x16x32_bf16 v[216:219], v[176:179], v[64:67], v[216:219]
  ds_read_b128 v[200:203], v4 offset:30720
  s_bitcmp1_b32 s37, 0
  s_cbranch_scc0 Lp4st_17888_5_0
  buffer_store_dwordx4 v[208:211], v4, s[12:15], s52 offen sc0 sc1
Lp4st_17888_5_0:
  v_mfma_f32_16x16x32_bf16 v[224:227], v[176:179], v[144:147], v[224:227]
  ds_read_b128 v[204:207], v4 offset:31744
  v_cndmask_b32 v208, v208, v2, s[48:49]
  v_mfma_f32_16x16x32_bf16 v[220:223], v[180:183], v[64:67], v[220:223]
  s_waitcnt lgkmcnt(4)
  v_cndmask_b32 v209, v209, v3, s[48:49]
  v_mfma_f32_16x16x32_bf16 v[228:231], v[180:183], v[144:147], v[228:231]
  v_exp_f32 v241, v241
  v_mfma_f32_16x16x32_bf16 v[216:219], v[184:187], v[68:71], v[216:219]
  ds_read_b128 v[176:179], v4 offset:32768
  v_fma_f32 v240, v240, v13, v13
  v_mfma_f32_16x16x32_bf16 v[224:227], v[184:187], v[148:151], v[224:227]
  ds_read_b128 v[180:183], v4 offset:33792
  v_fma_f32 v241, v241, v13, v13
  v_mfma_f32_16x16x32_bf16 v[220:223], v[188:191], v[68:71], v[220:223]
  s_waitcnt lgkmcnt(4)
  v_mfma_f32_16x16x32_bf16 v[228:231], v[188:191], v[148:151], v[228:231]
  v_rcp_f32 v240, v240
  v_mfma_f32_16x16x32_bf16 v[216:219], v[192:195], v[72:75], v[216:219]
  ds_read_b128 v[184:187], v4 offset:34816
  v_mfma_f32_16x16x32_bf16 v[224:227], v[192:195], v[152:155], v[224:227]
  ds_read_b128 v[188:191], v4 offset:35840
  v_mfma_f32_16x16x32_bf16 v[220:223], v[196:199], v[72:75], v[220:223]
  s_waitcnt lgkmcnt(4)
  v_mfma_f32_16x16x32_bf16 v[228:231], v[196:199], v[152:155], v[228:231]
  v_rcp_f32 v241, v241
  v_mfma_f32_16x16x32_bf16 v[216:219], v[200:203], v[76:79], v[216:219]
  ds_read_b128 v[192:195], v4 offset:36864
  v_pk_mul_f32 v[244:245], v[244:245], v[240:241]
  v_mfma_f32_16x16x32_bf16 v[224:227], v[200:203], v[156:159], v[224:227]
  ds_read_b128 v[196:199], v4 offset:37888
  v_cvt_pk_bf16_f32 v14, v244, v245
  v_mfma_f32_16x16x32_bf16 v[220:223], v[204:207], v[76:79], v[220:223]
  s_waitcnt lgkmcnt(4)
  v_mov_b32 v214, v14
  v_mfma_f32_16x16x32_bf16 v[228:231], v[204:207], v[156:159], v[228:231]
  v_exp_f32 v242, v242
  v_mfma_f32_16x16x32_bf16 v[216:219], v[176:179], v[80:83], v[216:219]
  ds_read_b128 v[200:203], v4 offset:38912
  v_fma_f32 v242, v242, v13, v13
  v_mfma_f32_16x16x32_bf16 v[224:227], v[176:179], v[160:163], v[224:227]
  ds_read_b128 v[204:207], v4 offset:39936
  v_mfma_f32_16x16x32_bf16 v[220:223], v[180:183], v[80:83], v[220:223]
  s_waitcnt lgkmcnt(4)
  v_mfma_f32_16x16x32_bf16 v[228:231], v[180:183], v[160:163], v[228:231]
  v_exp_f32 v243, v243
  v_mfma_f32_16x16x32_bf16 v[216:219], v[184:187], v[84:87], v[216:219]
  s_waitcnt lgkmcnt(2)
  v_fma_f32 v243, v243, v13, v13
  v_mfma_f32_16x16x32_bf16 v[224:227], v[184:187], v[164:167], v[224:227]
  v_rcp_f32 v242, v242
  v_mfma_f32_16x16x32_bf16 v[220:223], v[188:191], v[84:87], v[220:223]
  v_rcp_f32 v243, v243
  v_mfma_f32_16x16x32_bf16 v[228:231], v[188:191], v[164:167], v[228:231]
  v_pk_mul_f32 v[246:247], v[246:247], v[242:243]
  v_cvt_pk_bf16_f32 v15, v246, v247
  v_mfma_f32_16x16x32_bf16 v[216:219], v[192:195], v[88:91], v[216:219]
  s_waitcnt lgkmcnt(0)
  v_mov_b32 v215, v15
  v_mfma_f32_16x16x32_bf16 v[224:227], v[192:195], v[168:171], v[224:227]
  s_bitcmp1_b32 s37, 0
  s_cbranch_scc0 Lp4st_17888_5_1
  buffer_store_dwordx4 v[212:215], v4, s[12:15], s54 offen sc0 sc1
Lp4st_17888_5_1:
  s_nop 1
  v_cndmask_b32 v212, v212, v14, s[48:49]
  v_mfma_f32_16x16x32_bf16 v[220:223], v[196:199], v[88:91], v[220:223]
  v_cndmask_b32 v213, v213, v15, s[48:49]
  v_mfma_f32_16x16x32_bf16 v[228:231], v[196:199], v[168:171], v[228:231]
  v_mfma_f32_16x16x32_bf16 v[216:219], v[200:203], v[92:95], v[216:219]
  v_mfma_f32_16x16x32_bf16 v[224:227], v[200:203], v[172:175], v[224:227]
  v_mfma_f32_16x16x32_bf16 v[220:223], v[204:207], v[92:95], v[220:223]
  v_mfma_f32_16x16x32_bf16 v[228:231], v[204:207], v[172:175], v[228:231]
  s_add_u32 s37, s24, 6
  s_lshr_b32 s36, s37, 1
  s_lshl_b32 s36, s36, 10
  s_add_u32 s36, s36, s35
  s_bitcmp1_b32 s37, 0
  s_cselect_b64 s[50:51], -1, 0
  s_cselect_b64 s[48:49], 0, -1
  s_cselect_b32 s52, s36, s53
  s_cselect_b32 s55, s53, s36
  s_add_u32 s56, s55, 55296
  s_add_u32 s54, s52, 55296
  v_pk_mul_f32 v[220:221], v[216:217], v[220:221]
  v_pk_mul_f32 v[248:249], v[216:217], v[216:217]
  v_fma_f32 v248, v248, v9, v8
  v_fma_f32 v249, v249, v9, v8
  v_pk_mul_f32 v[216:217], v[248:249], v[216:217]
  v_exp_f32 v216, v216
  v_exp_f32 v217, v217
  v_fma_f32 v216, v216, v10, v10
  v_fma_f32 v217, v217, v10, v10
  v_rcp_f32 v216, v216
  v_rcp_f32 v217, v217
  s_nop 0
  v_pk_mul_f32 v[220:221], v[220:221], v[216:217]
  v_pk_mul_f32 v[222:223], v[218:219], v[222:223]
  v_pk_mul_f32 v[250:251], v[218:219], v[218:219]
  v_fma_f32 v250, v250, v9, v8
  v_fma_f32 v251, v251, v9, v8
  v_pk_mul_f32 v[218:219], v[250:251], v[218:219]
  v_exp_f32 v218, v218
  v_exp_f32 v219, v219
  v_fma_f32 v218, v218, v10, v10
  v_fma_f32 v219, v219, v10, v10
  v_rcp_f32 v218, v218
  v_rcp_f32 v219, v219
  s_nop 0
  v_pk_mul_f32 v[222:223], v[222:223], v[218:219]
  v_cvt_pk_bf16_f32 v2, v220, v221
  v_cvt_pk_bf16_f32 v3, v222, v223
  s_bitcmp0_b32 s37, 0
  s_cbranch_scc0 Lp4sh_17888_6_0
  buffer_store_dwordx2 v[2:3], v4, s[12:15], s55 offen sc0 sc1
Lp4sh_17888_6_0:
  v_mov_b32 v210, v2
  v_mov_b32 v211, v3
  s_bitcmp1_b32 s37, 0
  s_cbranch_scc0 Lp4st_17888_6_0
  buffer_store_dwordx4 v[208:211], v4, s[12:15], s52 offen sc0 sc1
Lp4st_17888_6_0:
  v_pk_mul_f32 v[228:229], v[224:225], v[228:229]
  v_pk_mul_f32 v[252:253], v[224:225], v[224:225]
  v_fma_f32 v252, v252, v12, v11
  v_fma_f32 v253, v253, v12, v11
  v_pk_mul_f32 v[224:225], v[252:253], v[224:225]
  v_exp_f32 v224, v224
  v_exp_f32 v225, v225
  v_fma_f32 v224, v224, v13, v13
  v_fma_f32 v225, v225, v13, v13
  v_rcp_f32 v224, v224
  v_rcp_f32 v225, v225
  s_nop 0
  v_pk_mul_f32 v[228:229], v[228:229], v[224:225]
  v_pk_mul_f32 v[230:231], v[226:227], v[230:231]
  v_pk_mul_f32 v[254:255], v[226:227], v[226:227]
  v_fma_f32 v254, v254, v12, v11
  v_fma_f32 v255, v255, v12, v11
  v_pk_mul_f32 v[226:227], v[254:255], v[226:227]
  v_exp_f32 v226, v226
  v_exp_f32 v227, v227
  v_fma_f32 v226, v226, v13, v13
  v_fma_f32 v227, v227, v13, v13
  v_rcp_f32 v226, v226
  v_rcp_f32 v227, v227
  s_nop 0
  v_pk_mul_f32 v[230:231], v[230:231], v[226:227]
  v_cvt_pk_bf16_f32 v14, v228, v229
  v_cvt_pk_bf16_f32 v15, v230, v231
  s_bitcmp0_b32 s37, 0
  s_cbranch_scc0 Lp4sh_17888_6_1
  buffer_store_dwordx2 v[14:15], v4, s[12:15], s56 offen sc0 sc1
Lp4sh_17888_6_1:
  v_mov_b32 v214, v14
  v_mov_b32 v215, v15
  s_bitcmp1_b32 s37, 0
  s_cbranch_scc0 Lp4st_17888_6_1
  buffer_store_dwordx4 v[212:215], v4, s[12:15], s54 offen sc0 sc1
Lp4st_17888_6_1:
  s_waitcnt vmcnt(0)
  s_barrier
  s_cmp_lg_u32 s22, 0
  s_cbranch_scc1 Lsequential_preLN__linear_kernel_hedgehog__geglu_ffn__prompt_kernel_a7
  s_lshl_b32 s33, s23, 4
  s_add_u32 s33, s33, s18
  s_lshl_b32 s31, s33, 7
  s_add_u32 s31, s31, 24772608
  v_mov_b32 v8, 0
  v_mov_b32 v9, s96
  s_mov_b64 exec, 1
  buffer_store_dword v9, v8, s[12:15], s31 offen sc0 sc1
  s_mov_b64 exec, -1
Lsequential_preLN__linear_kernel_hedgehog__geglu_ffn__prompt_kernel_a7:
  v_and_b32 v21, 15, v1
  v_lshrrev_b32 v3, 4, v1
  s_and_b32 s20, s2, 7
  s_lshr_b32 s21, s2, 3
  s_lshl_b32 s23, s20, 2
  s_lshr_b32 s24, s21, 3
  s_add_u32 s23, s23, s24
  s_and_b32 s24, s21, 7
  s_lshl_b32 s26, s23, 2
  s_add_u32 s26, s26, s25
  s_cmp_lg_u32 s22, 0
  s_cbranch_scc1 Lsequential_preLN__linear_kernel_hedgehog__geglu_ffn__prompt_kernel_a8
  s_lshr_b32 s33, s23, 1
  s_lshl_b32 s33, s33, 4
  s_lshl_b32 s31, s33, 7
  s_add_u32 s31, s31, 24772608
  v_lshlrev_b32 v8, 7, v1
  s_mov_b32 s97, 0
  s_mov_b64 exec, 0xffff
  s_waitcnt vmcnt(0)
  buffer_load_dword v253, v8, s[12:15], s31 offen sc1
  s_sleep 2
  buffer_load_dword v254, v8, s[12:15], s31 offen sc1
Lsequential_preLN__linear_kernel_hedgehog__geglu_ffn__prompt_kernel_pg:
  s_waitcnt vmcnt(1)
  v_cmp_ne_u32 vcc, s96, v253
  s_cbranch_vccz Lsequential_preLN__linear_kernel_hedgehog__geglu_ffn__prompt_kernel_pg_x
  buffer_load_dword v253, v8, s[12:15], s31 offen sc1
  s_waitcnt vmcnt(1)
  v_cmp_ne_u32 vcc, s96, v254
  s_cbranch_vccz Lsequential_preLN__linear_kernel_hedgehog__geglu_ffn__prompt_kernel_pg_x
  buffer_load_dword v254, v8, s[12:15], s31 offen sc1
  s_add_u32 s97, s97, 1
  s_cmp_le_u32 s97, 0x20000
  s_cbranch_scc1 Lsequential_preLN__linear_kernel_hedgehog__geglu_ffn__prompt_kernel_pg
Lsequential_preLN__linear_kernel_hedgehog__geglu_ffn__prompt_kernel_pg_x:
  s_mov_b64 exec, -1
Lsequential_preLN__linear_kernel_hedgehog__geglu_ffn__prompt_kernel_a8:
  s_barrier
  v_mov_b32 v7, v21
  v_mov_b32 v2, v3
  v_lshlrev_b32 v4, 4, v1
  v_add_u32 v5, 61440, v4
  v_add_u32 v6, 122880, v4
  s_mul_i32 s27, s26, 55296
  s_add_u32 s27, s27, 7864320
  v_lshlrev_b32 v8, 3, v1
  s_and_b32 s33, s21, 7
  s_mul_i32 s33, s33, 7
  s_cmp_ge_u32 s33, 54
  s_cselect_b32 s34, 54, 0
  s_sub_u32 s33, s33, s34
  s_lshl_b32 s34, s33, 10
  s_add_u32 s34, s34, s27
  s_add_u32 s33, s33, 1
  buffer_load_dwordx4 v[16:19], v4, s[12:15], s34 offen sc1
  s_cmp_ge_u32 s33, 54
  s_cselect_b32 s34, 54, 0
  s_sub_u32 s33, s33, s34
  s_lshl_b32 s34, s33, 10
  s_add_u32 s34, s34, s27
  s_add_u32 s33, s33, 1
  buffer_load_dwordx4 v[20:23], v4, s[12:15], s34 offen sc1
  s_cmp_ge_u32 s33, 54
  s_cselect_b32 s34, 54, 0
  s_sub_u32 s33, s33, s34
  s_lshl_b32 s34, s33, 10
  s_add_u32 s34, s34, s27
  s_add_u32 s33, s33, 1
  buffer_load_dwordx4 v[24:27], v4, s[12:15], s34 offen sc1
  s_cmp_ge_u32 s33, 54
  s_cselect_b32 s34, 54, 0
  s_sub_u32 s33, s33, s34
  s_lshl_b32 s34, s33, 10
  s_add_u32 s34, s34, s27
  s_add_u32 s33, s33, 1
  buffer_load_dwordx4 v[28:31], v4, s[12:15], s34 offen sc1
  s_cmp_ge_u32 s33, 54
  s_cselect_b32 s34, 54, 0
  s_sub_u32 s33, s33, s34
  s_lshl_b32 s34, s33, 10
  s_add_u32 s34, s34, s27
  s_add_u32 s33, s33, 1
  buffer_load_dwordx4 v[32:35], v4, s[12:15], s34 offen sc1
  s_cmp_ge_u32 s33, 54
  s_cselect_b32 s34, 54, 0
  s_sub_u32 s33, s33, s34
  s_lshl_b32 s34, s33, 10
  s_add_u32 s34, s34, s27
  s_add_u32 s33, s33, 1
  buffer_load_dwordx4 v[36:39], v4, s[12:15], s34 offen sc1
  s_cmp_ge_u32 s33, 54
  s_cselect_b32 s34, 54, 0
  s_sub_u32 s33, s33, s34
  s_lshl_b32 s34, s33, 10
  s_add_u32 s34, s34, s27
  s_add_u32 s33, s33, 1
  buffer_load_dwordx4 v[40:43], v4, s[12:15], s34 offen sc1
  s_cmp_ge_u32 s33, 54
  s_cselect_b32 s34, 54, 0
  s_sub_u32 s33, s33, s34
  s_lshl_b32 s34, s33, 10
  s_add_u32 s34, s34, s27
  s_add_u32 s33, s33, 1
  buffer_load_dwordx4 v[44:47], v4, s[12:15], s34 offen sc1
  s_load_dwordx2 s[4:5], s[0:1], 64
  s_lshl_b32 s30, s26, 4
  v_add_u32 v9, s30, v7
  v_mul_u32_u24 v9, 1280, v9
  v_mul_u32_u24 v10, 40, v2
  s_mul_i32 s31, s24, 160
  v_add3_u32 v9, v9, v10, s31
  s_waitcnt lgkmcnt(0)
  s_mov_b32 s16, s4
  s_mov_b32 s17, s5
  s_mov_b32 s18, 2621440
  s_mov_b32 s19, 0x20000
  s_waitcnt lgkmcnt(0)
  s_barrier
  ds_read_b128 v[128:131], v6 offset:0
  ds_read_b128 v[132:135], v6 offset:1024
  s_cmp_ge_u32 s33, 54
  s_cselect_b32 s34, 54, 0
  s_sub_u32 s33, s33, s34
  s_lshl_b32 s34, s33, 10
  s_add_u32 s34, s34, s27
  s_add_u32 s33, s33, 1
  buffer_load_dwordx4 v[48:51], v4, s[12:15], s34 offen sc1
  ds_read_b128 v[136:139], v6 offset:2048
  ds_read_b128 v[140:143], v6 offset:3072
  s_cmp_ge_u32 s33, 54
  s_cselect_b32 s34, 54, 0
  s_sub_u32 s33, s33, s34
  s_lshl_b32 s34, s33, 10
  s_add_u32 s34, s34, s27
  s_add_u32 s33, s33, 1
  buffer_load_dwordx4 v[52:55], v4, s[12:15], s34 offen sc1
  ds_read_b128 v[144:147], v6 offset:4096
  ds_read_b128 v[148:151], v6 offset:5120
  s_cmp_ge_u32 s33, 54
  s_cselect_b32 s34, 54, 0
  s_sub_u32 s33, s33, s34
  s_lshl_b32 s34, s33, 10
  s_add_u32 s34, s34, s27
  s_add_u32 s33, s33, 1
  buffer_load_dwordx4 v[56:59], v4, s[12:15], s34 offen sc1
  ds_read_b128 v[152:155], v6 offset:6144
  ds_read_b128 v[156:159], v6 offset:7168
  s_cmp_ge_u32 s33, 54
  s_cselect_b32 s34, 54, 0
  s_sub_u32 s33, s33, s34
  s_lshl_b32 s34, s33, 10
  s_add_u32 s34, s34, s27
  s_add_u32 s33, s33, 1
  buffer_load_dwordx4 v[60:63], v4, s[12:15], s34 offen sc1
  ds_read_b128 v[160:163], v6 offset:8192
  ds_read_b128 v[164:167], v6 offset:9216
  s_cmp_ge_u32 s33, 54
  s_cselect_b32 s34, 54, 0
  s_sub_u32 s33, s33, s34
  s_lshl_b32 s34, s33, 10
  s_add_u32 s34, s34, s27
  s_add_u32 s33, s33, 1
  buffer_load_dwordx4 v[64:67], v4, s[12:15], s34 offen sc1
  ds_read_b128 v[168:171], v6 offset:10240
  ds_read_b128 v[172:175], v6 offset:11264
  s_cmp_ge_u32 s33, 54
  s_cselect_b32 s34, 54, 0
  s_sub_u32 s33, s33, s34
  s_lshl_b32 s34, s33, 10
  s_add_u32 s34, s34, s27
  s_add_u32 s33, s33, 1
  buffer_load_dwordx4 v[68:71], v4, s[12:15], s34 offen sc1
  ds_read_b128 v[176:179], v6 offset:12288
  ds_read_b128 v[180:183], v6 offset:13312
  s_cmp_ge_u32 s33, 54
  s_cselect_b32 s34, 54, 0
  s_sub_u32 s33, s33, s34
  s_lshl_b32 s34, s33, 10
  s_add_u32 s34, s34, s27
  s_add_u32 s33, s33, 1
  buffer_load_dwordx4 v[72:75], v4, s[12:15], s34 offen sc1
  ds_read_b128 v[184:187], v6 offset:14336
  ds_read_b128 v[188:191], v6 offset:15360
  s_cmp_ge_u32 s33, 54
  s_cselect_b32 s34, 54, 0
  s_sub_u32 s33, s33, s34
  s_lshl_b32 s34, s33, 10
  s_add_u32 s34, s34, s27
  s_add_u32 s33, s33, 1
  buffer_load_dwordx4 v[76:79], v4, s[12:15], s34 offen sc1
  ds_read_b128 v[192:195], v6 offset:16384
  ds_read_b128 v[196:199], v6 offset:17408
  ds_read_b128 v[200:203], v6 offset:18432
  ds_read_b128 v[204:207], v6 offset:19456
  s_waitcnt lgkmcnt(0)
  s_barrier
  s_waitcnt vmcnt(12)
  v_mfma_f32_16x16x32_bf16 v[208:211], v[128:131], v[16:19], 0
  ds_read_b128 v[128:131], v4 offset:40960
  v_mfma_f32_16x16x32_bf16 v[212:215], v[132:135], v[16:19], 0
  ds_read_b128 v[132:135], v4 offset:41984
  s_cmp_ge_u32 s33, 54
  s_cselect_b32 s34, 54, 0
  s_sub_u32 s33, s33, s34
  s_lshl_b32 s34, s33, 10
  s_add_u32 s34, s34, s27
  s_add_u32 s33, s33, 1
  buffer_load_dwordx4 v[80:83], v4, s[12:15], s34 offen sc1
  v_mfma_f32_16x16x32_bf16 v[216:219], v[136:139], v[16:19], 0
  ds_read_b128 v[136:139], v4 offset:43008
  v_mfma_f32_16x16x32_bf16 v[220:223], v[140:143], v[16:19], 0
  ds_read_b128 v[140:143], v4 offset:44032
  s_cmp_ge_u32 s33, 54
  s_cselect_b32 s34, 54, 0
  s_sub_u32 s33, s33, s34
  s_lshl_b32 s34, s33, 10
  s_add_u32 s34, s34, s27
  s_add_u32 s33, s33, 1
  buffer_load_dwordx4 v[84:87], v4, s[12:15], s34 offen sc1
  v_mfma_f32_16x16x32_bf16 v[224:227], v[144:147], v[16:19], 0
  ds_read_b128 v[144:147], v4 offset:45056
  v_mfma_f32_16x16x32_bf16 v[208:211], v[148:151], v[20:23], v[208:211]
  ds_read_b128 v[148:151], v4 offset:46080
  s_cmp_ge_u32 s33, 54
  s_cselect_b32 s34, 54, 0
  s_sub_u32 s33, s33, s34
  s_lshl_b32 s34, s33, 10
  s_add_u32 s34, s34, s27
  s_add_u32 s33, s33, 1
  buffer_load_dwordx4 v[88:91], v4, s[12:15], s34 offen sc1
  v_mfma_f32_16x16x32_bf16 v[212:215], v[152:155], v[20:23], v[212:215]
  ds_read_b128 v[152:155], v4 offset:47104
  v_mfma_f32_16x16x32_bf16 v[216:219], v[156:159], v[20:23], v[216:219]
  ds_read_b128 v[156:159], v4 offset:48128
  s_cmp_ge_u32 s33, 54
  s_cselect_b32 s34, 54, 0
  s_sub_u32 s33, s33, s34
  s_lshl_b32 s34, s33, 10
  s_add_u32 s34, s34, s27
  s_add_u32 s33, s33, 1
  buffer_load_dwordx4 v[92:95], v4, s[12:15], s34 offen sc1
  v_mfma_f32_16x16x32_bf16 v[220:223], v[160:163], v[20:23], v[220:223]
  ds_read_b128 v[160:163], v4 offset:49152
  v_mfma_f32_16x16x32_bf16 v[224:227], v[164:167], v[20:23], v[224:227]
  ds_read_b128 v[164:167], v4 offset:50176
  s_cmp_ge_u32 s33, 54
  s_cselect_b32 s34, 54, 0
  s_sub_u32 s33, s33, s34
  s_lshl_b32 s34, s33, 10
  s_add_u32 s34, s34, s27
  s_add_u32 s33, s33, 1
  buffer_load_dwordx4 v[96:99], v4, s[12:15], s34 offen sc1
  v_mfma_f32_16x16x32_bf16 v[208:211], v[168:171], v[24:27], v[208:211]
  ds_read_b128 v[168:171], v4 offset:51200
  v_mfma_f32_16x16x32_bf16 v[212:215], v[172:175], v[24:27], v[212:215]
  ds_read_b128 v[172:175], v4 offset:52224
  s_cmp_ge_u32 s33, 54
  s_cselect_b32 s34, 54, 0
  s_sub_u32 s33, s33, s34
  s_lshl_b32 s34, s33, 10
  s_add_u32 s34, s34, s27
  s_add_u32 s33, s33, 1
  buffer_load_dwordx4 v[100:103], v4, s[12:15], s34 offen sc1
  v_mfma_f32_16x16x32_bf16 v[216:219], v[176:179], v[24:27], v[216:219]
  ds_read_b128 v[176:179], v4 offset:53248
  v_mfma_f32_16x16x32_bf16 v[220:223], v[180:183], v[24:27], v[220:223]
  ds_read_b128 v[180:183], v4 offset:54272
  s_cmp_ge_u32 s33, 54
  s_cselect_b32 s34, 54, 0
  s_sub_u32 s33, s33, s34
  s_lshl_b32 s34, s33, 10
  s_add_u32 s34, s34, s27
  s_add_u32 s33, s33, 1
  buffer_load_dwordx4 v[104:107], v4, s[12:15], s34 offen sc1
  v_mfma_f32_16x16x32_bf16 v[224:227], v[184:187], v[24:27], v[224:227]
  ds_read_b128 v[184:187], v4 offset:55296
  v_mfma_f32_16x16x32_bf16 v[208:211], v[188:191], v[28:31], v[208:211]
  ds_read_b128 v[188:191], v4 offset:56320
  s_cmp_ge_u32 s33, 54
  s_cselect_b32 s34, 54, 0
  s_sub_u32 s33, s33, s34
  s_lshl_b32 s34, s33, 10
  s_add_u32 s34, s34, s27
  s_add_u32 s33, s33, 1
  buffer_load_dwordx4 v[108:111], v4, s[12:15], s34 offen sc1
  v_mfma_f32_16x16x32_bf16 v[212:215], v[192:195], v[28:31], v[212:215]
  ds_read_b128 v[192:195], v4 offset:57344
  v_mfma_f32_16x16x32_bf16 v[216:219], v[196:199], v[28:31], v[216:219]
  ds_read_b128 v[196:199], v4 offset:58368
  v_mfma_f32_16x16x32_bf16 v[220:223], v[200:203], v[28:31], v[220:223]
  ds_read_b128 v[200:203], v4 offset:59392
  v_mfma_f32_16x16x32_bf16 v[224:227], v[204:207], v[28:31], v[224:227]
  ds_read_b128 v[204:207], v4 offset:60416
  s_waitcnt lgkmcnt(0)
  s_barrier
  s_waitcnt vmcnt(16)
  v_mfma_f32_16x16x32_bf16 v[208:211], v[128:131], v[32:35], v[208:211]
  ds_read_b128 v[128:131], v5 offset:0
  v_mfma_f32_16x16x32_bf16 v[212:215], v[132:135], v[32:35], v[212:215]
  ds_read_b128 v[132:135], v5 offset:1024
  s_cmp_ge_u32 s33, 54
  s_cselect_b32 s34, 54, 0
  s_sub_u32 s33, s33, s34
  s_lshl_b32 s34, s33, 10
  s_add_u32 s34, s34, s27
  s_add_u32 s33, s33, 1
  buffer_load_dwordx4 v[112:115], v4, s[12:15], s34 offen sc1
  v_mfma_f32_16x16x32_bf16 v[216:219], v[136:139], v[32:35], v[216:219]
  ds_read_b128 v[136:139], v5 offset:2048
  v_mfma_f32_16x16x32_bf16 v[220:223], v[140:143], v[32:35], v[220:223]
  ds_read_b128 v[140:143], v5 offset:3072
  s_cmp_ge_u32 s33, 54
  s_cselect_b32 s34, 54, 0
  s_sub_u32 s33, s33, s34
  s_lshl_b32 s34, s33, 10
  s_add_u32 s34, s34, s27
  s_add_u32 s33, s33, 1
  buffer_load_dwordx4 v[116:119], v4, s[12:15], s34 offen sc1
  v_mfma_f32_16x16x32_bf16 v[224:227], v[144:147], v[32:35], v[224:227]
  ds_read_b128 v[144:147], v5 offset:4096
  v_mfma_f32_16x16x32_bf16 v[208:211], v[148:151], v[36:39], v[208:211]
  ds_read_b128 v[148:151], v5 offset:5120
  s_cmp_ge_u32 s33, 54
  s_cselect_b32 s34, 54, 0
  s_sub_u32 s33, s33, s34
  s_lshl_b32 s34, s33, 10
  s_add_u32 s34, s34, s27
  s_add_u32 s33, s33, 1
  buffer_load_dwordx4 v[120:123], v4, s[12:15], s34 offen sc1
  v_mfma_f32_16x16x32_bf16 v[212:215], v[152:155], v[36:39], v[212:215]
  ds_read_b128 v[152:155], v5 offset:6144
  v_mfma_f32_16x16x32_bf16 v[216:219], v[156:159], v[36:39], v[216:219]
  ds_read_b128 v[156:159], v5 offset:7168
  s_cmp_ge_u32 s33, 54
  s_cselect_b32 s34, 54, 0
  s_sub_u32 s33, s33, s34
  s_lshl_b32 s34, s33, 10
  s_add_u32 s34, s34, s27
  s_add_u32 s33, s33, 1
  buffer_load_dwordx4 v[124:127], v4, s[12:15], s34 offen sc1
  v_mfma_f32_16x16x32_bf16 v[220:223], v[160:163], v[36:39], v[220:223]
  ds_read_b128 v[160:163], v5 offset:8192
  v_mfma_f32_16x16x32_bf16 v[224:227], v[164:167], v[36:39], v[224:227]
  ds_read_b128 v[164:167], v5 offset:9216
  s_cmp_ge_u32 s33, 54
  s_cselect_b32 s34, 54, 0
  s_sub_u32 s33, s33, s34
  s_lshl_b32 s34, s33, 10
  s_add_u32 s34, s34, s27
  s_add_u32 s33, s33, 1
  buffer_load_dwordx4 v[16:19], v4, s[12:15], s34 offen sc1
  v_mfma_f32_16x16x32_bf16 v[208:211], v[168:171], v[40:43], v[208:211]
  ds_read_b128 v[168:171], v5 offset:10240
  v_mfma_f32_16x16x32_bf16 v[212:215], v[172:175], v[40:43], v[212:215]
  ds_read_b128 v[172:175], v5 offset:11264
  s_cmp_ge_u32 s33, 54
  s_cselect_b32 s34, 54, 0
  s_sub_u32 s33, s33, s34
  s_lshl_b32 s34, s33, 10
  s_add_u32 s34, s34, s27
  s_add_u32 s33, s33, 1
  buffer_load_dwordx4 v[20:23], v4, s[12:15], s34 offen sc1
  v_mfma_f32_16x16x32_bf16 v[216:219], v[176:179], v[40:43], v[216:219]
  ds_read_b128 v[176:179], v5 offset:12288
  v_mfma_f32_16x16x32_bf16 v[220:223], v[180:183], v[40:43], v[220:223]
  ds_read_b128 v[180:183], v5 offset:13312
  s_cmp_ge_u32 s33, 54
  s_cselect_b32 s34, 54, 0
  s_sub_u32 s33, s33, s34
  s_lshl_b32 s34, s33, 10
  s_add_u32 s34, s34, s27
  s_add_u32 s33, s33, 1
  buffer_load_dwordx4 v[24:27], v4, s[12:15], s34 offen sc1
  v_mfma_f32_16x16x32_bf16 v[224:227], v[184:187], v[40:43], v[224:227]
  ds_read_b128 v[184:187], v5 offset:14336
  v_mfma_f32_16x16x32_bf16 v[208:211], v[188:191], v[44:47], v[208:211]
  ds_read_b128 v[188:191], v5 offset:15360
  s_cmp_ge_u32 s33, 54
  s_cselect_b32 s34, 54, 0
  s_sub_u32 s33, s33, s34
  s_lshl_b32 s34, s33, 10
  s_add_u32 s34, s34, s27
  s_add_u32 s33, s33, 1
  buffer_load_dwordx4 v[28:31], v4, s[12:15], s34 offen sc1
  v_mfma_f32_16x16x32_bf16 v[212:215], v[192:195], v[44:47], v[212:215]
  ds_read_b128 v[192:195], v5 offset:16384
  v_mfma_f32_16x16x32_bf16 v[216:219], v[196:199], v[44:47], v[216:219]
  ds_read_b128 v[196:199], v5 offset:17408
  v_mfma_f32_16x16x32_bf16 v[220:223], v[200:203], v[44:47], v[220:223]
  ds_read_b128 v[200:203], v5 offset:18432
  v_mfma_f32_16x16x32_bf16 v[224:227], v[204:207], v[44:47], v[224:227]
  ds_read_b128 v[204:207], v5 offset:19456
  s_waitcnt lgkmcnt(0)
  s_barrier
  s_waitcnt vmcnt(20)
  v_mfma_f32_16x16x32_bf16 v[208:211], v[128:131], v[48:51], v[208:211]
  ds_read_b128 v[128:131], v5 offset:20480
  v_mfma_f32_16x16x32_bf16 v[212:215], v[132:135], v[48:51], v[212:215]
  ds_read_b128 v[132:135], v5 offset:21504
  s_cmp_ge_u32 s33, 54
  s_cselect_b32 s34, 54, 0
  s_sub_u32 s33, s33, s34
  s_lshl_b32 s34, s33, 10
  s_add_u32 s34, s34, s27
  s_add_u32 s33, s33, 1
  buffer_load_dwordx4 v[32:35], v4, s[12:15], s34 offen sc1
  v_mfma_f32_16x16x32_bf16 v[216:219], v[136:139], v[48:51], v[216:219]
  ds_read_b128 v[136:139], v5 offset:22528
  v_mfma_f32_16x16x32_bf16 v[220:223], v[140:143], v[48:51], v[220:223]
  ds_read_b128 v[140:143], v5 offset:23552
  s_cmp_ge_u32 s33, 54
  s_cselect_b32 s34, 54, 0
  s_sub_u32 s33, s33, s34
  s_lshl_b32 s34, s33, 10
  s_add_u32 s34, s34, s27
  s_add_u32 s33, s33, 1
  buffer_load_dwordx4 v[36:39], v4, s[12:15], s34 offen sc1
  v_mfma_f32_16x16x32_bf16 v[224:227], v[144:147], v[48:51], v[224:227]
  ds_read_b128 v[144:147], v5 offset:24576
  v_mfma_f32_16x16x32_bf16 v[208:211], v[148:151], v[52:55], v[208:211]
  ds_read_b128 v[148:151], v5 offset:25600
  s_cmp_ge_u32 s33, 54
  s_cselect_b32 s34, 54, 0
  s_sub_u32 s33, s33, s34
  s_lshl_b32 s34, s33, 10
  s_add_u32 s34, s34, s27
  s_add_u32 s33, s33, 1
  buffer_load_dwordx4 v[40:43], v4, s[12:15], s34 offen sc1
  v_mfma_f32_16x16x32_bf16 v[212:215], v[152:155], v[52:55], v[212:215]
  ds_read_b128 v[152:155], v5 offset:26624
  v_mfma_f32_16x16x32_bf16 v[216:219], v[156:159], v[52:55], v[216:219]
  ds_read_b128 v[156:159], v5 offset:27648
  s_cmp_ge_u32 s33, 54
  s_cselect_b32 s34, 54, 0
  s_sub_u32 s33, s33, s34
  s_lshl_b32 s34, s33, 10
  s_add_u32 s34, s34, s27
  s_add_u32 s33, s33, 1
  buffer_load_dwordx4 v[44:47], v4, s[12:15], s34 offen sc1
  v_mfma_f32_16x16x32_bf16 v[220:223], v[160:163], v[52:55], v[220:223]
  ds_read_b128 v[160:163], v5 offset:28672
  v_mfma_f32_16x16x32_bf16 v[224:227], v[164:167], v[52:55], v[224:227]
  ds_read_b128 v[164:167], v5 offset:29696
  v_mfma_f32_16x16x32_bf16 v[208:211], v[168:171], v[56:59], v[208:211]
  ds_read_b128 v[168:171], v5 offset:30720
  v_mfma_f32_16x16x32_bf16 v[212:215], v[172:175], v[56:59], v[212:215]
  ds_read_b128 v[172:175], v5 offset:31744
  v_mfma_f32_16x16x32_bf16 v[216:219], v[176:179], v[56:59], v[216:219]
  ds_read_b128 v[176:179], v5 offset:32768
  v_mfma_f32_16x16x32_bf16 v[220:223], v[180:183], v[56:59], v[220:223]
  ds_read_b128 v[180:183], v5 offset:33792
  v_mfma_f32_16x16x32_bf16 v[224:227], v[184:187], v[56:59], v[224:227]
  ds_read_b128 v[184:187], v5 offset:34816
  v_mfma_f32_16x16x32_bf16 v[208:211], v[188:191], v[60:63], v[208:211]
  ds_read_b128 v[188:191], v5 offset:35840
  v_mfma_f32_16x16x32_bf16 v[212:215], v[192:195], v[60:63], v[212:215]
  ds_read_b128 v[192:195], v5 offset:36864
  v_mfma_f32_16x16x32_bf16 v[216:219], v[196:199], v[60:63], v[216:219]
  ds_read_b128 v[196:199], v5 offset:37888
  v_mfma_f32_16x16x32_bf16 v[220:223], v[200:203], v[60:63], v[220:223]
  ds_read_b128 v[200:203], v5 offset:38912
  v_mfma_f32_16x16x32_bf16 v[224:227], v[204:207], v[60:63], v[224:227]
  ds_read_b128 v[204:207], v5 offset:39936
  s_waitcnt lgkmcnt(0)
  s_barrier
  s_waitcnt vmcnt(20)
  v_mfma_f32_16x16x32_bf16 v[208:211], v[128:131], v[64:67], v[208:211]
  ds_read_b128 v[128:131], v5 offset:40960
  v_mfma_f32_16x16x32_bf16 v[212:215], v[132:135], v[64:67], v[212:215]
  ds_read_b128 v[132:135], v5 offset:41984
  s_cmp_ge_u32 s33, 54
  s_cselect_b32 s34, 54, 0
  s_sub_u32 s33, s33, s34
  s_lshl_b32 s34, s33, 10
  s_add_u32 s34, s34, s27
  s_add_u32 s33, s33, 1
  buffer_load_dwordx4 v[48:51], v4, s[12:15], s34 offen sc1
  v_mfma_f32_16x16x32_bf16 v[216:219], v[136:139], v[64:67], v[216:219]
  ds_read_b128 v[136:139], v5 offset:43008
  v_mfma_f32_16x16x32_bf16 v[220:223], v[140:143], v[64:67], v[220:223]
  ds_read_b128 v[140:143], v5 offset:44032
  s_cmp_ge_u32 s33, 54
  s_cselect_b32 s34, 54, 0
  s_sub_u32 s33, s33, s34
  s_lshl_b32 s34, s33, 10
  s_add_u32 s34, s34, s27
  s_add_u32 s33, s33, 1
  buffer_load_dwordx4 v[52:55], v4, s[12:15], s34 offen sc1
  v_mfma_f32_16x16x32_bf16 v[224:227], v[144:147], v[64:67], v[224:227]
  ds_read_b128 v[144:147], v5 offset:45056
  v_mfma_f32_16x16x32_bf16 v[208:211], v[148:151], v[68:71], v[208:211]
  ds_read_b128 v[148:151], v5 offset:46080
  s_cmp_ge_u32 s33, 54
  s_cselect_b32 s34, 54, 0
  s_sub_u32 s33, s33, s34
  s_lshl_b32 s34, s33, 10
  s_add_u32 s34, s34, s27
  s_add_u32 s33, s33, 1
  buffer_load_dwordx4 v[56:59], v4, s[12:15], s34 offen sc1
  v_mfma_f32_16x16x32_bf16 v[212:215], v[152:155], v[68:71], v[212:215]
  ds_read_b128 v[152:155], v5 offset:47104
  v_mfma_f32_16x16x32_bf16 v[216:219], v[156:159], v[68:71], v[216:219]
  ds_read_b128 v[156:159], v5 offset:48128
  s_cmp_ge_u32 s33, 54
  s_cselect_b32 s34, 54, 0
  s_sub_u32 s33, s33, s34
  s_lshl_b32 s34, s33, 10
  s_add_u32 s34, s34, s27
  s_add_u32 s33, s33, 1
  buffer_load_dwordx4 v[60:63], v4, s[12:15], s34 offen sc1
  v_mfma_f32_16x16x32_bf16 v[220:223], v[160:163], v[68:71], v[220:223]
  ds_read_b128 v[160:163], v5 offset:49152
  v_mfma_f32_16x16x32_bf16 v[224:227], v[164:167], v[68:71], v[224:227]
  ds_read_b128 v[164:167], v5 offset:50176
  v_mfma_f32_16x16x32_bf16 v[208:211], v[168:171], v[72:75], v[208:211]
  ds_read_b128 v[168:171], v5 offset:51200
  v_mfma_f32_16x16x32_bf16 v[212:215], v[172:175], v[72:75], v[212:215]
  ds_read_b128 v[172:175], v5 offset:52224
  v_mfma_f32_16x16x32_bf16 v[216:219], v[176:179], v[72:75], v[216:219]
  ds_read_b128 v[176:179], v5 offset:53248
  v_mfma_f32_16x16x32_bf16 v[220:223], v[180:183], v[72:75], v[220:223]
  ds_read_b128 v[180:183], v5 offset:54272
  v_mfma_f32_16x16x32_bf16 v[224:227], v[184:187], v[72:75], v[224:227]
  ds_read_b128 v[184:187], v5 offset:55296
  v_mfma_f32_16x16x32_bf16 v[208:211], v[188:191], v[76:79], v[208:211]
  ds_read_b128 v[188:191], v5 offset:56320
  v_mfma_f32_16x16x32_bf16 v[212:215], v[192:195], v[76:79], v[212:215]
  ds_read_b128 v[192:195], v5 offset:57344
  v_mfma_f32_16x16x32_bf16 v[216:219], v[196:199], v[76:79], v[216:219]
  ds_read_b128 v[196:199], v5 offset:58368
  v_mfma_f32_16x16x32_bf16 v[220:223], v[200:203], v[76:79], v[220:223]
  ds_read_b128 v[200:203], v5 offset:59392
  v_mfma_f32_16x16x32_bf16 v[224:227], v[204:207], v[76:79], v[224:227]
  ds_read_b128 v[204:207], v5 offset:60416
  s_waitcnt lgkmcnt(0)
  s_barrier
  s_waitcnt vmcnt(20)
  v_mfma_f32_16x16x32_bf16 v[208:211], v[128:131], v[80:83], v[208:211]
  ds_read_b128 v[128:131], v4 offset:0
  v_mfma_f32_16x16x32_bf16 v[212:215], v[132:135], v[80:83], v[212:215]
  ds_read_b128 v[132:135], v4 offset:1024
  s_cmp_ge_u32 s33, 54
  s_cselect_b32 s34, 54, 0
  s_sub_u32 s33, s33, s34
  s_lshl_b32 s34, s33, 10
  s_add_u32 s34, s34, s27
  s_add_u32 s33, s33, 1
  buffer_load_dwordx4 v[64:67], v4, s[12:15], s34 offen sc1
  v_mfma_f32_16x16x32_bf16 v[216:219], v[136:139], v[80:83], v[216:219]
  ds_read_b128 v[136:139], v4 offset:2048
  v_mfma_f32_16x16x32_bf16 v[220:223], v[140:143], v[80:83], v[220:223]
  ds_read_b128 v[140:143], v4 offset:3072
  s_cmp_ge_u32 s33, 54
  s_cselect_b32 s34, 54, 0
  s_sub_u32 s33, s33, s34
  s_lshl_b32 s34, s33, 10
  s_add_u32 s34, s34, s27
  s_add_u32 s33, s33, 1
  buffer_load_dwordx4 v[68:71], v4, s[12:15], s34 offen sc1
  v_mfma_f32_16x16x32_bf16 v[224:227], v[144:147], v[80:83], v[224:227]
  ds_read_b128 v[144:147], v4 offset:4096
  v_mfma_f32_16x16x32_bf16 v[208:211], v[148:151], v[84:87], v[208:211]
  ds_read_b128 v[148:151], v4 offset:5120
  s_cmp_ge_u32 s33, 54
  s_cselect_b32 s34, 54, 0
  s_sub_u32 s33, s33, s34
  s_lshl_b32 s34, s33, 10
  s_add_u32 s34, s34, s27
  s_add_u32 s33, s33, 1
  buffer_load_dwordx4 v[72:75], v4, s[12:15], s34 offen sc1
  v_mfma_f32_16x16x32_bf16 v[212:215], v[152:155], v[84:87], v[212:215]
  ds_read_b128 v[152:155], v4 offset:6144
  v_mfma_f32_16x16x32_bf16 v[216:219], v[156:159], v[84:87], v[216:219]
  ds_read_b128 v[156:159], v4 offset:7168
  s_cmp_ge_u32 s33, 54
  s_cselect_b32 s34, 54, 0
  s_sub_u32 s33, s33, s34
  s_lshl_b32 s34, s33, 10
  s_add_u32 s34, s34, s27
  s_add_u32 s33, s33, 1
  buffer_load_dwordx4 v[76:79], v4, s[12:15], s34 offen sc1
  v_mfma_f32_16x16x32_bf16 v[220:223], v[160:163], v[84:87], v[220:223]
  ds_read_b128 v[160:163], v4 offset:8192
  v_mfma_f32_16x16x32_bf16 v[224:227], v[164:167], v[84:87], v[224:227]
  ds_read_b128 v[164:167], v4 offset:9216
  v_mfma_f32_16x16x32_bf16 v[208:211], v[168:171], v[88:91], v[208:211]
  ds_read_b128 v[168:171], v4 offset:10240
  v_mfma_f32_16x16x32_bf16 v[212:215], v[172:175], v[88:91], v[212:215]
  ds_read_b128 v[172:175], v4 offset:11264
  v_mfma_f32_16x16x32_bf16 v[216:219], v[176:179], v[88:91], v[216:219]
  ds_read_b128 v[176:179], v4 offset:12288
  v_mfma_f32_16x16x32_bf16 v[220:223], v[180:183], v[88:91], v[220:223]
  ds_read_b128 v[180:183], v4 offset:13312
  v_mfma_f32_16x16x32_bf16 v[224:227], v[184:187], v[88:91], v[224:227]
  ds_read_b128 v[184:187], v4 offset:14336
  v_mfma_f32_16x16x32_bf16 v[208:211], v[188:191], v[92:95], v[208:211]
  ds_read_b128 v[188:191], v4 offset:15360
  v_mfma_f32_16x16x32_bf16 v[212:215], v[192:195], v[92:95], v[212:215]
  ds_read_b128 v[192:195], v4 offset:16384
  v_mfma_f32_16x16x32_bf16 v[216:219], v[196:199], v[92:95], v[216:219]
  ds_read_b128 v[196:199], v4 offset:17408
  v_mfma_f32_16x16x32_bf16 v[220:223], v[200:203], v[92:95], v[220:223]
  ds_read_b128 v[200:203], v4 offset:18432
  v_mfma_f32_16x16x32_bf16 v[224:227], v[204:207], v[92:95], v[224:227]
  ds_read_b128 v[204:207], v4 offset:19456
  s_waitcnt lgkmcnt(0)
  s_barrier
  s_waitcnt vmcnt(20)
  v_mfma_f32_16x16x32_bf16 v[208:211], v[128:131], v[96:99], v[208:211]
  ds_read_b128 v[128:131], v4 offset:20480
  v_mfma_f32_16x16x32_bf16 v[212:215], v[132:135], v[96:99], v[212:215]
  ds_read_b128 v[132:135], v4 offset:21504
  s_cmp_ge_u32 s33, 54
  s_cselect_b32 s34, 54, 0
  s_sub_u32 s33, s33, s34
  s_lshl_b32 s34, s33, 10
  s_add_u32 s34, s34, s27
  s_add_u32 s33, s33, 1
  buffer_load_dwordx4 v[80:83], v4, s[12:15], s34 offen sc1
  v_mfma_f32_16x16x32_bf16 v[216:219], v[136:139], v[96:99], v[216:219]
  ds_read_b128 v[136:139], v4 offset:22528
  v_mfma_f32_16x16x32_bf16 v[220:223], v[140:143], v[96:99], v[220:223]
  ds_read_b128 v[140:143], v4 offset:23552
  s_cmp_ge_u32 s33, 54
  s_cselect_b32 s34, 54, 0
  s_sub_u32 s33, s33, s34
  s_lshl_b32 s34, s33, 10
  s_add_u32 s34, s34, s27
  s_add_u32 s33, s33, 1
  buffer_load_dwordx4 v[84:87], v4, s[12:15], s34 offen sc1
  v_mfma_f32_16x16x32_bf16 v[224:227], v[144:147], v[96:99], v[224:227]
  ds_read_b128 v[144:147], v4 offset:24576
  v_mfma_f32_16x16x32_bf16 v[208:211], v[148:151], v[100:103], v[208:211]
  ds_read_b128 v[148:151], v4 offset:25600
  s_cmp_ge_u32 s33, 54
  s_cselect_b32 s34, 54, 0
  s_sub_u32 s33, s33, s34
  s_lshl_b32 s34, s33, 10
  s_add_u32 s34, s34, s27
  s_add_u32 s33, s33, 1
  buffer_load_dwordx4 v[88:91], v4, s[12:15], s34 offen sc1
  v_mfma_f32_16x16x32_bf16 v[212:215], v[152:155], v[100:103], v[212:215]
  ds_read_b128 v[152:155], v4 offset:26624
  v_mfma_f32_16x16x32_bf16 v[216:219], v[156:159], v[100:103], v[216:219]
  ds_read_b128 v[156:159], v4 offset:27648
  s_cmp_ge_u32 s33, 54
  s_cselect_b32 s34, 54, 0
  s_sub_u32 s33, s33, s34
  s_lshl_b32 s34, s33, 10
  s_add_u32 s34, s34, s27
  s_add_u32 s33, s33, 1
  buffer_load_dwordx4 v[92:95], v4, s[12:15], s34 offen sc1
  v_mfma_f32_16x16x32_bf16 v[220:223], v[160:163], v[100:103], v[220:223]
  ds_read_b128 v[160:163], v4 offset:28672
  v_mfma_f32_16x16x32_bf16 v[224:227], v[164:167], v[100:103], v[224:227]
  ds_read_b128 v[164:167], v4 offset:29696
  v_mfma_f32_16x16x32_bf16 v[208:211], v[168:171], v[104:107], v[208:211]
  ds_read_b128 v[168:171], v4 offset:30720
  v_mfma_f32_16x16x32_bf16 v[212:215], v[172:175], v[104:107], v[212:215]
  ds_read_b128 v[172:175], v4 offset:31744
  v_mfma_f32_16x16x32_bf16 v[216:219], v[176:179], v[104:107], v[216:219]
  ds_read_b128 v[176:179], v4 offset:32768
  v_mfma_f32_16x16x32_bf16 v[220:223], v[180:183], v[104:107], v[220:223]
  ds_read_b128 v[180:183], v4 offset:33792
  v_mfma_f32_16x16x32_bf16 v[224:227], v[184:187], v[104:107], v[224:227]
  ds_read_b128 v[184:187], v4 offset:34816
  v_mfma_f32_16x16x32_bf16 v[208:211], v[188:191], v[108:111], v[208:211]
  ds_read_b128 v[188:191], v4 offset:35840
  v_mfma_f32_16x16x32_bf16 v[212:215], v[192:195], v[108:111], v[212:215]
  ds_read_b128 v[192:195], v4 offset:36864
  v_mfma_f32_16x16x32_bf16 v[216:219], v[196:199], v[108:111], v[216:219]
  ds_read_b128 v[196:199], v4 offset:37888
  v_mfma_f32_16x16x32_bf16 v[220:223], v[200:203], v[108:111], v[220:223]
  ds_read_b128 v[200:203], v4 offset:38912
  v_mfma_f32_16x16x32_bf16 v[224:227], v[204:207], v[108:111], v[224:227]
  ds_read_b128 v[204:207], v4 offset:39936
  s_waitcnt lgkmcnt(0)
  s_barrier
  s_waitcnt vmcnt(20)
  v_mfma_f32_16x16x32_bf16 v[208:211], v[128:131], v[112:115], v[208:211]
  ds_read_b128 v[128:131], v6 offset:0
  v_mfma_f32_16x16x32_bf16 v[212:215], v[132:135], v[112:115], v[212:215]
  ds_read_b128 v[132:135], v6 offset:1024
  s_cmp_ge_u32 s33, 54
  s_cselect_b32 s34, 54, 0
  s_sub_u32 s33, s33, s34
  s_lshl_b32 s34, s33, 10
  s_add_u32 s34, s34, s27
  s_add_u32 s33, s33, 1
  buffer_load_dwordx4 v[96:99], v4, s[12:15], s34 offen sc1
  v_mfma_f32_16x16x32_bf16 v[216:219], v[136:139], v[112:115], v[216:219]
  ds_read_b128 v[136:139], v6 offset:2048
  v_mfma_f32_16x16x32_bf16 v[220:223], v[140:143], v[112:115], v[220:223]
  ds_read_b128 v[140:143], v6 offset:3072
  s_cmp_ge_u32 s33, 54
  s_cselect_b32 s34, 54, 0
  s_sub_u32 s33, s33, s34
  s_lshl_b32 s34, s33, 10
  s_add_u32 s34, s34, s27
  s_add_u32 s33, s33, 1
  buffer_load_dwordx4 v[100:103], v4, s[12:15], s34 offen sc1
  v_mfma_f32_16x16x32_bf16 v[224:227], v[144:147], v[112:115], v[224:227]
  ds_read_b128 v[144:147], v6 offset:4096
  v_mfma_f32_16x16x32_bf16 v[208:211], v[148:151], v[116:119], v[208:211]
  ds_read_b128 v[148:151], v6 offset:5120
  s_cmp_ge_u32 s33, 54
  s_cselect_b32 s34, 54, 0
  s_sub_u32 s33, s33, s34
  s_lshl_b32 s34, s33, 10
  s_add_u32 s34, s34, s27
  s_add_u32 s33, s33, 1
  buffer_load_dwordx4 v[104:107], v4, s[12:15], s34 offen sc1
  v_mfma_f32_16x16x32_bf16 v[212:215], v[152:155], v[116:119], v[212:215]
  ds_read_b128 v[152:155], v6 offset:6144
  v_mfma_f32_16x16x32_bf16 v[216:219], v[156:159], v[116:119], v[216:219]
  ds_read_b128 v[156:159], v6 offset:7168
  s_cmp_ge_u32 s33, 54
  s_cselect_b32 s34, 54, 0
  s_sub_u32 s33, s33, s34
  s_lshl_b32 s34, s33, 10
  s_add_u32 s34, s34, s27
  s_add_u32 s33, s33, 1
  buffer_load_dwordx4 v[108:111], v4, s[12:15], s34 offen sc1
  v_mfma_f32_16x16x32_bf16 v[220:223], v[160:163], v[116:119], v[220:223]
  ds_read_b128 v[160:163], v6 offset:8192
  v_mfma_f32_16x16x32_bf16 v[224:227], v[164:167], v[116:119], v[224:227]
  ds_read_b128 v[164:167], v6 offset:9216
  v_mfma_f32_16x16x32_bf16 v[208:211], v[168:171], v[120:123], v[208:211]
  ds_read_b128 v[168:171], v6 offset:10240
  v_mfma_f32_16x16x32_bf16 v[212:215], v[172:175], v[120:123], v[212:215]
  ds_read_b128 v[172:175], v6 offset:11264
  v_mfma_f32_16x16x32_bf16 v[216:219], v[176:179], v[120:123], v[216:219]
  ds_read_b128 v[176:179], v6 offset:12288
  v_mfma_f32_16x16x32_bf16 v[220:223], v[180:183], v[120:123], v[220:223]
  ds_read_b128 v[180:183], v6 offset:13312
  v_mfma_f32_16x16x32_bf16 v[224:227], v[184:187], v[120:123], v[224:227]
  ds_read_b128 v[184:187], v6 offset:14336
  v_mfma_f32_16x16x32_bf16 v[208:211], v[188:191], v[124:127], v[208:211]
  ds_read_b128 v[188:191], v6 offset:15360
  v_mfma_f32_16x16x32_bf16 v[212:215], v[192:195], v[124:127], v[212:215]
  ds_read_b128 v[192:195], v6 offset:16384
  v_mfma_f32_16x16x32_bf16 v[216:219], v[196:199], v[124:127], v[216:219]
  ds_read_b128 v[196:199], v6 offset:17408
  v_mfma_f32_16x16x32_bf16 v[220:223], v[200:203], v[124:127], v[220:223]
  ds_read_b128 v[200:203], v6 offset:18432
  v_mfma_f32_16x16x32_bf16 v[224:227], v[204:207], v[124:127], v[224:227]
  ds_read_b128 v[204:207], v6 offset:19456
  s_waitcnt lgkmcnt(0)
  s_barrier
  s_waitcnt vmcnt(20)
  v_mfma_f32_16x16x32_bf16 v[208:211], v[128:131], v[16:19], v[208:211]
  ds_read_b128 v[128:131], v4 offset:40960
  v_mfma_f32_16x16x32_bf16 v[212:215], v[132:135], v[16:19], v[212:215]
  ds_read_b128 v[132:135], v4 offset:41984
  s_cmp_ge_u32 s33, 54
  s_cselect_b32 s34, 54, 0
  s_sub_u32 s33, s33, s34
  s_lshl_b32 s34, s33, 10
  s_add_u32 s34, s34, s27
  s_add_u32 s33, s33, 1
  buffer_load_dwordx4 v[112:115], v4, s[12:15], s34 offen sc1
  v_mfma_f32_16x16x32_bf16 v[216:219], v[136:139], v[16:19], v[216:219]
  ds_read_b128 v[136:139], v4 offset:43008
  v_mfma_f32_16x16x32_bf16 v[220:223], v[140:143], v[16:19], v[220:223]
  ds_read_b128 v[140:143], v4 offset:44032
  s_cmp_ge_u32 s33, 54
  s_cselect_b32 s34, 54, 0
  s_sub_u32 s33, s33, s34
  s_lshl_b32 s34, s33, 10
  s_add_u32 s34, s34, s27
  s_add_u32 s33, s33, 1
  buffer_load_dwordx4 v[116:119], v4, s[12:15], s34 offen sc1
  v_mfma_f32_16x16x32_bf16 v[224:227], v[144:147], v[16:19], v[224:227]
  ds_read_b128 v[144:147], v4 offset:45056
  v_mfma_f32_16x16x32_bf16 v[208:211], v[148:151], v[20:23], v[208:211]
  ds_read_b128 v[148:151], v4 offset:46080
  v_mfma_f32_16x16x32_bf16 v[212:215], v[152:155], v[20:23], v[212:215]
  ds_read_b128 v[152:155], v4 offset:47104
  v_mfma_f32_16x16x32_bf16 v[216:219], v[156:159], v[20:23], v[216:219]
  ds_read_b128 v[156:159], v4 offset:48128
  v_mfma_f32_16x16x32_bf16 v[220:223], v[160:163], v[20:23], v[220:223]
  ds_read_b128 v[160:163], v4 offset:49152
  v_mfma_f32_16x16x32_bf16 v[224:227], v[164:167], v[20:23], v[224:227]
  ds_read_b128 v[164:167], v4 offset:50176
  v_mfma_f32_16x16x32_bf16 v[208:211], v[168:171], v[24:27], v[208:211]
  ds_read_b128 v[168:171], v4 offset:51200
  v_mfma_f32_16x16x32_bf16 v[212:215], v[172:175], v[24:27], v[212:215]
  ds_read_b128 v[172:175], v4 offset:52224
  v_mfma_f32_16x16x32_bf16 v[216:219], v[176:179], v[24:27], v[216:219]
  ds_read_b128 v[176:179], v4 offset:53248
  v_mfma_f32_16x16x32_bf16 v[220:223], v[180:183], v[24:27], v[220:223]
  ds_read_b128 v[180:183], v4 offset:54272
  v_mfma_f32_16x16x32_bf16 v[224:227], v[184:187], v[24:27], v[224:227]
  ds_read_b128 v[184:187], v4 offset:55296
  v_mfma_f32_16x16x32_bf16 v[208:211], v[188:191], v[28:31], v[208:211]
  ds_read_b128 v[188:191], v4 offset:56320
  v_mfma_f32_16x16x32_bf16 v[212:215], v[192:195], v[28:31], v[212:215]
  ds_read_b128 v[192:195], v4 offset:57344
  v_mfma_f32_16x16x32_bf16 v[216:219], v[196:199], v[28:31], v[216:219]
  ds_read_b128 v[196:199], v4 offset:58368
  v_mfma_f32_16x16x32_bf16 v[220:223], v[200:203], v[28:31], v[220:223]
  ds_read_b128 v[200:203], v4 offset:59392
  v_mfma_f32_16x16x32_bf16 v[224:227], v[204:207], v[28:31], v[224:227]
  ds_read_b128 v[204:207], v4 offset:60416
  s_waitcnt lgkmcnt(0)
  s_barrier
  s_waitcnt vmcnt(18)
  v_mfma_f32_16x16x32_bf16 v[208:211], v[128:131], v[32:35], v[208:211]
  ds_read_b128 v[128:131], v5 offset:0
  v_mfma_f32_16x16x32_bf16 v[212:215], v[132:135], v[32:35], v[212:215]
  ds_read_b128 v[132:135], v5 offset:1024
  v_mfma_f32_16x16x32_bf16 v[216:219], v[136:139], v[32:35], v[216:219]
  ds_read_b128 v[136:139], v5 offset:2048
  v_mfma_f32_16x16x32_bf16 v[220:223], v[140:143], v[32:35], v[220:223]
  ds_read_b128 v[140:143], v5 offset:3072
  v_mfma_f32_16x16x32_bf16 v[224:227], v[144:147], v[32:35], v[224:227]
  ds_read_b128 v[144:147], v5 offset:4096
  v_mfma_f32_16x16x32_bf16 v[208:211], v[148:151], v[36:39], v[208:211]
  ds_read_b128 v[148:151], v5 offset:5120
  v_mfma_f32_16x16x32_bf16 v[212:215], v[152:155], v[36:39], v[212:215]
  ds_read_b128 v[152:155], v5 offset:6144
  v_mfma_f32_16x16x32_bf16 v[216:219], v[156:159], v[36:39], v[216:219]
  ds_read_b128 v[156:159], v5 offset:7168
  v_mfma_f32_16x16x32_bf16 v[220:223], v[160:163], v[36:39], v[220:223]
  ds_read_b128 v[160:163], v5 offset:8192
  v_mfma_f32_16x16x32_bf16 v[224:227], v[164:167], v[36:39], v[224:227]
  ds_read_b128 v[164:167], v5 offset:9216
  v_mfma_f32_16x16x32_bf16 v[208:211], v[168:171], v[40:43], v[208:211]
  ds_read_b128 v[168:171], v5 offset:10240
  v_mfma_f32_16x16x32_bf16 v[212:215], v[172:175], v[40:43], v[212:215]
  ds_read_b128 v[172:175], v5 offset:11264
  v_mfma_f32_16x16x32_bf16 v[216:219], v[176:179], v[40:43], v[216:219]
  ds_read_b128 v[176:179], v5 offset:12288
  v_mfma_f32_16x16x32_bf16 v[220:223], v[180:183], v[40:43], v[220:223]
  ds_read_b128 v[180:183], v5 offset:13312
  v_mfma_f32_16x16x32_bf16 v[224:227], v[184:187], v[40:43], v[224:227]
  ds_read_b128 v[184:187], v5 offset:14336
  v_mfma_f32_16x16x32_bf16 v[208:211], v[188:191], v[44:47], v[208:211]
  ds_read_b128 v[188:191], v5 offset:15360
  v_mfma_f32_16x16x32_bf16 v[212:215], v[192:195], v[44:47], v[212:215]
  ds_read_b128 v[192:195], v5 offset:16384
  v_mfma_f32_16x16x32_bf16 v[216:219], v[196:199], v[44:47], v[216:219]
  ds_read_b128 v[196:199], v5 offset:17408
  v_mfma_f32_16x16x32_bf16 v[220:223], v[200:203], v[44:47], v[220:223]
  ds_read_b128 v[200:203], v5 offset:18432
  v_mfma_f32_16x16x32_bf16 v[224:227], v[204:207], v[44:47], v[224:227]
  ds_read_b128 v[204:207], v5 offset:19456
  s_waitcnt lgkmcnt(0)
  s_barrier
  s_waitcnt vmcnt(14)
  v_mfma_f32_16x16x32_bf16 v[208:211], v[128:131], v[48:51], v[208:211]
  ds_read_b128 v[128:131], v5 offset:20480
  v_mfma_f32_16x16x32_bf16 v[212:215], v[132:135], v[48:51], v[212:215]
  ds_read_b128 v[132:135], v5 offset:21504
  v_mfma_f32_16x16x32_bf16 v[216:219], v[136:139], v[48:51], v[216:219]
  ds_read_b128 v[136:139], v5 offset:22528
  v_mfma_f32_16x16x32_bf16 v[220:223], v[140:143], v[48:51], v[220:223]
  ds_read_b128 v[140:143], v5 offset:23552
  v_mfma_f32_16x16x32_bf16 v[224:227], v[144:147], v[48:51], v[224:227]
  ds_read_b128 v[144:147], v5 offset:24576
  v_mfma_f32_16x16x32_bf16 v[208:211], v[148:151], v[52:55], v[208:211]
  ds_read_b128 v[148:151], v5 offset:25600
  v_mfma_f32_16x16x32_bf16 v[212:215], v[152:155], v[52:55], v[212:215]
  ds_read_b128 v[152:155], v5 offset:26624
  v_mfma_f32_16x16x32_bf16 v[216:219], v[156:159], v[52:55], v[216:219]
  ds_read_b128 v[156:159], v5 offset:27648
  v_mfma_f32_16x16x32_bf16 v[220:223], v[160:163], v[52:55], v[220:223]
  ds_read_b128 v[160:163], v5 offset:28672
  v_mfma_f32_16x16x32_bf16 v[224:227], v[164:167], v[52:55], v[224:227]
  ds_read_b128 v[164:167], v5 offset:29696
  v_mfma_f32_16x16x32_bf16 v[208:211], v[168:171], v[56:59], v[208:211]
  ds_read_b128 v[168:171], v5 offset:30720
  v_mfma_f32_16x16x32_bf16 v[212:215], v[172:175], v[56:59], v[212:215]
  ds_read_b128 v[172:175], v5 offset:31744
  v_mfma_f32_16x16x32_bf16 v[216:219], v[176:179], v[56:59], v[216:219]
  ds_read_b128 v[176:179], v5 offset:32768
  v_mfma_f32_16x16x32_bf16 v[220:223], v[180:183], v[56:59], v[220:223]
  ds_read_b128 v[180:183], v5 offset:33792
  v_mfma_f32_16x16x32_bf16 v[224:227], v[184:187], v[56:59], v[224:227]
  ds_read_b128 v[184:187], v5 offset:34816
  v_mfma_f32_16x16x32_bf16 v[208:211], v[188:191], v[60:63], v[208:211]
  ds_read_b128 v[188:191], v5 offset:35840
  v_mfma_f32_16x16x32_bf16 v[212:215], v[192:195], v[60:63], v[212:215]
  ds_read_b128 v[192:195], v5 offset:36864
  v_mfma_f32_16x16x32_bf16 v[216:219], v[196:199], v[60:63], v[216:219]
  ds_read_b128 v[196:199], v5 offset:37888
  v_mfma_f32_16x16x32_bf16 v[220:223], v[200:203], v[60:63], v[220:223]
  ds_read_b128 v[200:203], v5 offset:38912
  v_mfma_f32_16x16x32_bf16 v[224:227], v[204:207], v[60:63], v[224:227]
  ds_read_b128 v[204:207], v5 offset:39936
  s_waitcnt lgkmcnt(0)
  s_barrier
  s_waitcnt vmcnt(10)
  v_mfma_f32_16x16x32_bf16 v[208:211], v[128:131], v[64:67], v[208:211]
  ds_read_b128 v[128:131], v5 offset:40960
  v_mfma_f32_16x16x32_bf16 v[212:215], v[132:135], v[64:67], v[212:215]
  ds_read_b128 v[132:135], v5 offset:41984
  v_mfma_f32_16x16x32_bf16 v[216:219], v[136:139], v[64:67], v[216:219]
  ds_read_b128 v[136:139], v5 offset:43008
  v_mfma_f32_16x16x32_bf16 v[220:223], v[140:143], v[64:67], v[220:223]
  ds_read_b128 v[140:143], v5 offset:44032
  v_mfma_f32_16x16x32_bf16 v[224:227], v[144:147], v[64:67], v[224:227]
  ds_read_b128 v[144:147], v5 offset:45056
  v_mfma_f32_16x16x32_bf16 v[208:211], v[148:151], v[68:71], v[208:211]
  ds_read_b128 v[148:151], v5 offset:46080
  v_mfma_f32_16x16x32_bf16 v[212:215], v[152:155], v[68:71], v[212:215]
  ds_read_b128 v[152:155], v5 offset:47104
  v_mfma_f32_16x16x32_bf16 v[216:219], v[156:159], v[68:71], v[216:219]
  ds_read_b128 v[156:159], v5 offset:48128
  v_mfma_f32_16x16x32_bf16 v[220:223], v[160:163], v[68:71], v[220:223]
  ds_read_b128 v[160:163], v5 offset:49152
  v_mfma_f32_16x16x32_bf16 v[224:227], v[164:167], v[68:71], v[224:227]
  ds_read_b128 v[164:167], v5 offset:50176
  v_mfma_f32_16x16x32_bf16 v[208:211], v[168:171], v[72:75], v[208:211]
  ds_read_b128 v[168:171], v5 offset:51200
  v_mfma_f32_16x16x32_bf16 v[212:215], v[172:175], v[72:75], v[212:215]
  ds_read_b128 v[172:175], v5 offset:52224
  v_mfma_f32_16x16x32_bf16 v[216:219], v[176:179], v[72:75], v[216:219]
  ds_read_b128 v[176:179], v5 offset:53248
  v_mfma_f32_16x16x32_bf16 v[220:223], v[180:183], v[72:75], v[220:223]
  ds_read_b128 v[180:183], v5 offset:54272
  v_mfma_f32_16x16x32_bf16 v[224:227], v[184:187], v[72:75], v[224:227]
  ds_read_b128 v[184:187], v5 offset:55296
  v_mfma_f32_16x16x32_bf16 v[208:211], v[188:191], v[76:79], v[208:211]
  ds_read_b128 v[188:191], v5 offset:56320
  v_mfma_f32_16x16x32_bf16 v[212:215], v[192:195], v[76:79], v[212:215]
  ds_read_b128 v[192:195], v5 offset:57344
  v_mfma_f32_16x16x32_bf16 v[216:219], v[196:199], v[76:79], v[216:219]
  ds_read_b128 v[196:199], v5 offset:58368
  v_mfma_f32_16x16x32_bf16 v[220:223], v[200:203], v[76:79], v[220:223]
  ds_read_b128 v[200:203], v5 offset:59392
  v_mfma_f32_16x16x32_bf16 v[224:227], v[204:207], v[76:79], v[224:227]
  ds_read_b128 v[204:207], v5 offset:60416
  s_waitcnt lgkmcnt(0)
  s_barrier
  s_waitcnt vmcnt(6)
  v_mfma_f32_16x16x32_bf16 v[208:211], v[128:131], v[80:83], v[208:211]
  ds_read_b128 v[128:131], v4 offset:0
  v_mfma_f32_16x16x32_bf16 v[212:215], v[132:135], v[80:83], v[212:215]
  ds_read_b128 v[132:135], v4 offset:1024
  v_mfma_f32_16x16x32_bf16 v[216:219], v[136:139], v[80:83], v[216:219]
  ds_read_b128 v[136:139], v4 offset:2048
  v_mfma_f32_16x16x32_bf16 v[220:223], v[140:143], v[80:83], v[220:223]
  ds_read_b128 v[140:143], v4 offset:3072
  v_mfma_f32_16x16x32_bf16 v[224:227], v[144:147], v[80:83], v[224:227]
  ds_read_b128 v[144:147], v4 offset:4096
  v_mfma_f32_16x16x32_bf16 v[208:211], v[148:151], v[84:87], v[208:211]
  ds_read_b128 v[148:151], v4 offset:5120
  v_mfma_f32_16x16x32_bf16 v[212:215], v[152:155], v[84:87], v[212:215]
  ds_read_b128 v[152:155], v4 offset:6144
  v_mfma_f32_16x16x32_bf16 v[216:219], v[156:159], v[84:87], v[216:219]
  ds_read_b128 v[156:159], v4 offset:7168
  v_mfma_f32_16x16x32_bf16 v[220:223], v[160:163], v[84:87], v[220:223]
  ds_read_b128 v[160:163], v4 offset:8192
  v_mfma_f32_16x16x32_bf16 v[224:227], v[164:167], v[84:87], v[224:227]
  ds_read_b128 v[164:167], v4 offset:9216
  v_mfma_f32_16x16x32_bf16 v[208:211], v[168:171], v[88:91], v[208:211]
  ds_read_b128 v[168:171], v4 offset:10240
  v_mfma_f32_16x16x32_bf16 v[212:215], v[172:175], v[88:91], v[212:215]
  ds_read_b128 v[172:175], v4 offset:11264
  v_mfma_f32_16x16x32_bf16 v[216:219], v[176:179], v[88:91], v[216:219]
  ds_read_b128 v[176:179], v4 offset:12288
  v_mfma_f32_16x16x32_bf16 v[220:223], v[180:183], v[88:91], v[220:223]
  ds_read_b128 v[180:183], v4 offset:13312
  v_mfma_f32_16x16x32_bf16 v[224:227], v[184:187], v[88:91], v[224:227]
  ds_read_b128 v[184:187], v4 offset:14336
  v_mfma_f32_16x16x32_bf16 v[208:211], v[188:191], v[92:95], v[208:211]
  ds_read_b128 v[188:191], v4 offset:15360
  v_mfma_f32_16x16x32_bf16 v[212:215], v[192:195], v[92:95], v[212:215]
  ds_read_b128 v[192:195], v4 offset:16384
  v_mfma_f32_16x16x32_bf16 v[216:219], v[196:199], v[92:95], v[216:219]
  ds_read_b128 v[196:199], v4 offset:17408
  v_mfma_f32_16x16x32_bf16 v[220:223], v[200:203], v[92:95], v[220:223]
  ds_read_b128 v[200:203], v4 offset:18432
  v_mfma_f32_16x16x32_bf16 v[224:227], v[204:207], v[92:95], v[224:227]
  ds_read_b128 v[204:207], v4 offset:19456
  s_waitcnt lgkmcnt(0)
  s_barrier
  s_waitcnt vmcnt(2)
  v_mfma_f32_16x16x32_bf16 v[208:211], v[128:131], v[96:99], v[208:211]
  ds_read_b128 v[128:131], v4 offset:20480
  v_mfma_f32_16x16x32_bf16 v[212:215], v[132:135], v[96:99], v[212:215]
  ds_read_b128 v[132:135], v4 offset:21504
  v_mfma_f32_16x16x32_bf16 v[216:219], v[136:139], v[96:99], v[216:219]
  ds_read_b128 v[136:139], v4 offset:22528
  v_mfma_f32_16x16x32_bf16 v[220:223], v[140:143], v[96:99], v[220:223]
  ds_read_b128 v[140:143], v4 offset:23552
  v_mfma_f32_16x16x32_bf16 v[224:227], v[144:147], v[96:99], v[224:227]
  ds_read_b128 v[144:147], v4 offset:24576
  v_mfma_f32_16x16x32_bf16 v[208:211], v[148:151], v[100:103], v[208:211]
  ds_read_b128 v[148:151], v4 offset:25600
  v_mfma_f32_16x16x32_bf16 v[212:215], v[152:155], v[100:103], v[212:215]
  ds_read_b128 v[152:155], v4 offset:26624
  v_mfma_f32_16x16x32_bf16 v[216:219], v[156:159], v[100:103], v[216:219]
  ds_read_b128 v[156:159], v4 offset:27648
  v_mfma_f32_16x16x32_bf16 v[220:223], v[160:163], v[100:103], v[220:223]
  ds_read_b128 v[160:163], v4 offset:28672
  v_mfma_f32_16x16x32_bf16 v[224:227], v[164:167], v[100:103], v[224:227]
  ds_read_b128 v[164:167], v4 offset:29696
  v_mfma_f32_16x16x32_bf16 v[208:211], v[168:171], v[104:107], v[208:211]
  v_mfma_f32_16x16x32_bf16 v[212:215], v[172:175], v[104:107], v[212:215]
  v_mfma_f32_16x16x32_bf16 v[216:219], v[176:179], v[104:107], v[216:219]
  v_mfma_f32_16x16x32_bf16 v[220:223], v[180:183], v[104:107], v[220:223]
  v_mfma_f32_16x16x32_bf16 v[224:227], v[184:187], v[104:107], v[224:227]
  v_mfma_f32_16x16x32_bf16 v[208:211], v[188:191], v[108:111], v[208:211]
  v_mfma_f32_16x16x32_bf16 v[212:215], v[192:195], v[108:111], v[212:215]
  v_mfma_f32_16x16x32_bf16 v[216:219], v[196:199], v[108:111], v[216:219]
  v_mfma_f32_16x16x32_bf16 v[220:223], v[200:203], v[108:111], v[220:223]
  v_mfma_f32_16x16x32_bf16 v[224:227], v[204:207], v[108:111], v[224:227]
  s_waitcnt lgkmcnt(0)
  s_waitcnt vmcnt(0)
  v_mfma_f32_16x16x32_bf16 v[208:211], v[128:131], v[112:115], v[208:211]
  v_mfma_f32_16x16x32_bf16 v[212:215], v[132:135], v[112:115], v[212:215]
  v_mfma_f32_16x16x32_bf16 v[216:219], v[136:139], v[112:115], v[216:219]
  v_mfma_f32_16x16x32_bf16 v[220:223], v[140:143], v[112:115], v[220:223]
  v_mfma_f32_16x16x32_bf16 v[224:227], v[144:147], v[112:115], v[224:227]
  v_mfma_f32_16x16x32_bf16 v[208:211], v[148:151], v[116:119], v[208:211]
  v_mfma_f32_16x16x32_bf16 v[212:215], v[152:155], v[116:119], v[212:215]
  v_mfma_f32_16x16x32_bf16 v[216:219], v[156:159], v[116:119], v[216:219]
  v_mfma_f32_16x16x32_bf16 v[220:223], v[160:163], v[116:119], v[220:223]
  v_mfma_f32_16x16x32_bf16 v[224:227], v[164:167], v[116:119], v[224:227]
  s_mul_i32 s35, s25, 3072
  s_add_u32 s35, s35, 143360
  v_add_u32 v10, s35, v4
  ds_read_b128 v[228:231], v10
  ds_read_b128 v[232:235], v10 offset:1024
  ds_read_b128 v[236:239], v10 offset:2048
  s_waitcnt lgkmcnt(0)
  v_cvt_pk_bf16_f32 v16, v208, v209
  v_cvt_pk_bf16_f32 v17, v210, v211
  v_cvt_pk_bf16_f32 v18, v212, v213
  v_cvt_pk_bf16_f32 v19, v214, v215
  v_cvt_pk_bf16_f32 v20, v216, v217
  v_cvt_pk_bf16_f32 v21, v218, v219
  v_cvt_pk_bf16_f32 v22, v220, v221
  v_cvt_pk_bf16_f32 v23, v222, v223
  v_cvt_pk_bf16_f32 v24, v224, v225
  v_cvt_pk_bf16_f32 v25, v226, v227
  v_lshlrev_b32 v32, 16, v16
  v_and_b32 v33, 0xffff0000, v16
  v_lshlrev_b32 v56, 16, v228
  v_and_b32 v57, 0xffff0000, v228
  v_lshlrev_b32 v34, 16, v17
  v_and_b32 v35, 0xffff0000, v17
  v_lshlrev_b32 v58, 16, v229
  v_and_b32 v59, 0xffff0000, v229
  v_lshlrev_b32 v36, 16, v18
  v_and_b32 v37, 0xffff0000, v18
  v_lshlrev_b32 v60, 16, v230
  v_and_b32 v61, 0xffff0000, v230
  v_lshlrev_b32 v38, 16, v19
  v_and_b32 v39, 0xffff0000, v19
  v_lshlrev_b32 v62, 16, v231
  v_and_b32 v63, 0xffff0000, v231
  v_lshlrev_b32 v40, 16, v20
  v_and_b32 v41, 0xffff0000, v20
  v_lshlrev_b32 v64, 16, v232
  v_and_b32 v65, 0xffff0000, v232
  v_lshlrev_b32 v42, 16, v21
  v_and_b32 v43, 0xffff0000, v21
  v_lshlrev_b32 v66, 16, v233
  v_and_b32 v67, 0xffff0000, v233
  v_lshlrev_b32 v44, 16, v22
  v_and_b32 v45, 0xffff0000, v22
  v_lshlrev_b32 v68, 16, v234
  v_and_b32 v69, 0xffff0000, v234
  v_lshlrev_b32 v46, 16, v23
  v_and_b32 v47, 0xffff0000, v23
  v_lshlrev_b32 v70, 16, v235
  v_and_b32 v71, 0xffff0000, v235
  v_lshlrev_b32 v48, 16, v24
  v_and_b32 v49, 0xffff0000, v24
  v_lshlrev_b32 v72, 16, v236
  v_and_b32 v73, 0xffff0000, v236
  v_lshlrev_b32 v50, 16, v25
  v_and_b32 v51, 0xffff0000, v25
  v_lshlrev_b32 v74, 16, v237
  v_and_b32 v75, 0xffff0000, v237
  v_pk_add_f32 v[32:33], v[32:33], v[56:57]
  v_pk_add_f32 v[34:35], v[34:35], v[58:59]
  v_pk_add_f32 v[36:37], v[36:37], v[60:61]
  v_pk_add_f32 v[38:39], v[38:39], v[62:63]
  v_pk_add_f32 v[40:41], v[40:41], v[64:65]
  v_pk_add_f32 v[42:43], v[42:43], v[66:67]
  v_pk_add_f32 v[44:45], v[44:45], v[68:69]
  v_pk_add_f32 v[46:47], v[46:47], v[70:71]
  v_pk_add_f32 v[48:49], v[48:49], v[72:73]
  v_pk_add_f32 v[50:51], v[50:51], v[74:75]
  v_cvt_pk_bf16_f32 v80, v32, v33
  v_cvt_pk_bf16_f32 v81, v34, v35
  v_cvt_pk_bf16_f32 v82, v36, v37
  v_cvt_pk_bf16_f32 v83, v38, v39
  v_cvt_pk_bf16_f32 v84, v40, v41
  v_cvt_pk_bf16_f32 v85, v42, v43
  v_cvt_pk_bf16_f32 v86, v44, v45
  v_cvt_pk_bf16_f32 v87, v46, v47
  v_cvt_pk_bf16_f32 v88, v48, v49
  v_cvt_pk_bf16_f32 v89, v50, v51
  buffer_store_dwordx4 v[80:83], v9, s[16:19], 0 offen
  buffer_store_dwordx4 v[84:87], v9, s[16:19], 0 offen offset:16
  buffer_store_dwordx2 v[88:89], v9, s[16:19], 0 offen offset:32
  s_branch Lsequential_preLN__linear_kernel_hedgehog__geglu_ffn__prompt_kernel_fin
Lsequential_preLN__linear_kernel_hedgehog__geglu_ffn__prompt_kernel_H3:
  s_cmp_lg_u32 s22, 4
  s_cbranch_scc1 Lsequential_preLN__linear_kernel_hedgehog__geglu_ffn__prompt_kernel_fw1
  s_mov_b32 s31, 24674304
  v_lshlrev_b32 v8, 7, v1
  s_mov_b32 s97, 0
Lsequential_preLN__linear_kernel_hedgehog__geglu_ffn__prompt_kernel_pw:
  buffer_load_dword v9, v8, s[12:15], s31 offen sc1
  s_add_u32 s30, s31, 8192
  buffer_load_dword v10, v8, s[12:15], s30 offen sc1
  s_add_u32 s30, s31, 16384
  buffer_load_dword v11, v8, s[12:15], s30 offen sc1
  s_add_u32 s30, s31, 24576
  buffer_load_dword v12, v8, s[12:15], s30 offen sc1
  s_add_u32 s97, s97, 1
  s_waitcnt vmcnt(0)
  v_xor_b32 v9, s96, v9
  v_xor_b32 v10, s96, v10
  v_xor_b32 v11, s96, v11
  v_xor_b32 v12, s96, v12
  v_or_b32 v9, v9, v10
  v_or_b32 v9, v9, v11
  v_or_b32 v9, v9, v12
  v_cmp_ne_u32 vcc, 0, v9
  s_cmp_gt_u32 s97, 0x40000
  s_cbranch_scc1 Lsequential_preLN__linear_kernel_hedgehog__geglu_ffn__prompt_kernel_pw_x
  s_cbranch_vccnz Lsequential_preLN__linear_kernel_hedgehog__geglu_ffn__prompt_kernel_pw
Lsequential_preLN__linear_kernel_hedgehog__geglu_ffn__prompt_kernel_pw_x:
  s_mov_b64 exec, -1
  v_mov_b32 v8, 163824
  v_mov_b32 v9, 1
  ds_write_b32 v8, v9 offset:4
  s_branch Lsequential_preLN__linear_kernel_hedgehog__geglu_ffn__prompt_kernel_fw2
Lsequential_preLN__linear_kernel_hedgehog__geglu_ffn__prompt_kernel_fw1:
  v_mov_b32 v8, 163824
  s_mov_b32 s97, 0
Lsequential_preLN__linear_kernel_hedgehog__geglu_ffn__prompt_kernel_fw3:
  ds_read_b32 v9, v8 offset:4
  s_add_u32 s97, s97, 1
  s_waitcnt lgkmcnt(0)
  v_readfirstlane_b32 s33, v9
  s_cmp_gt_u32 s97, 0x1000000
  s_cbranch_scc1 Lsequential_preLN__linear_kernel_hedgehog__geglu_ffn__prompt_kernel_fw2
  s_nop 1
  s_cmp_eq_u32 s33, 0
  s_cbranch_scc1 Lsequential_preLN__linear_kernel_hedgehog__geglu_ffn__prompt_kernel_fw3
Lsequential_preLN__linear_kernel_hedgehog__geglu_ffn__prompt_kernel_fw2:
  v_lshlrev_b32 v4, 4, v1
  v_lshlrev_b32 v5, 4, v3
  s_mul_i32 s28, s24, 102400
  s_add_u32 s28, s28, 14942208
  s_mul_i32 s29, s25, 6144
  s_and_b32 s33, s21, 3
  s_mul_i32 s33, s33, 5
  s_add_u32 s33, s33, s25
  s_cmp_ge_u32 s33, 20
  s_cselect_b32 s34, 20, 0
  s_sub_u32 s33, s33, s34
  s_mul_i32 s34, s33, 5120
  s_add_u32 s34, s34, s28
  s_lshl_b32 s30, s33, 6
  s_add_u32 s30, s30, 24633344
  s_add_u32 m0, s29, 0
  s_nop 0
  buffer_load_dwordx4 v4, s[12:15], s34 offen offset:0 sc1 lds
  buffer_load_dwordx4 v4, s[12:15], s34 offen offset:1024 sc1 lds
  buffer_load_dwordx4 v4, s[12:15], s34 offen offset:2048 sc1 lds
  buffer_load_dwordx4 v4, s[12:15], s34 offen offset:3072 sc1 lds
  s_add_u32 m0, s29, 4096
  s_add_u32 s32, s34, 4096
  buffer_load_dwordx4 v4, s[12:15], s32 offen sc1 lds
  s_add_u32 m0, s29, 5120
  s_nop 0
  buffer_load_dwordx4 v5, s[12:15], s30 offen sc1 lds
  s_add_u32 s33, s33, 4
  s_cmp_ge_u32 s33, 20
  s_cselect_b32 s34, 20, 0
  s_sub_u32 s33, s33, s34
  s_mul_i32 s34, s33, 5120
  s_add_u32 s34, s34, s28
  s_lshl_b32 s30, s33, 6
  s_add_u32 s30, s30, 24633344
  s_add_u32 m0, s29, 24576
  s_nop 0
  buffer_load_dwordx4 v4, s[12:15], s34 offen offset:0 sc1 lds
  buffer_load_dwordx4 v4, s[12:15], s34 offen offset:1024 sc1 lds
  buffer_load_dwordx4 v4, s[12:15], s34 offen offset:2048 sc1 lds
  buffer_load_dwordx4 v4, s[12:15], s34 offen offset:3072 sc1 lds
  s_add_u32 m0, s29, 28672
  s_add_u32 s32, s34, 4096
  buffer_load_dwordx4 v4, s[12:15], s32 offen sc1 lds
  s_add_u32 m0, s29, 29696
  s_nop 0
  buffer_load_dwordx4 v5, s[12:15], s30 offen sc1 lds
  s_add_u32 s33, s33, 4
  s_cmp_ge_u32 s33, 20
  s_cselect_b32 s34, 20, 0
  s_sub_u32 s33, s33, s34
  s_mul_i32 s34, s33, 5120
  s_add_u32 s34, s34, s28
  s_lshl_b32 s30, s33, 6
  s_add_u32 s30, s30, 24633344
  s_add_u32 m0, s29, 49152
  s_nop 0
  buffer_load_dwordx4 v4, s[12:15], s34 offen offset:0 sc1 lds
  buffer_load_dwordx4 v4, s[12:15], s34 offen offset:1024 sc1 lds
  buffer_load_dwordx4 v4, s[12:15], s34 offen offset:2048 sc1 lds
  buffer_load_dwordx4 v4, s[12:15], s34 offen offset:3072 sc1 lds
  s_add_u32 m0, s29, 53248
  s_add_u32 s32, s34, 4096
  buffer_load_dwordx4 v4, s[12:15], s32 offen sc1 lds
  s_add_u32 m0, s29, 54272
  s_nop 0
  buffer_load_dwordx4 v5, s[12:15], s30 offen sc1 lds
  s_add_u32 s33, s33, 4
  s_waitcnt vmcnt(12)
  s_barrier
  s_cmp_ge_u32 s33, 20
  s_cselect_b32 s34, 20, 0
  s_sub_u32 s33, s33, s34
  s_mul_i32 s34, s33, 5120
  s_add_u32 s34, s34, s28
  s_lshl_b32 s30, s33, 6
  s_add_u32 s30, s30, 24633344
  s_add_u32 m0, s29, 73728
  s_nop 0
  buffer_load_dwordx4 v4, s[12:15], s34 offen offset:0 sc1 lds
  buffer_load_dwordx4 v4, s[12:15], s34 offen offset:1024 sc1 lds
  buffer_load_dwordx4 v4, s[12:15], s34 offen offset:2048 sc1 lds
  buffer_load_dwordx4 v4, s[12:15], s34 offen offset:3072 sc1 lds
  s_add_u32 m0, s29, 77824
  s_add_u32 s32, s34, 4096
  buffer_load_dwordx4 v4, s[12:15], s32 offen sc1 lds
  s_add_u32 m0, s29, 78848
  s_nop 0
  buffer_load_dwordx4 v5, s[12:15], s30 offen sc1 lds
  s_add_u32 s33, s33, 4
  s_waitcnt vmcnt(12)
  s_barrier
  s_cmp_ge_u32 s33, 20
  s_cselect_b32 s34, 20, 0
  s_sub_u32 s33, s33, s34
  s_mul_i32 s34, s33, 5120
  s_add_u32 s34, s34, s28
  s_lshl_b32 s30, s33, 6
  s_add_u32 s30, s30, 24633344
  s_add_u32 m0, s29, 98304
  s_nop 0
  buffer_load_dwordx4 v4, s[12:15], s34 offen offset:0 sc1 lds
  buffer_load_dwordx4 v4, s[12:15], s34 offen offset:1024 sc1 lds
  buffer_load_dwordx4 v4, s[12:15], s34 offen offset:2048 sc1 lds
  buffer_load_dwordx4 v4, s[12:15], s34 offen offset:3072 sc1 lds
  s_add_u32 m0, s29, 102400
  s_add_u32 s32, s34, 4096
  buffer_load_dwordx4 v4, s[12:15], s32 offen sc1 lds
  s_add_u32 m0, s29, 103424
  s_nop 0
  buffer_load_dwordx4 v5, s[12:15], s30 offen sc1 lds
  s_add_u32 s33, s33, 4
  s_waitcnt vmcnt(12)
  s_barrier
  s_waitcnt vmcnt(6)
  s_barrier
  s_waitcnt vmcnt(0)
  s_barrier
  s_barrier
  s_and_b32 s20, s2, 7
  s_lshr_b32 s21, s2, 3
  s_lshr_b32 s23, s20, 2
  s_lshl_b32 s23, s23, 3
  s_lshr_b32 s24, s21, 2
  s_add_u32 s23, s23, s24
  s_and_b32 s24, s20, 3
  s_lshl_b32 s24, s24, 2
  s_and_b32 s27, s21, 3
  s_add_u32 s24, s24, s27
  s_mov_b32 s18, s24
  s_mul_i32 s24, s24, 7
  s_min_u32 s24, s24, 101
  s_lshl_b32 s26, s23, 7
  s_lshl_b32 s27, s25, 5
  s_add_u32 s26, s26, s27
  v_lshlrev_b32 v4, 4, v1
  s_mul_i32 s28, s24, 40960
  s_and_b32 s29, s21, 3
  s_add_u32 s29, s29, s25
  s_and_b32 s29, s29, 3
  s_mul_i32 s29, s29, 10240
  s_add_u32 s28, s28, s29
  s_add_u32 s28, s28, 15761408
  s_mul_i32 s29, s25, 10240
  s_add_u32 m0, s29, 0
  s_add_u32 s32, s28, 0
  buffer_load_dwordx4 v4, s[12:15], s32 offen offset:0 sc1 lds
  buffer_load_dwordx4 v4, s[12:15], s32 offen offset:1024 sc1 lds
  buffer_load_dwordx4 v4, s[12:15], s32 offen offset:2048 sc1 lds
  buffer_load_dwordx4 v4, s[12:15], s32 offen offset:3072 sc1 lds
  s_add_u32 m0, s29, 4096
  s_add_u32 s32, s28, 4096
  buffer_load_dwordx4 v4, s[12:15], s32 offen offset:0 sc1 lds
  buffer_load_dwordx4 v4, s[12:15], s32 offen offset:1024 sc1 lds
  buffer_load_dwordx4 v4, s[12:15], s32 offen offset:2048 sc1 lds
  buffer_load_dwordx4 v4, s[12:15], s32 offen offset:3072 sc1 lds
  s_add_u32 m0, s29, 8192
  s_add_u32 s32, s28, 8192
  buffer_load_dwordx4 v4, s[12:15], s32 offen offset:0 sc1 lds
  buffer_load_dwordx4 v4, s[12:15], s32 offen offset:1024 sc1 lds
  s_add_u32 m0, s29, 40960
  s_add_u32 s32, s28, 40960
  buffer_load_dwordx4 v4, s[12:15], s32 offen offset:0 sc1 lds
  buffer_load_dwordx4 v4, s[12:15], s32 offen offset:1024 sc1 lds
  buffer_load_dwordx4 v4, s[12:15], s32 offen offset:2048 sc1 lds
  buffer_load_dwordx4 v4, s[12:15], s32 offen offset:3072 sc1 lds
  s_add_u32 m0, s29, 45056
  s_add_u32 s32, s28, 45056
  buffer_load_dwordx4 v4, s[12:15], s32 offen offset:0 sc1 lds
  buffer_load_dwordx4 v4, s[12:15], s32 offen offset:1024 sc1 lds
  buffer_load_dwordx4 v4, s[12:15], s32 offen offset:2048 sc1 lds
  buffer_load_dwordx4 v4, s[12:15], s32 offen offset:3072 sc1 lds
  s_add_u32 m0, s29, 49152
  s_add_u32 s32, s28, 49152
  buffer_load_dwordx4 v4, s[12:15], s32 offen offset:0 sc1 lds
  buffer_load_dwordx4 v4, s[12:15], s32 offen offset:1024 sc1 lds
  s_add_u32 m0, s29, 81920
  s_add_u32 s32, s28, 81920
  buffer_load_dwordx4 v4, s[12:15], s32 offen offset:0 sc1 lds
  buffer_load_dwordx4 v4, s[12:15], s32 offen offset:1024 sc1 lds
  buffer_load_dwordx4 v4, s[12:15], s32 offen offset:2048 sc1 lds
  buffer_load_dwordx4 v4, s[12:15], s32 offen offset:3072 sc1 lds
  s_add_u32 m0, s29, 86016
  s_add_u32 s32, s28, 86016
  buffer_load_dwordx4 v4, s[12:15], s32 offen offset:0 sc1 lds
  buffer_load_dwordx4 v4, s[12:15], s32 offen offset:1024 sc1 lds
  buffer_load_dwordx4 v4, s[12:15], s32 offen offset:2048 sc1 lds
  buffer_load_dwordx4 v4, s[12:15], s32 offen offset:3072 sc1 lds
  s_add_u32 m0, s29, 90112
  s_add_u32 s32, s28, 90112
  buffer_load_dwordx4 v4, s[12:15], s32 offen offset:0 sc1 lds
  buffer_load_dwordx4 v4, s[12:15], s32 offen offset:1024 sc1 lds
  s_barrier
  s_barrier
  s_mov_b32 s44, s23
  s_mov_b32 s45, s24
  s_mov_b32 s46, s26
  s_and_b32 s20, s2, 7
  s_lshr_b32 s21, s2, 3
  s_lshl_b32 s23, s20, 2
  s_lshr_b32 s24, s21, 3
  s_add_u32 s23, s23, s24
  s_and_b32 s24, s21, 7
  s_lshl_b32 s26, s23, 2
  s_add_u32 s26, s26, s25
  v_lshlrev_b32 v4, 4, v1
  s_mul_i32 s40, s24, 276480
  s_add_u32 s40, s40, 20185088
  s_mul_i32 s41, s25, 5120
  s_and_b32 s43, s21, 7
  s_mul_i32 s43, s43, 7
  s_add_u32 s43, s43, s25
  s_mov_b32 s23, s44
  s_mov_b32 s24, s45
  s_mov_b32 s26, s46
  s_lshr_b32 s35, s26, 4
  s_mul_i32 s35, s35, 55296
  s_add_u32 s35, s35, 7864320
  s_lshl_b32 s30, s25, 12
  v_add_u32 v5, s30, v4
  v_add_u32 v5, 122880, v5
  v_add_u32 v14, s26, v21
  v_lshlrev_b32 v14, 2, v14
  v_lshl_add_u32 v14, v3, 14, v14
  s_mov_b32 s34, 24567808
  s_mov_b32 s33, 24576000
  buffer_load_dword v24, v14, s[12:15], s34 offen offset:0 sc1
  buffer_load_dword v25, v14, s[12:15], s33 offen offset:0 sc1
  buffer_load_dword v26, v14, s[12:15], s34 offen offset:64 sc1
  buffer_load_dword v27, v14, s[12:15], s33 offen offset:64 sc1
  s_waitcnt vmcnt(24)
  s_barrier
  s_waitcnt vmcnt(0)
  v_add_f32 v28, v24, v25
  v_mov_b32 v29, v28
  s_nop 1
  v_permlane16_swap_b32 v29, v28
  v_add_f32 v28, v28, v29
  v_mov_b32 v29, v28
  s_nop 1
  v_permlane32_swap_b32 v29, v28
  v_add_f32 v28, v28, v29
  v_mul_f32 v28, 0x3acccccd, v28
  v_cvt_pk_bf16_f32 v29, v28, v28
  v_lshlrev_b32 v28, 16, v29
  v_add_f32 v28, 0x3727c5ac, v28
  v_cvt_pk_bf16_f32 v29, v28, v28
  v_lshlrev_b32 v28, 16, v29
  v_sqrt_f32 v28, v28
  s_nop 0
  v_cvt_pk_bf16_f32 v29, v28, v28
  v_lshlrev_b32 v28, 16, v29
  v_mul_f32 v42, v28, v28
  v_rcp_f32 v29, v28
  s_nop 0
  v_mul_f32 v40, 0xc0135761, v29
  v_mul_f32 v31, v29, v29
  v_mul_f32 v31, v31, v29
  v_mul_f32 v41, 0xbdd2d3e8, v31
  v_add_f32 v32, v26, v27
  v_mov_b32 v33, v32
  s_nop 1
  v_permlane16_swap_b32 v33, v32
  v_add_f32 v32, v32, v33
  v_mov_b32 v33, v32
  s_nop 1
  v_permlane32_swap_b32 v33, v32
  v_add_f32 v32, v32, v33
  v_mul_f32 v32, 0x3acccccd, v32
  v_cvt_pk_bf16_f32 v33, v32, v32
  v_lshlrev_b32 v32, 16, v33
  v_add_f32 v32, 0x3727c5ac, v32
  v_cvt_pk_bf16_f32 v33, v32, v32
  v_lshlrev_b32 v32, 16, v33
  v_sqrt_f32 v32, v32
  s_nop 0
  v_cvt_pk_bf16_f32 v33, v32, v32
  v_lshlrev_b32 v32, 16, v33
  v_mul_f32 v45, v32, v32
  v_rcp_f32 v33, v32
  s_nop 0
  v_mul_f32 v43, 0xc0135761, v33
  v_mul_f32 v35, v33, v33
  v_mul_f32 v35, v35, v33
  v_mul_f32 v44, 0xbdd2d3e8, v35
  s_lshl_b32 s30, s25, 11
  s_add_u32 s30, s30, 155648
  v_add_u32 v6, s30, v4
  ds_write_b128 v6, v[40:43]
  ds_write_b128 v6, v[44:47] offset:1024
  s_waitcnt lgkmcnt(0)
  s_waitcnt vmcnt(4)
  s_barrier
  s_add_u32 m0, s29, 0
  s_add_u32 s32, s28, 122880
  buffer_load_dwordx4 v4, s[12:15], s32 offen offset:0 sc1 lds
  buffer_load_dwordx4 v4, s[12:15], s32 offen offset:1024 sc1 lds
  buffer_load_dwordx4 v4, s[12:15], s32 offen offset:2048 sc1 lds
  buffer_load_dwordx4 v4, s[12:15], s32 offen offset:3072 sc1 lds
  s_add_u32 m0, s29, 4096
  s_add_u32 s32, s28, 126976
  buffer_load_dwordx4 v4, s[12:15], s32 offen offset:0 sc1 lds
  buffer_load_dwordx4 v4, s[12:15], s32 offen offset:1024 sc1 lds
  buffer_load_dwordx4 v4, s[12:15], s32 offen offset:2048 sc1 lds
  buffer_load_dwordx4 v4, s[12:15], s32 offen offset:3072 sc1 lds
  s_add_u32 m0, s29, 8192
  s_add_u32 s32, s28, 131072
  buffer_load_dwordx4 v4, s[12:15], s32 offen offset:0 sc1 lds
  buffer_load_dwordx4 v4, s[12:15], s32 offen offset:1024 sc1 lds
  s_add_u32 m0, s29, 40960
  s_add_u32 s32, s28, 163840
  buffer_load_dwordx4 v4, s[12:15], s32 offen offset:0 sc1 lds
  buffer_load_dwordx4 v4, s[12:15], s32 offen offset:1024 sc1 lds
  buffer_load_dwordx4 v4, s[12:15], s32 offen offset:2048 sc1 lds
  buffer_load_dwordx4 v4, s[12:15], s32 offen offset:3072 sc1 lds
  s_add_u32 m0, s29, 45056
  s_add_u32 s32, s28, 167936
  buffer_load_dwordx4 v4, s[12:15], s32 offen offset:0 sc1 lds
  buffer_load_dwordx4 v4, s[12:15], s32 offen offset:1024 sc1 lds
  buffer_load_dwordx4 v4, s[12:15], s32 offen offset:2048 sc1 lds
  buffer_load_dwordx4 v4, s[12:15], s32 offen offset:3072 sc1 lds
  s_add_u32 m0, s29, 49152
  s_add_u32 s32, s28, 172032
  buffer_load_dwordx4 v4, s[12:15], s32 offen offset:0 sc1 lds
  buffer_load_dwordx4 v4, s[12:15], s32 offen offset:1024 sc1 lds
  s_waitcnt vmcnt(10)
  s_barrier
  s_add_u32 m0, s29, 81920
  s_add_u32 s32, s28, 204800
  buffer_load_dwordx4 v4, s[12:15], s32 offen offset:0 sc1 lds
  buffer_load_dwordx4 v4, s[12:15], s32 offen offset:1024 sc1 lds
  buffer_load_dwordx4 v4, s[12:15], s32 offen offset:2048 sc1 lds
  buffer_load_dwordx4 v4, s[12:15], s32 offen offset:3072 sc1 lds
  s_add_u32 m0, s29, 86016
  s_add_u32 s32, s28, 208896
  buffer_load_dwordx4 v4, s[12:15], s32 offen offset:0 sc1 lds
  buffer_load_dwordx4 v4, s[12:15], s32 offen offset:1024 sc1 lds
  buffer_load_dwordx4 v4, s[12:15], s32 offen offset:2048 sc1 lds
  buffer_load_dwordx4 v4, s[12:15], s32 offen offset:3072 sc1 lds
  s_add_u32 m0, s29, 90112
  s_add_u32 s32, s28, 212992
  buffer_load_dwordx4 v4, s[12:15], s32 offen offset:0 sc1 lds
  buffer_load_dwordx4 v4, s[12:15], s32 offen offset:1024 sc1 lds
  s_waitcnt vmcnt(10)
  s_barrier
  s_add_u32 m0, s29, 0
  s_add_u32 s32, s28, 245760
  buffer_load_dwordx4 v4, s[12:15], s32 offen offset:0 sc1 lds
  buffer_load_dwordx4 v4, s[12:15], s32 offen offset:1024 sc1 lds
  buffer_load_dwordx4 v4, s[12:15], s32 offen offset:2048 sc1 lds
  buffer_load_dwordx4 v4, s[12:15], s32 offen offset:3072 sc1 lds
  s_add_u32 m0, s29, 4096
  s_add_u32 s32, s28, 249856
  buffer_load_dwordx4 v4, s[12:15], s32 offen offset:0 sc1 lds
  buffer_load_dwordx4 v4, s[12:15], s32 offen offset:1024 sc1 lds
  buffer_load_dwordx4 v4, s[12:15], s32 offen offset:2048 sc1 lds
  buffer_load_dwordx4 v4, s[12:15], s32 offen offset:3072 sc1 lds
  s_add_u32 m0, s29, 8192
  s_add_u32 s32, s28, 253952
  buffer_load_dwordx4 v4, s[12:15], s32 offen offset:0 sc1 lds
  buffer_load_dwordx4 v4, s[12:15], s32 offen offset:1024 sc1 lds
  s_waitcnt vmcnt(10)
  s_barrier
  s_cmp_ge_u32 s43, 54
  s_cselect_b32 s42, 54, 0
  s_sub_u32 s43, s43, s42
  s_mul_i32 s42, s43, 5120
  s_add_u32 s42, s42, s40
  s_add_u32 s43, s43, 4
  s_add_u32 m0, s41, 122880
  s_nop 0
  buffer_load_dwordx4 v4, s[12:15], s42 offen offset:0 sc1 lds
  buffer_load_dwordx4 v4, s[12:15], s42 offen offset:1024 sc1 lds
  buffer_load_dwordx4 v4, s[12:15], s42 offen offset:2048 sc1 lds
  buffer_load_dwordx4 v4, s[12:15], s42 offen offset:3072 sc1 lds
  s_add_u32 m0, s41, 126976
  s_add_u32 s42, s42, 4096
  buffer_load_dwordx4 v4, s[12:15], s42 offen sc1 lds
  s_cmp_ge_u32 s43, 54
  s_cselect_b32 s42, 54, 0
  s_sub_u32 s43, s43, s42
  s_mul_i32 s42, s43, 5120
  s_add_u32 s42, s42, s40
  s_add_u32 s43, s43, 4
  s_add_u32 m0, s41, 40960
  s_nop 0
  buffer_load_dwordx4 v4, s[12:15], s42 offen offset:0 sc1 lds
  buffer_load_dwordx4 v4, s[12:15], s42 offen offset:1024 sc1 lds
  buffer_load_dwordx4 v4, s[12:15], s42 offen offset:2048 sc1 lds
  buffer_load_dwordx4 v4, s[12:15], s42 offen offset:3072 sc1 lds
  s_add_u32 m0, s41, 45056
  s_add_u32 s42, s42, 4096
  buffer_load_dwordx4 v4, s[12:15], s42 offen sc1 lds
  s_cmp_ge_u32 s43, 54
  s_cselect_b32 s42, 54, 0
  s_sub_u32 s43, s43, s42
  s_mul_i32 s42, s43, 5120
  s_add_u32 s42, s42, s40
  s_add_u32 s43, s43, 4
  s_add_u32 m0, s41, 61440
  s_nop 0
  buffer_load_dwordx4 v4, s[12:15], s42 offen offset:0 sc1 lds
  buffer_load_dwordx4 v4, s[12:15], s42 offen offset:1024 sc1 lds
  buffer_load_dwordx4 v4, s[12:15], s42 offen offset:2048 sc1 lds
  buffer_load_dwordx4 v4, s[12:15], s42 offen offset:3072 sc1 lds
  s_add_u32 m0, s41, 65536
  s_add_u32 s42, s42, 4096
  buffer_load_dwordx4 v4, s[12:15], s42 offen sc1 lds
  s_waitcnt vmcnt(15)
  s_barrier
  s_cmp_ge_u32 s43, 54
  s_cselect_b32 s42, 54, 0
  s_sub_u32 s43, s43, s42
  s_mul_i32 s42, s43, 5120
  s_add_u32 s42, s42, s40
  s_add_u32 s43, s43, 4
  s_add_u32 m0, s41, 81920
  s_nop 0
  buffer_load_dwordx4 v4, s[12:15], s42 offen offset:0 sc1 lds
  buffer_load_dwordx4 v4, s[12:15], s42 offen offset:1024 sc1 lds
  buffer_load_dwordx4 v4, s[12:15], s42 offen offset:2048 sc1 lds
  buffer_load_dwordx4 v4, s[12:15], s42 offen offset:3072 sc1 lds
  s_add_u32 m0, s41, 86016
  s_add_u32 s42, s42, 4096
  buffer_load_dwordx4 v4, s[12:15], s42 offen sc1 lds
  s_cmp_ge_u32 s43, 54
  s_cselect_b32 s42, 54, 0
  s_sub_u32 s43, s43, s42
  s_mul_i32 s42, s43, 5120
  s_add_u32 s42, s42, s40
  s_add_u32 s43, s43, 4
  s_add_u32 m0, s41, 102400
  s_nop 0
  buffer_load_dwordx4 v4, s[12:15], s42 offen offset:0 sc1 lds
  buffer_load_dwordx4 v4, s[12:15], s42 offen offset:1024 sc1 lds
  buffer_load_dwordx4 v4, s[12:15], s42 offen offset:2048 sc1 lds
  buffer_load_dwordx4 v4, s[12:15], s42 offen offset:3072 sc1 lds
  s_add_u32 m0, s41, 106496
  s_add_u32 s42, s42, 4096
  buffer_load_dwordx4 v4, s[12:15], s42 offen sc1 lds
  s_barrier
  s_cmp_ge_u32 s43, 54
  s_cselect_b32 s42, 54, 0
  s_sub_u32 s43, s43, s42
  s_mul_i32 s42, s43, 5120
  s_add_u32 s42, s42, s40
  s_add_u32 s43, s43, 4
  s_add_u32 m0, s41, 0
  s_nop 0
  buffer_load_dwordx4 v4, s[12:15], s42 offen offset:0 sc1 lds
  buffer_load_dwordx4 v4, s[12:15], s42 offen offset:1024 sc1 lds
  buffer_load_dwordx4 v4, s[12:15], s42 offen offset:2048 sc1 lds
  buffer_load_dwordx4 v4, s[12:15], s42 offen offset:3072 sc1 lds
  s_add_u32 m0, s41, 4096
  s_add_u32 s42, s42, 4096
  buffer_load_dwordx4 v4, s[12:15], s42 offen sc1 lds
  s_cmp_ge_u32 s43, 54
  s_cselect_b32 s42, 54, 0
  s_sub_u32 s43, s43, s42
  s_mul_i32 s42, s43, 5120
  s_add_u32 s42, s42, s40
  s_add_u32 s43, s43, 4
  s_add_u32 m0, s41, 20480
  s_nop 0
  buffer_load_dwordx4 v4, s[12:15], s42 offen offset:0 sc1 lds
  buffer_load_dwordx4 v4, s[12:15], s42 offen offset:1024 sc1 lds
  buffer_load_dwordx4 v4, s[12:15], s42 offen offset:2048 sc1 lds
  buffer_load_dwordx4 v4, s[12:15], s42 offen offset:3072 sc1 lds
  s_add_u32 m0, s41, 24576
  s_add_u32 s42, s42, 4096
  buffer_load_dwordx4 v4, s[12:15], s42 offen sc1 lds
  s_barrier
  s_waitcnt vmcnt(30)
  s_barrier
  s_waitcnt vmcnt(25)
  s_barrier
  s_cmp_ge_u32 s43, 54
  s_cselect_b32 s42, 54, 0
  s_sub_u32 s43, s43, s42
  s_mul_i32 s42, s43, 5120
  s_add_u32 s42, s42, s40
  s_add_u32 s43, s43, 4
  s_add_u32 m0, s41, 122880
  s_nop 0
  buffer_load_dwordx4 v4, s[12:15], s42 offen offset:0 sc1 lds
  buffer_load_dwordx4 v4, s[12:15], s42 offen offset:1024 sc1 lds
  buffer_load_dwordx4 v4, s[12:15], s42 offen offset:2048 sc1 lds
  buffer_load_dwordx4 v4, s[12:15], s42 offen offset:3072 sc1 lds
  s_add_u32 m0, s41, 126976
  s_add_u32 s42, s42, 4096
  buffer_load_dwordx4 v4, s[12:15], s42 offen sc1 lds
  s_waitcnt vmcnt(25)
  s_barrier
  s_cmp_ge_u32 s43, 54
  s_cselect_b32 s42, 54, 0
  s_sub_u32 s43, s43, s42
  s_mul_i32 s42, s43, 5120
  s_add_u32 s42, s42, s40
  s_add_u32 s43, s43, 4
  s_add_u32 m0, s41, 40960
  s_nop 0
  buffer_load_dwordx4 v4, s[12:15], s42 offen offset:0 sc1 lds
  buffer_load_dwordx4 v4, s[12:15], s42 offen offset:1024 sc1 lds
  buffer_load_dwordx4 v4, s[12:15], s42 offen offset:2048 sc1 lds
  buffer_load_dwordx4 v4, s[12:15], s42 offen offset:3072 sc1 lds
  s_add_u32 m0, s41, 45056
  s_add_u32 s42, s42, 4096
  buffer_load_dwordx4 v4, s[12:15], s42 offen sc1 lds
  s_waitcnt vmcnt(25)
  s_barrier
  s_cmp_ge_u32 s43, 54
  s_cselect_b32 s42, 54, 0
  s_sub_u32 s43, s43, s42
  s_mul_i32 s42, s43, 5120
  s_add_u32 s42, s42, s40
  s_add_u32 s43, s43, 4
  s_add_u32 m0, s41, 61440
  s_nop 0
  buffer_load_dwordx4 v4, s[12:15], s42 offen offset:0 sc1 lds
  buffer_load_dwordx4 v4, s[12:15], s42 offen offset:1024 sc1 lds
  buffer_load_dwordx4 v4, s[12:15], s42 offen offset:2048 sc1 lds
  buffer_load_dwordx4 v4, s[12:15], s42 offen offset:3072 sc1 lds
  s_add_u32 m0, s41, 65536
  s_add_u32 s42, s42, 4096
  buffer_load_dwordx4 v4, s[12:15], s42 offen sc1 lds
  s_waitcnt vmcnt(25)
  s_barrier
  s_cmp_ge_u32 s43, 54
  s_cselect_b32 s42, 54, 0
  s_sub_u32 s43, s43, s42
  s_mul_i32 s42, s43, 5120
  s_add_u32 s42, s42, s40
  s_add_u32 s43, s43, 4
  s_add_u32 m0, s41, 81920
  s_nop 0
  buffer_load_dwordx4 v4, s[12:15], s42 offen offset:0 sc1 lds
  buffer_load_dwordx4 v4, s[12:15], s42 offen offset:1024 sc1 lds
  buffer_load_dwordx4 v4, s[12:15], s42 offen offset:2048 sc1 lds
  buffer_load_dwordx4 v4, s[12:15], s42 offen offset:3072 sc1 lds
  s_add_u32 m0, s41, 86016
  s_add_u32 s42, s42, 4096
  buffer_load_dwordx4 v4, s[12:15], s42 offen sc1 lds
  s_waitcnt vmcnt(25)
  s_barrier
  s_cmp_ge_u32 s43, 54
  s_cselect_b32 s42, 54, 0
  s_sub_u32 s43, s43, s42
  s_mul_i32 s42, s43, 5120
  s_add_u32 s42, s42, s40
  s_add_u32 s43, s43, 4
  s_add_u32 m0, s41, 102400
  s_nop 0
  buffer_load_dwordx4 v4, s[12:15], s42 offen offset:0 sc1 lds
  buffer_load_dwordx4 v4, s[12:15], s42 offen offset:1024 sc1 lds
  buffer_load_dwordx4 v4, s[12:15], s42 offen offset:2048 sc1 lds
  buffer_load_dwordx4 v4, s[12:15], s42 offen offset:3072 sc1 lds
  s_add_u32 m0, s41, 106496
  s_add_u32 s42, s42, 4096
  buffer_load_dwordx4 v4, s[12:15], s42 offen sc1 lds
  s_waitcnt vmcnt(25)
  s_barrier
  s_cmp_ge_u32 s43, 54
  s_cselect_b32 s42, 54, 0
  s_sub_u32 s43, s43, s42
  s_mul_i32 s42, s43, 5120
  s_add_u32 s42, s42, s40
  s_add_u32 s43, s43, 4
  s_add_u32 m0, s41, 0
  s_nop 0
  buffer_load_dwordx4 v4, s[12:15], s42 offen offset:0 sc1 lds
  buffer_load_dwordx4 v4, s[12:15], s42 offen offset:1024 sc1 lds
  buffer_load_dwordx4 v4, s[12:15], s42 offen offset:2048 sc1 lds
  buffer_load_dwordx4 v4, s[12:15], s42 offen offset:3072 sc1 lds
  s_add_u32 m0, s41, 4096
  s_add_u32 s42, s42, 4096
  buffer_load_dwordx4 v4, s[12:15], s42 offen sc1 lds
  s_waitcnt vmcnt(25)
  s_barrier
  s_cmp_ge_u32 s43, 54
  s_cselect_b32 s42, 54, 0
  s_sub_u32 s43, s43, s42
  s_mul_i32 s42, s43, 5120
  s_add_u32 s42, s42, s40
  s_add_u32 s43, s43, 4
  s_add_u32 m0, s41, 20480
  s_nop 0
  buffer_load_dwordx4 v4, s[12:15], s42 offen offset:0 sc1 lds
  buffer_load_dwordx4 v4, s[12:15], s42 offen offset:1024 sc1 lds
  buffer_load_dwordx4 v4, s[12:15], s42 offen offset:2048 sc1 lds
  buffer_load_dwordx4 v4, s[12:15], s42 offen offset:3072 sc1 lds
  s_add_u32 m0, s41, 24576
  s_add_u32 s42, s42, 4096
  buffer_load_dwordx4 v4, s[12:15], s42 offen sc1 lds
  s_waitcnt vmcnt(25)
  s_barrier
  s_waitcnt vmcnt(20)
  s_barrier
  s_waitcnt vmcnt(15)
  s_barrier
  s_waitcnt vmcnt(10)
  s_barrier
  s_waitcnt vmcnt(5)
  s_barrier
  s_waitcnt vmcnt(0)
  s_barrier
Lsequential_preLN__linear_kernel_hedgehog__geglu_ffn__prompt_kernel_fin:
Lsequential_preLN__linear_kernel_hedgehog__geglu_ffn__prompt_kernel_end:
  s_endpgm
Lsequential_preLN__linear_kernel_hedgehog__geglu_ffn__prompt_kernel_last:

.section .rodata,"a"
.p2align 6
.amdhsa_kernel sequential_preLN__linear_kernel_hedgehog__geglu_ffn__prompt_kernel
  .amdhsa_next_free_vgpr 256
  .amdhsa_next_free_sgpr 102
  .amdhsa_accum_offset 256
  .amdhsa_group_segment_fixed_size 0
  .amdhsa_kernarg_size 88
  .amdhsa_user_sgpr_count 2
  .amdhsa_user_sgpr_kernarg_segment_ptr 1
  .amdhsa_system_sgpr_workgroup_id_x 1
.end_amdhsa_kernel
```
